```python
import torch

def _softmax(x, axis=-1):
    return torch.softmax(x, dim=axis)
def _gelu(x):
    return torch.nn.functional.gelu(x, approximate="tanh")
def _silu(x):
    return torch.nn.functional.silu(x)
def _sigmoid(x):
    return torch.sigmoid(x)
def _layernorm(x, axis=-1, eps=1e-5):
    m = x.mean(dim=axis, keepdim=True)
    v = x.var(dim=axis, keepdim=True, unbiased=False)
    return (x - m) / torch.sqrt(v + eps)
def _scatter_add(tgt, idx, src, axis=0):
    return tgt.clone().index_add_(axis, idx, src)
def _segment_sum(src, seg, n):
    out = torch.zeros((n,) + src.shape[1:], dtype=src.dtype)
    return out.index_add_(0, seg, src)
def _pad(x, pw):
    flat = tuple(v for pair in reversed(pw) for v in pair)
    return torch.nn.functional.pad(x, flat)

kernel_name = 'parallel_sum__linear_attn_block__glu_gated_glu__prompt'

def setup_inputs():

    _w = (lambda a: (lambda t: t.to(torch.bfloat16) if t.is_floating_point() else t)(torch.as_tensor(a)))
    def _A_setup():
        B, S, D = 1, 2048, 640
        return {
            "x": _w((lambda *s: torch.randn(*s, dtype=torch.bfloat16) * 0.05)(B, S, D)),
            "wqkv": _w((lambda *s: torch.randn(*s, dtype=torch.bfloat16) * 0.2)(D, 3 * D)),
            "wo": _w((lambda *s: torch.randn(*s, dtype=torch.bfloat16) * 0.2)(D, D)),
        }
    _A_in = _A_setup()

    def _B_setup():
        B, S, D, F = 1, 2048, 640, 1728
        return {
            "x": _w((lambda *s: torch.randn(*s, dtype=torch.bfloat16) * 0.05)(B, S, D)),
            "w_gate": _w((lambda *s: torch.randn(*s, dtype=torch.bfloat16) * 0.05)(D, F)),
            "w_up": _w((lambda *s: torch.randn(*s, dtype=torch.bfloat16) * 0.05)(D, F)),
            "w_down": _w((lambda *s: torch.randn(*s, dtype=torch.bfloat16) * 0.05)(F, D)),
        }
    _B_in = _B_setup()

    return {
        "A_x": _A_in["x"],
        "A_wqkv": _A_in["wqkv"],
        "A_wo": _A_in["wo"],
        "B_x": _B_in["x"],
        "B_w_gate": _B_in["w_gate"],
        "B_w_up": _B_in["w_up"],
        "B_w_down": _B_in["w_down"],
    }

def reference(A_x, A_wqkv, A_wo, B_x, B_w_gate, B_w_up, B_w_down):
    def _A_ref(x, wqkv, wo):
        B, S, D = x.shape
        H = 32; Dh = D // H
        qkv = (lambda x, *d: x.permute(*d))((x @ wqkv).reshape(B, S, 3, H, Dh), 2, 0, 3, 1, 4)
        q, k, v = qkv[0], qkv[1], qkv[2]
        phi = lambda t: torch.where(t > 0, t + 1, torch.exp(t)) + 1e-6
        pq, pk = phi(q), phi(k)
        kv = torch.einsum("bhsd,bhse->bhde", pk, v)
        z = torch.einsum("bhsd->bhd", pk)
        num = torch.einsum("bhqd,bhde->bhqe", pq, kv)
        den = torch.einsum("bhqd,bhd->bhq", pq, z)[..., None] + 1e-6
        o = num / den
        return (lambda x, *d: x.permute(*d))(o, 0, 2, 1, 3).reshape(B, S, D) @ wo

    def _B_ref(x, w_gate, w_up, w_down):
        g = torch.einsum("bsd,df->bsf", x, w_gate)
        u = torch.einsum("bsd,df->bsf", x, w_up)
        h = _sigmoid(g) * u
        return torch.einsum("bsf,fd->bsd", h, w_down)

    x = A_x
    xn = _layernorm(x, axis=-1)
    return x + _A_ref(xn, A_wqkv, A_wo) + _B_ref(xn, B_w_gate, B_w_up, B_w_down)
```

```asm
; @launch kernel=prep_kernel grid=(256,1,1) block=(256,1,1) lds=16384
; @launch kernel=front_kernel grid=(256,1,1) block=(512,1,1) lds=163840
; @launch kernel=final_kernel grid=(256,1,1) block=(256,1,1) lds=86016
.amdgcn_target "amdgcn-amd-amdhsa--gfx950"
.text
.globl prep_kernel
.p2align 8
.type prep_kernel,@function
prep_kernel:

  s_cmp_ge_u32 s2, 256
  s_cbranch_scc1 prep_kernel_end
  s_load_dwordx2 s[4:5], s[0:1], 0
  s_load_dwordx2 s[8:9], s[0:1], 16
  s_load_dwordx2 s[16:17], s[0:1], 48
  s_load_dwordx2 s[22:23], s[0:1], 72
  v_lshrrev_b32 v1, 6, v0
  v_and_b32 v15, 63, v0
  v_readfirstlane_b32 s24, v1
  v_lshrrev_b32 v23, 5, v15
  v_and_b32 v24, 31, v15
  v_lshlrev_b32 v14, 4, v15
  s_lshl_b32 s80, s2, 3
  s_lshl_b32 s81, s24, 1
  s_add_u32 s80, s80, s81
  v_add_u32 v30, s80, v23
  v_mul_u32_u24 v31, 1280, v30
  v_lshlrev_b32 v32, 4, v24
  v_add_u32 v31, v31, v32
  v_cmp_gt_u32 vcc, 16, v24
  v_mov_b32 v33, 0x7f000000
  s_lshl_b32 s60, s24, 8
  s_add_u32 s60, s60, s2
  s_mul_i32 s61, s60, 0x199a
  s_lshr_b32 s61, s61, 16
  s_mul_i32 s62, s61, 10
  s_sub_u32 s62, s60, s62
  v_cndmask_b32 v32, v33, v31, vcc
  s_waitcnt lgkmcnt(0)
  s_mov_b32 s28, s4
  s_mov_b32 s29, s5
  s_mov_b32 s30, 2621440
  s_mov_b32 s31, 0x00020000
  buffer_load_dwordx4 v[36:39], v31, s[28:31], 0 offen
  buffer_load_dwordx4 v[40:43], v31, s[28:31], 0 offen offset:512
  buffer_load_dwordx4 v[44:47], v32, s[28:31], 0 offen offset:1024
  s_getpc_b64 s[84:85]
Lpf_1:
  s_add_u32 s84, s84, front_kernel-Lpf_1
  s_addc_u32 s85, s85, 0
  s_lshr_b32 s86, s2, 3
  s_lshl_b32 s86, s86, 11
  s_lshl_b32 s87, s24, 9
  s_add_u32 s86, s86, s87
  v_lshlrev_b32 v110, 3, v15
  v_add_u32 v110, s86, v110
  s_mov_b32 s87, code_end-front_kernel-8
  v_min_u32 v110, s87, v110
  global_load_dwordx2 v[112:113], v110, s[84:85]
  v_add_u32 v111, 0x10000, v110
  v_min_u32 v111, s87, v111
  global_load_dwordx2 v[114:115], v111, s[84:85]
  s_load_dwordx2 s[88:89], s[0:1], 8
  s_lshl_b32 s86, s2, 8
  v_add_u32 v116, s86, v0
  s_waitcnt lgkmcnt(0)
  s_mov_b32 s64, s88
  s_mov_b32 s65, s89
  s_mov_b32 s66, 2457600
  s_mov_b32 s67, 0x00020000
  s_add_u32 s68, s22, 25165824
  s_addc_u32 s69, s23, 0
  s_mov_b32 s70, 2621440
  s_mov_b32 s71, 0x00020000
  v_add_u32 v120, 0, v116
  v_lshrrev_b32 v121, 5, v120
  v_and_b32 v122, 31, v120
  v_mul_u32_u24 v123, 6554, v121
  v_lshrrev_b32 v123, 22, v123
  v_mul_u32_u24 v127, 640, v123
  v_sub_u32 v124, v121, v127
  v_lshlrev_b32 v127, 4, v122
  v_mul_u32_u24 v128, 160, v123
  v_add_u32 v125, v127, v128
  v_mov_b32 v128, 0
  v_cmp_le_u32 vcc, 12, v122
  v_mov_b32 v126, 1088
  s_nop 0
  v_cndmask_b32 v128, v128, v126, vcc
  v_cmp_le_u32 vcc, 22, v122
  v_mov_b32 v126, 2336
  s_nop 0
  v_cndmask_b32 v128, v128, v126, vcc
  v_cmp_le_u32 vcc, 24, v122
  v_mov_b32 v126, 2176
  s_nop 0
  v_cndmask_b32 v128, v128, v126, vcc
  v_add_u32 v125, v125, v128
  v_mul_u32_u24 v128, 3840, v124
  v_add_u32 v125, v125, v128
  v_mul_u32_u24 v126, 192, v121
  v_add_u32 v126, v126, v127
  v_add_u32 v128, 982848, v126
  v_cmp_le_u32 vcc, 12, v122
  s_nop 1
  v_cndmask_b32 v126, v126, v128, vcc
  v_lshlrev_b32 v128, 7, v121
  v_add_u32 v128, v128, v127
  v_add_u32 v128, 1965696, v128
  v_cmp_le_u32 vcc, 24, v122
  s_nop 1
  v_cndmask_b32 v126, v126, v128, vcc
  buffer_load_dwordx4 v[152:155], v125, s[64:67], 0 offen
  v_add_u32 v130, 65536, v116
  v_lshrrev_b32 v131, 5, v130
  v_and_b32 v132, 31, v130
  v_mul_u32_u24 v133, 6554, v131
  v_lshrrev_b32 v133, 22, v133
  v_mul_u32_u24 v137, 640, v133
  v_sub_u32 v134, v131, v137
  v_lshlrev_b32 v137, 4, v132
  v_mul_u32_u24 v138, 160, v133
  v_add_u32 v135, v137, v138
  v_mov_b32 v138, 0
  v_cmp_le_u32 vcc, 12, v132
  v_mov_b32 v136, 1088
  s_nop 0
  v_cndmask_b32 v138, v138, v136, vcc
  v_cmp_le_u32 vcc, 22, v132
  v_mov_b32 v136, 2336
  s_nop 0
  v_cndmask_b32 v138, v138, v136, vcc
  v_cmp_le_u32 vcc, 24, v132
  v_mov_b32 v136, 2176
  s_nop 0
  v_cndmask_b32 v138, v138, v136, vcc
  v_add_u32 v135, v135, v138
  v_mul_u32_u24 v138, 3840, v134
  v_add_u32 v135, v135, v138
  v_mul_u32_u24 v136, 192, v131
  v_add_u32 v136, v136, v137
  v_add_u32 v138, 982848, v136
  v_cmp_le_u32 vcc, 12, v132
  s_nop 1
  v_cndmask_b32 v136, v136, v138, vcc
  v_lshlrev_b32 v138, 7, v131
  v_add_u32 v138, v138, v137
  v_add_u32 v138, 1965696, v138
  v_cmp_le_u32 vcc, 24, v132
  s_nop 1
  v_cndmask_b32 v136, v136, v138, vcc
  buffer_load_dwordx4 v[156:159], v135, s[64:67], 0 offen
  v_add_u32 v140, 131072, v116
  v_lshrrev_b32 v141, 5, v140
  v_and_b32 v142, 31, v140
  v_mul_u32_u24 v143, 6554, v141
  v_lshrrev_b32 v143, 22, v143
  v_mul_u32_u24 v147, 640, v143
  v_sub_u32 v144, v141, v147
  v_lshlrev_b32 v147, 4, v142
  v_mul_u32_u24 v148, 160, v143
  v_add_u32 v145, v147, v148
  v_mov_b32 v148, 0
  v_cmp_le_u32 vcc, 12, v142
  v_mov_b32 v146, 1088
  s_nop 0
  v_cndmask_b32 v148, v148, v146, vcc
  v_cmp_le_u32 vcc, 22, v142
  v_mov_b32 v146, 2336
  s_nop 0
  v_cndmask_b32 v148, v148, v146, vcc
  v_cmp_le_u32 vcc, 24, v142
  v_mov_b32 v146, 2176
  s_nop 0
  v_cndmask_b32 v148, v148, v146, vcc
  v_add_u32 v145, v145, v148
  v_mul_u32_u24 v148, 3840, v144
  v_add_u32 v145, v145, v148
  v_mul_u32_u24 v146, 192, v141
  v_add_u32 v146, v146, v147
  v_add_u32 v148, 982848, v146
  v_cmp_le_u32 vcc, 12, v142
  s_nop 1
  v_cndmask_b32 v146, v146, v148, vcc
  v_lshlrev_b32 v148, 7, v141
  v_add_u32 v148, v148, v147
  v_add_u32 v148, 1965696, v148
  v_cmp_le_u32 vcc, 24, v142
  s_nop 1
  v_cndmask_b32 v146, v146, v148, vcc
  v_cmp_gt_u32 vcc, 163840, v140
  v_mov_b32 v148, 0x7f000000
  s_nop 0
  v_cndmask_b32 v145, v148, v145, vcc
  v_cndmask_b32 v146, v148, v146, vcc
  buffer_load_dwordx4 v[160:163], v145, s[64:67], 0 offen
  s_mul_i32 s97, s61, 40
  s_lshl_b32 s83, s62, 2
  s_add_u32 s97, s97, s83
  s_lshl_b32 s97, s97, 10
  s_cmp_ge_u32 s60, 740
  s_cselect_b32 s97, 0x7f000000, s97
  s_mov_b32 s56, s8
  s_mov_b32 s57, s9
  s_mov_b32 s58, 819200
  s_mov_b32 s59, 0x00020000
  s_lshl_b32 s83, s61, 5
  s_cmp_lt_u32 s61, 20
  s_cbranch_scc1 Lw2_2
  s_mov_b32 s56, s16
  s_mov_b32 s57, s17
  s_mov_b32 s58, 2211840
  s_mov_b32 s59, 0x00020000
  s_sub_u32 s83, s83, 640
Lw2_2:
  s_mul_i32 s83, s83, 1280
  s_lshl_b32 s62, s62, 7
  s_add_u32 s83, s83, s62
  s_cmp_ge_u32 s60, 740
  s_cselect_b32 s83, 0x7f000000, s83
  v_lshrrev_b32 v96, 3, v15
  v_mul_u32_u24 v96, 1280, v96
  v_and_b32 v97, 7, v15
  v_lshlrev_b32 v97, 4, v97
  v_add_u32 v96, v96, v97
  s_lshl_b32 s74, s24, 12
  s_mov_b32 m0, s74
  s_nop 0
  buffer_load_dwordx4 v96, s[56:59], s83 offen lds
  s_add_u32 m0, m0, 1024
  s_add_u32 s83, s83, 10240
  buffer_load_dwordx4 v96, s[56:59], s83 offen lds
  s_add_u32 m0, m0, 1024
  s_add_u32 s83, s83, 10240
  buffer_load_dwordx4 v96, s[56:59], s83 offen lds
  s_add_u32 m0, m0, 1024
  s_add_u32 s83, s83, 10240
  buffer_load_dwordx4 v96, s[56:59], s83 offen lds
  s_add_u32 s40, s22, 16777216
  s_addc_u32 s41, s23, 0
  s_mov_b32 s42, 2621440
  s_mov_b32 s43, 0x00020000
  s_add_u32 s44, s22, 10485760
  s_addc_u32 s45, s23, 0
  s_mov_b32 s46, 3031040
  s_mov_b32 s47, 0x00020000
  s_add_u32 s48, s22, 14680064
  s_addc_u32 s49, s23, 0
  s_mov_b32 s50, 262144
  s_mov_b32 s51, 0x00020000
  s_add_u32 s52, s22, 15466496
  s_addc_u32 s53, s23, 0
  s_mov_b32 s54, 16384
  s_mov_b32 s55, 0x00020000
  v_mov_b32 v100, 0
  v_mov_b32 v101, 0
  v_mov_b32 v102, 0
  v_mov_b32 v103, 0
  s_cmp_lg_u32 s24, 0
  s_cbranch_scc1 Lz_3
  s_lshl_b32 s72, s2, 10
  buffer_store_dwordx4 v[100:103], v14, s[48:51], s72 offen
Lz_3:
  s_cmp_lg_u32 s24, 1
  s_cbranch_scc1 Lz_4
  s_cmp_ge_u32 s2, 16
  s_cbranch_scc1 Lz_4
  s_lshl_b32 s72, s2, 10
  buffer_store_dwordx4 v[100:103], v14, s[52:55], s72 offen
Lz_4:
  s_waitcnt vmcnt(0)
  v_lshlrev_b32 v50, 16, v36
  v_and_b32 v51, 0xffff0000, v36
  v_lshlrev_b32 v52, 16, v37
  v_and_b32 v53, 0xffff0000, v37
  v_lshlrev_b32 v54, 16, v38
  v_and_b32 v55, 0xffff0000, v38
  v_lshlrev_b32 v56, 16, v39
  v_and_b32 v57, 0xffff0000, v39
  v_lshlrev_b32 v58, 16, v40
  v_and_b32 v59, 0xffff0000, v40
  v_lshlrev_b32 v60, 16, v41
  v_and_b32 v61, 0xffff0000, v41
  v_lshlrev_b32 v62, 16, v42
  v_and_b32 v63, 0xffff0000, v42
  v_lshlrev_b32 v64, 16, v43
  v_and_b32 v65, 0xffff0000, v43
  v_lshlrev_b32 v66, 16, v44
  v_and_b32 v67, 0xffff0000, v44
  v_lshlrev_b32 v68, 16, v45
  v_and_b32 v69, 0xffff0000, v45
  v_lshlrev_b32 v70, 16, v46
  v_and_b32 v71, 0xffff0000, v46
  v_lshlrev_b32 v72, 16, v47
  v_and_b32 v73, 0xffff0000, v47
  v_add_f32 v80, v50, v51
  v_add_f32 v81, v52, v53
  v_add_f32 v80, v80, v54
  v_add_f32 v81, v81, v55
  v_add_f32 v80, v80, v56
  v_add_f32 v81, v81, v57
  v_add_f32 v80, v80, v58
  v_add_f32 v81, v81, v59
  v_add_f32 v80, v80, v60
  v_add_f32 v81, v81, v61
  v_add_f32 v80, v80, v62
  v_add_f32 v81, v81, v63
  v_add_f32 v80, v80, v64
  v_add_f32 v81, v81, v65
  v_add_f32 v80, v80, v66
  v_add_f32 v81, v81, v67
  v_add_f32 v80, v80, v68
  v_add_f32 v81, v81, v69
  v_add_f32 v80, v80, v70
  v_add_f32 v81, v81, v71
  v_add_f32 v80, v80, v72
  v_add_f32 v81, v81, v73
  v_add_f32 v80, v80, v81
  s_nop 1
  v_add_f32_dpp v80, v80, v80 quad_perm:[1,0,3,2] row_mask:0xf bank_mask:0xf
  s_nop 1
  v_add_f32_dpp v80, v80, v80 quad_perm:[2,3,0,1] row_mask:0xf bank_mask:0xf
  s_nop 1
  v_add_f32_dpp v80, v80, v80 row_half_mirror row_mask:0xf bank_mask:0xf
  s_nop 1
  v_add_f32_dpp v80, v80, v80 row_mirror row_mask:0xf bank_mask:0xf
  v_mov_b32 v81, v80
  s_nop 1
  v_permlane16_swap_b32 v80, v81
  s_nop 1
  v_add_f32 v80, v80, v81
  v_mul_f32 v80, 0x3acccccd, v80
  v_sub_f32 v50, v50, v80
  v_sub_f32 v51, v51, v80
  v_sub_f32 v52, v52, v80
  v_sub_f32 v53, v53, v80
  v_sub_f32 v54, v54, v80
  v_sub_f32 v55, v55, v80
  v_sub_f32 v56, v56, v80
  v_sub_f32 v57, v57, v80
  v_sub_f32 v58, v58, v80
  v_sub_f32 v59, v59, v80
  v_sub_f32 v60, v60, v80
  v_sub_f32 v61, v61, v80
  v_sub_f32 v62, v62, v80
  v_sub_f32 v63, v63, v80
  v_sub_f32 v64, v64, v80
  v_sub_f32 v65, v65, v80
  v_sub_f32 v66, v66, v80
  v_sub_f32 v67, v67, v80
  v_sub_f32 v68, v68, v80
  v_sub_f32 v69, v69, v80
  v_sub_f32 v70, v70, v80
  v_sub_f32 v71, v71, v80
  v_sub_f32 v72, v72, v80
  v_sub_f32 v73, v73, v80
  v_cmp_gt_u32 vcc, 16, v24
  v_mul_f32 v82, v50, v50
  v_mul_f32 v83, v51, v51
  v_fmac_f32 v82, v52, v52
  v_fmac_f32 v83, v53, v53
  v_fmac_f32 v82, v54, v54
  v_fmac_f32 v83, v55, v55
  v_fmac_f32 v82, v56, v56
  v_fmac_f32 v83, v57, v57
  v_fmac_f32 v82, v58, v58
  v_fmac_f32 v83, v59, v59
  v_fmac_f32 v82, v60, v60
  v_fmac_f32 v83, v61, v61
  v_fmac_f32 v82, v62, v62
  v_fmac_f32 v83, v63, v63
  v_fmac_f32 v82, v64, v64
  v_fmac_f32 v83, v65, v65
  v_cndmask_b32 v66, 0, v66, vcc
  v_cndmask_b32 v67, 0, v67, vcc
  v_cndmask_b32 v68, 0, v68, vcc
  v_cndmask_b32 v69, 0, v69, vcc
  v_cndmask_b32 v70, 0, v70, vcc
  v_cndmask_b32 v71, 0, v71, vcc
  v_cndmask_b32 v72, 0, v72, vcc
  v_cndmask_b32 v73, 0, v73, vcc
  v_fmac_f32 v82, v66, v66
  v_fmac_f32 v83, v67, v67
  v_fmac_f32 v82, v68, v68
  v_fmac_f32 v83, v69, v69
  v_fmac_f32 v82, v70, v70
  v_fmac_f32 v83, v71, v71
  v_fmac_f32 v82, v72, v72
  v_fmac_f32 v83, v73, v73
  v_add_f32 v82, v82, v83
  s_nop 1
  v_add_f32_dpp v82, v82, v82 quad_perm:[1,0,3,2] row_mask:0xf bank_mask:0xf
  s_nop 1
  v_add_f32_dpp v82, v82, v82 quad_perm:[2,3,0,1] row_mask:0xf bank_mask:0xf
  s_nop 1
  v_add_f32_dpp v82, v82, v82 row_half_mirror row_mask:0xf bank_mask:0xf
  s_nop 1
  v_add_f32_dpp v82, v82, v82 row_mirror row_mask:0xf bank_mask:0xf
  v_mov_b32 v83, v82
  s_nop 1
  v_permlane16_swap_b32 v82, v83
  s_nop 1
  v_add_f32 v82, v82, v83
  v_mul_f32 v82, 0x3acccccd, v82
  v_add_f32 v82, 0x3727c5ac, v82
  v_rsq_f32 v82, v82
  s_nop 0
  v_mul_f32 v50, v50, v82
  v_mul_f32 v51, v51, v82
  v_mul_f32 v52, v52, v82
  v_mul_f32 v53, v53, v82
  v_mul_f32 v54, v54, v82
  v_mul_f32 v55, v55, v82
  v_mul_f32 v56, v56, v82
  v_mul_f32 v57, v57, v82
  v_mul_f32 v58, v58, v82
  v_mul_f32 v59, v59, v82
  v_mul_f32 v60, v60, v82
  v_mul_f32 v61, v61, v82
  v_mul_f32 v62, v62, v82
  v_mul_f32 v63, v63, v82
  v_mul_f32 v64, v64, v82
  v_mul_f32 v65, v65, v82
  v_mul_f32 v66, v66, v82
  v_mul_f32 v67, v67, v82
  v_mul_f32 v68, v68, v82
  v_mul_f32 v69, v69, v82
  v_mul_f32 v70, v70, v82
  v_mul_f32 v71, v71, v82
  v_mul_f32 v72, v72, v82
  v_mul_f32 v73, v73, v82
  v_cvt_pk_bf16_f32 v36, v50, v51
  v_cvt_pk_bf16_f32 v37, v52, v53
  v_cvt_pk_bf16_f32 v38, v54, v55
  v_cvt_pk_bf16_f32 v39, v56, v57
  v_cvt_pk_bf16_f32 v40, v58, v59
  v_cvt_pk_bf16_f32 v41, v60, v61
  v_cvt_pk_bf16_f32 v42, v62, v63
  v_cvt_pk_bf16_f32 v43, v64, v65
  v_cvt_pk_bf16_f32 v44, v66, v67
  v_cvt_pk_bf16_f32 v45, v68, v69
  v_cvt_pk_bf16_f32 v46, v70, v71
  v_cvt_pk_bf16_f32 v47, v72, v73
  v_lshrrev_b32 v84, 5, v30
  v_mul_u32_u24 v84, 40960, v84
  v_and_b32 v85, 31, v30
  v_lshlrev_b32 v85, 4, v85
  v_add_u32 v84, v84, v85
  v_lshrrev_b32 v85, 1, v24
  v_lshlrev_b32 v85, 10, v85
  v_add_u32 v84, v84, v85
  v_and_b32 v85, 1, v24
  v_lshlrev_b32 v85, 9, v85
  v_add_u32 v84, v84, v85
  v_cmp_gt_u32 vcc, 16, v24
  v_mov_b32 v86, 0x7f000000
  s_mov_b32 s72, 16384
  s_mov_b32 s73, 32768
  v_cndmask_b32 v86, v86, v84, vcc
  buffer_store_dwordx4 v[36:39], v84, s[40:43], 0 offen
  buffer_store_dwordx4 v[40:43], v84, s[40:43], s72 offen
  buffer_store_dwordx4 v[44:47], v86, s[40:43], s73 offen
  buffer_store_dwordx4 v[152:155], v126, s[68:71], 0 offen
  buffer_store_dwordx4 v[156:159], v136, s[68:71], 0 offen
  buffer_store_dwordx4 v[160:163], v146, s[68:71], 0 offen
  v_lshrrev_b32 v96, 5, v15
  v_lshlrev_b32 v96, 4, v96
  v_bfe_u32 v97, v15, 4, 1
  v_lshlrev_b32 v97, 2, v97
  v_add_u32 v96, v96, v97
  v_bfe_u32 v97, v15, 2, 2
  v_add_u32 v96, v96, v97
  v_lshlrev_b32 v96, 7, v96
  v_and_b32 v97, 3, v15
  v_lshlrev_b32 v97, 3, v97
  v_add_u32 v96, v96, v97
  v_add_u32 v96, s74, v96
  ds_read_b64_tr_b16 v[104:105], v96 offset:0
  ds_read_b64_tr_b16 v[106:107], v96 offset:1024
  ds_read_b64_tr_b16 v[108:109], v96 offset:32
  ds_read_b64_tr_b16 v[110:111], v96 offset:1056
  ds_read_b64_tr_b16 v[112:113], v96 offset:64
  ds_read_b64_tr_b16 v[114:115], v96 offset:1088
  ds_read_b64_tr_b16 v[116:117], v96 offset:96
  ds_read_b64_tr_b16 v[118:119], v96 offset:1120
  s_waitcnt lgkmcnt(0)
  buffer_store_dwordx4 v[104:107], v14, s[44:47], s97 offen offset:0
  buffer_store_dwordx4 v[108:111], v14, s[44:47], s97 offen offset:1024
  buffer_store_dwordx4 v[112:115], v14, s[44:47], s97 offen offset:2048
  buffer_store_dwordx4 v[116:119], v14, s[44:47], s97 offen offset:3072
prep_kernel_end:
  s_endpgm
.section .rodata,"a"
.p2align 6
.amdhsa_kernel prep_kernel
  .amdhsa_next_free_vgpr 168
  .amdhsa_next_free_sgpr 102
  .amdhsa_accum_offset 168
  .amdhsa_group_segment_fixed_size 0
  .amdhsa_kernarg_size 80
  .amdhsa_user_sgpr_count 2
  .amdhsa_user_sgpr_kernarg_segment_ptr 1
  .amdhsa_system_sgpr_workgroup_id_x 1
.end_amdhsa_kernel
.text
.globl front_kernel
.p2align 8
.type front_kernel,@function
front_kernel:

  s_cmp_ge_u32 s2, 256
  s_cbranch_scc1 front_kernel_end
  s_load_dwordx4 s[4:7], s[0:1], 0
  s_load_dwordx2 s[8:9], s[0:1], 16
  s_load_dwordx4 s[12:15], s[0:1], 32
  s_load_dwordx2 s[16:17], s[0:1], 48
  s_load_dwordx4 s[20:23], s[0:1], 64
  v_lshrrev_b32 v1, 6, v0
  s_and_b32 s83, s2, 7
  v_readfirstlane_b32 s3, v1
  s_lshr_b32 s84, s2, 3
  s_and_b32 s25, s83, 1
  s_lshl_b32 s25, s25, 3
  s_and_b32 s85, s84, 7
  s_add_u32 s25, s25, s85
  s_lshr_b32 s85, s83, 1
  s_lshr_b32 s86, s84, 3
  s_lshr_b32 s27, s86, 1
  s_lshl_b32 s26, s85, 1
  s_and_b32 s86, s86, 1
  s_add_u32 s26, s26, s86
  s_lshl_b32 s19, s27, 3
  s_add_u32 s19, s19, s26
  s_and_b32 s24, s3, 3
  s_cmp_ge_u32 s3, 4
  s_cbranch_scc1 front_kernel_aux
  s_waitcnt lgkmcnt(0)
  s_add_u32 s28, s22, 16777216
  s_addc_u32 s29, s23, 0
  s_mov_b32 s30, 2621440
  s_mov_b32 s31, 0x00020000
  v_and_b32 v248, 63, v0
  v_lshlrev_b32 v247, 4, v248
  s_lshl_b32 s72, s25, 2
  s_add_u32 s72, s72, s24
  s_mul_i32 s72, s72, 40960
  buffer_load_dwordx4 v[0:3], v247, s[28:31], s72 offen offset:0
  buffer_load_dwordx4 v[4:7], v247, s[28:31], s72 offen offset:1024
  buffer_load_dwordx4 v[8:11], v247, s[28:31], s72 offen offset:2048
  buffer_load_dwordx4 v[12:15], v247, s[28:31], s72 offen offset:3072
  s_add_u32 s72, s72, 4096
  buffer_load_dwordx4 v[16:19], v247, s[28:31], s72 offen offset:0
  buffer_load_dwordx4 v[20:23], v247, s[28:31], s72 offen offset:1024
  buffer_load_dwordx4 v[24:27], v247, s[28:31], s72 offen offset:2048
  buffer_load_dwordx4 v[28:31], v247, s[28:31], s72 offen offset:3072
  v_lshrrev_b32 v249, 5, v248
  v_bfe_u32 v250, v248, 2, 2
  v_lshlrev_b32 v251, 3, v249
  v_add_u32 v251, v251, v250
  v_bfe_u32 v252, v248, 4, 1
  v_lshlrev_b32 v252, 5, v252
  v_and_b32 v253, 3, v248
  v_lshlrev_b32 v253, 3, v253
  v_add_u32 v252, v252, v253
  v_lshlrev_b32 v253, 7, v251
  v_add_u32 v253, v253, v252
  v_lshrrev_b32 v254, 1, v250
  v_lshlrev_b32 v254, 6, v254
  v_add_u32 v246, v253, v254
  v_mul_u32_u24 v253, 192, v251
  v_add_u32 v255, v253, v252
  s_mov_b32 s40, s22
  s_mov_b32 s41, s23
  s_mov_b32 s42, 9699328
  s_mov_b32 s43, 0x00020000
  s_add_u32 s44, s22, 20971520
  s_addc_u32 s45, s23, 0
  s_mov_b32 s46, 2621440
  s_mov_b32 s47, 0x00020000
  s_mov_b32 s97, 0xbfb8aa3b
  s_mov_b32 s98, 0x3fb8aa3b
  s_mov_b32 s99, 0x358637bd
  s_mov_b32 s76, 0xffff
  s_mov_b32 s77, 0xffff
  s_lshl_b32 s73, s24, 10
  s_add_u32 s73, s73, 114688
  v_add_u32 v252, s73, v247
  s_cmp_eq_u32 s27, 1
  s_cbranch_scc1 front_kernel_ckv
  s_barrier
  v_add_u32 v244, 0, v255
  ds_read_b64_tr_b16 v[224:225], v244 offset:0
  ds_read_b64_tr_b16 v[226:227], v244 offset:768
  ds_read_b64_tr_b16 v[228:229], v244 offset:64
  ds_read_b64_tr_b16 v[230:231], v244 offset:832
  ds_read_b64_tr_b16 v[232:233], v244 offset:128
  ds_read_b64_tr_b16 v[234:235], v244 offset:896
  ds_read_b64_tr_b16 v[236:237], v244 offset:3072
  ds_read_b64_tr_b16 v[238:239], v244 offset:3840
  ds_read_b64_tr_b16 v[240:241], v244 offset:3136
  ds_read_b64_tr_b16 v[242:243], v244 offset:3904
  s_waitcnt vmcnt(7)
  s_waitcnt lgkmcnt(6)
  v_mfma_f32_32x32x16_bf16 v[160:175], v[224:227], v[0:3], 0
  ds_read_b64_tr_b16 v[224:225], v244 offset:3200
  ds_read_b64_tr_b16 v[226:227], v244 offset:3968
  v_mfma_f32_32x32x16_bf16 v[176:191], v[228:231], v[0:3], 0
  s_add_u32 s72, s72, 4096
  buffer_load_dwordx4 v[32:35], v247, s[28:31], s72 offen offset:0
  ds_read_b64_tr_b16 v[228:229], v244 offset:6144
  ds_read_b64_tr_b16 v[230:231], v244 offset:6912
  s_waitcnt lgkmcnt(6)
  v_mfma_f32_32x32x16_bf16 v[192:207], v[232:235], v[0:3], 0
  ds_read_b64_tr_b16 v[232:233], v244 offset:6208
  ds_read_b64_tr_b16 v[234:235], v244 offset:6976
  s_waitcnt vmcnt(7)
  v_mfma_f32_32x32x16_bf16 v[160:175], v[236:239], v[4:7], v[160:175]
  buffer_load_dwordx4 v[36:39], v247, s[28:31], s72 offen offset:1024
  ds_read_b64_tr_b16 v[236:237], v244 offset:6272
  ds_read_b64_tr_b16 v[238:239], v244 offset:7040
  s_waitcnt lgkmcnt(6)
  v_mfma_f32_32x32x16_bf16 v[176:191], v[240:243], v[4:7], v[176:191]
  ds_read_b64_tr_b16 v[240:241], v244 offset:9216
  ds_read_b64_tr_b16 v[242:243], v244 offset:9984
  v_mfma_f32_32x32x16_bf16 v[192:207], v[224:227], v[4:7], v[192:207]
  buffer_load_dwordx4 v[40:43], v247, s[28:31], s72 offen offset:2048
  ds_read_b64_tr_b16 v[224:225], v244 offset:9280
  ds_read_b64_tr_b16 v[226:227], v244 offset:10048
  s_waitcnt vmcnt(8)
  s_waitcnt lgkmcnt(6)
  v_mfma_f32_32x32x16_bf16 v[160:175], v[228:231], v[8:11], v[160:175]
  ds_read_b64_tr_b16 v[228:229], v244 offset:9344
  ds_read_b64_tr_b16 v[230:231], v244 offset:10112
  v_mfma_f32_32x32x16_bf16 v[176:191], v[232:235], v[8:11], v[176:191]
  buffer_load_dwordx4 v[44:47], v247, s[28:31], s72 offen offset:3072
  ds_read_b64_tr_b16 v[232:233], v244 offset:12288
  ds_read_b64_tr_b16 v[234:235], v244 offset:13056
  s_waitcnt lgkmcnt(6)
  v_mfma_f32_32x32x16_bf16 v[192:207], v[236:239], v[8:11], v[192:207]
  ds_read_b64_tr_b16 v[236:237], v244 offset:12352
  ds_read_b64_tr_b16 v[238:239], v244 offset:13120
  s_waitcnt vmcnt(8)
  v_mfma_f32_32x32x16_bf16 v[160:175], v[240:243], v[12:15], v[160:175]
  s_add_u32 s72, s72, 4096
  buffer_load_dwordx4 v[48:51], v247, s[28:31], s72 offen offset:0
  ds_read_b64_tr_b16 v[240:241], v244 offset:12416
  ds_read_b64_tr_b16 v[242:243], v244 offset:13184
  s_waitcnt lgkmcnt(6)
  v_mfma_f32_32x32x16_bf16 v[176:191], v[224:227], v[12:15], v[176:191]
  ds_read_b64_tr_b16 v[224:225], v244 offset:15360
  ds_read_b64_tr_b16 v[226:227], v244 offset:16128
  v_mfma_f32_32x32x16_bf16 v[192:207], v[228:231], v[12:15], v[192:207]
  buffer_load_dwordx4 v[52:55], v247, s[28:31], s72 offen offset:1024
  ds_read_b64_tr_b16 v[228:229], v244 offset:15424
  ds_read_b64_tr_b16 v[230:231], v244 offset:16192
  s_waitcnt vmcnt(9)
  s_waitcnt lgkmcnt(6)
  v_mfma_f32_32x32x16_bf16 v[160:175], v[232:235], v[16:19], v[160:175]
  ds_read_b64_tr_b16 v[232:233], v244 offset:15488
  ds_read_b64_tr_b16 v[234:235], v244 offset:16256
  v_mfma_f32_32x32x16_bf16 v[176:191], v[236:239], v[16:19], v[176:191]
  buffer_load_dwordx4 v[56:59], v247, s[28:31], s72 offen offset:2048
  ds_read_b64_tr_b16 v[236:237], v244 offset:18432
  ds_read_b64_tr_b16 v[238:239], v244 offset:19200
  s_waitcnt lgkmcnt(6)
  v_mfma_f32_32x32x16_bf16 v[192:207], v[240:243], v[16:19], v[192:207]
  ds_read_b64_tr_b16 v[240:241], v244 offset:18496
  ds_read_b64_tr_b16 v[242:243], v244 offset:19264
  s_waitcnt vmcnt(9)
  v_mfma_f32_32x32x16_bf16 v[160:175], v[224:227], v[20:23], v[160:175]
  buffer_load_dwordx4 v[60:63], v247, s[28:31], s72 offen offset:3072
  ds_read_b64_tr_b16 v[224:225], v244 offset:18560
  ds_read_b64_tr_b16 v[226:227], v244 offset:19328
  s_waitcnt lgkmcnt(6)
  v_mfma_f32_32x32x16_bf16 v[176:191], v[228:231], v[20:23], v[176:191]
  ds_read_b64_tr_b16 v[228:229], v244 offset:21504
  ds_read_b64_tr_b16 v[230:231], v244 offset:22272
  v_mfma_f32_32x32x16_bf16 v[192:207], v[232:235], v[20:23], v[192:207]
  s_add_u32 s72, s72, 4096
  buffer_load_dwordx4 v[64:67], v247, s[28:31], s72 offen offset:0
  ds_read_b64_tr_b16 v[232:233], v244 offset:21568
  ds_read_b64_tr_b16 v[234:235], v244 offset:22336
  s_waitcnt vmcnt(10)
  s_waitcnt lgkmcnt(6)
  v_mfma_f32_32x32x16_bf16 v[160:175], v[236:239], v[24:27], v[160:175]
  ds_read_b64_tr_b16 v[236:237], v244 offset:21632
  ds_read_b64_tr_b16 v[238:239], v244 offset:22400
  v_mfma_f32_32x32x16_bf16 v[176:191], v[240:243], v[24:27], v[176:191]
  buffer_load_dwordx4 v[68:71], v247, s[28:31], s72 offen offset:1024
  s_barrier
  v_add_u32 v244, 24576, v255
  ds_read_b64_tr_b16 v[240:241], v244 offset:0
  ds_read_b64_tr_b16 v[242:243], v244 offset:768
  s_waitcnt lgkmcnt(6)
  v_mfma_f32_32x32x16_bf16 v[192:207], v[224:227], v[24:27], v[192:207]
  ds_read_b64_tr_b16 v[224:225], v244 offset:64
  ds_read_b64_tr_b16 v[226:227], v244 offset:832
  s_waitcnt vmcnt(10)
  v_mfma_f32_32x32x16_bf16 v[160:175], v[228:231], v[28:31], v[160:175]
  buffer_load_dwordx4 v[72:75], v247, s[28:31], s72 offen offset:2048
  ds_read_b64_tr_b16 v[228:229], v244 offset:128
  ds_read_b64_tr_b16 v[230:231], v244 offset:896
  s_waitcnt lgkmcnt(6)
  v_mfma_f32_32x32x16_bf16 v[176:191], v[232:235], v[28:31], v[176:191]
  ds_read_b64_tr_b16 v[232:233], v244 offset:3072
  ds_read_b64_tr_b16 v[234:235], v244 offset:3840
  v_mfma_f32_32x32x16_bf16 v[192:207], v[236:239], v[28:31], v[192:207]
  buffer_load_dwordx4 v[76:79], v247, s[28:31], s72 offen offset:3072
  ds_read_b64_tr_b16 v[236:237], v244 offset:3136
  ds_read_b64_tr_b16 v[238:239], v244 offset:3904
  s_waitcnt vmcnt(11)
  s_waitcnt lgkmcnt(6)
  v_mfma_f32_32x32x16_bf16 v[160:175], v[240:243], v[32:35], v[160:175]
  ds_read_b64_tr_b16 v[240:241], v244 offset:3200
  ds_read_b64_tr_b16 v[242:243], v244 offset:3968
  v_mfma_f32_32x32x16_bf16 v[176:191], v[224:227], v[32:35], v[176:191]
  s_add_u32 s72, s72, 4096
  buffer_load_dwordx4 v[80:83], v247, s[28:31], s72 offen offset:0
  ds_read_b64_tr_b16 v[224:225], v244 offset:6144
  ds_read_b64_tr_b16 v[226:227], v244 offset:6912
  s_waitcnt lgkmcnt(6)
  v_mfma_f32_32x32x16_bf16 v[192:207], v[228:231], v[32:35], v[192:207]
  ds_read_b64_tr_b16 v[228:229], v244 offset:6208
  ds_read_b64_tr_b16 v[230:231], v244 offset:6976
  s_waitcnt vmcnt(11)
  v_mfma_f32_32x32x16_bf16 v[160:175], v[232:235], v[36:39], v[160:175]
  buffer_load_dwordx4 v[84:87], v247, s[28:31], s72 offen offset:1024
  ds_read_b64_tr_b16 v[232:233], v244 offset:6272
  ds_read_b64_tr_b16 v[234:235], v244 offset:7040
  s_waitcnt lgkmcnt(6)
  v_mfma_f32_32x32x16_bf16 v[176:191], v[236:239], v[36:39], v[176:191]
  ds_read_b64_tr_b16 v[236:237], v244 offset:9216
  ds_read_b64_tr_b16 v[238:239], v244 offset:9984
  v_mfma_f32_32x32x16_bf16 v[192:207], v[240:243], v[36:39], v[192:207]
  buffer_load_dwordx4 v[88:91], v247, s[28:31], s72 offen offset:2048
  ds_read_b64_tr_b16 v[240:241], v244 offset:9280
  ds_read_b64_tr_b16 v[242:243], v244 offset:10048
  s_waitcnt vmcnt(12)
  s_waitcnt lgkmcnt(6)
  v_mfma_f32_32x32x16_bf16 v[160:175], v[224:227], v[40:43], v[160:175]
  ds_read_b64_tr_b16 v[224:225], v244 offset:9344
  ds_read_b64_tr_b16 v[226:227], v244 offset:10112
  v_mfma_f32_32x32x16_bf16 v[176:191], v[228:231], v[40:43], v[176:191]
  buffer_load_dwordx4 v[92:95], v247, s[28:31], s72 offen offset:3072
  ds_read_b64_tr_b16 v[228:229], v244 offset:12288
  ds_read_b64_tr_b16 v[230:231], v244 offset:13056
  s_waitcnt lgkmcnt(6)
  v_mfma_f32_32x32x16_bf16 v[192:207], v[232:235], v[40:43], v[192:207]
  ds_read_b64_tr_b16 v[232:233], v244 offset:12352
  ds_read_b64_tr_b16 v[234:235], v244 offset:13120
  s_waitcnt vmcnt(12)
  v_mfma_f32_32x32x16_bf16 v[160:175], v[236:239], v[44:47], v[160:175]
  s_add_u32 s72, s72, 4096
  buffer_load_dwordx4 v[96:99], v247, s[28:31], s72 offen offset:0
  ds_read_b64_tr_b16 v[236:237], v244 offset:12416
  ds_read_b64_tr_b16 v[238:239], v244 offset:13184
  s_waitcnt lgkmcnt(6)
  v_mfma_f32_32x32x16_bf16 v[176:191], v[240:243], v[44:47], v[176:191]
  ds_read_b64_tr_b16 v[240:241], v244 offset:15360
  ds_read_b64_tr_b16 v[242:243], v244 offset:16128
  v_mfma_f32_32x32x16_bf16 v[192:207], v[224:227], v[44:47], v[192:207]
  buffer_load_dwordx4 v[100:103], v247, s[28:31], s72 offen offset:1024
  ds_read_b64_tr_b16 v[224:225], v244 offset:15424
  ds_read_b64_tr_b16 v[226:227], v244 offset:16192
  s_waitcnt vmcnt(13)
  s_waitcnt lgkmcnt(6)
  v_mfma_f32_32x32x16_bf16 v[160:175], v[228:231], v[48:51], v[160:175]
  ds_read_b64_tr_b16 v[228:229], v244 offset:15488
  ds_read_b64_tr_b16 v[230:231], v244 offset:16256
  v_mfma_f32_32x32x16_bf16 v[176:191], v[232:235], v[48:51], v[176:191]
  buffer_load_dwordx4 v[104:107], v247, s[28:31], s72 offen offset:2048
  ds_read_b64_tr_b16 v[232:233], v244 offset:18432
  ds_read_b64_tr_b16 v[234:235], v244 offset:19200
  s_waitcnt lgkmcnt(6)
  v_mfma_f32_32x32x16_bf16 v[192:207], v[236:239], v[48:51], v[192:207]
  ds_read_b64_tr_b16 v[236:237], v244 offset:18496
  ds_read_b64_tr_b16 v[238:239], v244 offset:19264
  s_waitcnt vmcnt(13)
  v_mfma_f32_32x32x16_bf16 v[160:175], v[240:243], v[52:55], v[160:175]
  buffer_load_dwordx4 v[108:111], v247, s[28:31], s72 offen offset:3072
  ds_read_b64_tr_b16 v[240:241], v244 offset:18560
  ds_read_b64_tr_b16 v[242:243], v244 offset:19328
  s_waitcnt lgkmcnt(6)
  v_mfma_f32_32x32x16_bf16 v[176:191], v[224:227], v[52:55], v[176:191]
  ds_read_b64_tr_b16 v[224:225], v244 offset:21504
  ds_read_b64_tr_b16 v[226:227], v244 offset:22272
  v_mfma_f32_32x32x16_bf16 v[192:207], v[228:231], v[52:55], v[192:207]
  s_add_u32 s72, s72, 4096
  buffer_load_dwordx4 v[112:115], v247, s[28:31], s72 offen offset:0
  ds_read_b64_tr_b16 v[228:229], v244 offset:21568
  ds_read_b64_tr_b16 v[230:231], v244 offset:22336
  s_waitcnt vmcnt(14)
  s_waitcnt lgkmcnt(6)
  v_mfma_f32_32x32x16_bf16 v[160:175], v[232:235], v[56:59], v[160:175]
  ds_read_b64_tr_b16 v[232:233], v244 offset:21632
  ds_read_b64_tr_b16 v[234:235], v244 offset:22400
  v_mfma_f32_32x32x16_bf16 v[176:191], v[236:239], v[56:59], v[176:191]
  buffer_load_dwordx4 v[116:119], v247, s[28:31], s72 offen offset:1024
  s_barrier
  v_add_u32 v244, 49152, v255
  ds_read_b64_tr_b16 v[236:237], v244 offset:0
  ds_read_b64_tr_b16 v[238:239], v244 offset:768
  s_waitcnt lgkmcnt(6)
  v_mfma_f32_32x32x16_bf16 v[192:207], v[240:243], v[56:59], v[192:207]
  ds_read_b64_tr_b16 v[240:241], v244 offset:64
  ds_read_b64_tr_b16 v[242:243], v244 offset:832
  s_waitcnt vmcnt(14)
  v_mfma_f32_32x32x16_bf16 v[160:175], v[224:227], v[60:63], v[160:175]
  buffer_load_dwordx4 v[120:123], v247, s[28:31], s72 offen offset:2048
  ds_read_b64_tr_b16 v[224:225], v244 offset:128
  ds_read_b64_tr_b16 v[226:227], v244 offset:896
  s_waitcnt lgkmcnt(6)
  v_mfma_f32_32x32x16_bf16 v[176:191], v[228:231], v[60:63], v[176:191]
  ds_read_b64_tr_b16 v[228:229], v244 offset:3072
  ds_read_b64_tr_b16 v[230:231], v244 offset:3840
  v_mfma_f32_32x32x16_bf16 v[192:207], v[232:235], v[60:63], v[192:207]
  buffer_load_dwordx4 v[124:127], v247, s[28:31], s72 offen offset:3072
  ds_read_b64_tr_b16 v[232:233], v244 offset:3136
  ds_read_b64_tr_b16 v[234:235], v244 offset:3904
  s_waitcnt vmcnt(15)
  s_waitcnt lgkmcnt(6)
  v_mfma_f32_32x32x16_bf16 v[160:175], v[236:239], v[64:67], v[160:175]
  ds_read_b64_tr_b16 v[236:237], v244 offset:3200
  ds_read_b64_tr_b16 v[238:239], v244 offset:3968
  v_mfma_f32_32x32x16_bf16 v[176:191], v[240:243], v[64:67], v[176:191]
  s_add_u32 s72, s72, 4096
  buffer_load_dwordx4 v[128:131], v247, s[28:31], s72 offen offset:0
  ds_read_b64_tr_b16 v[240:241], v244 offset:6144
  ds_read_b64_tr_b16 v[242:243], v244 offset:6912
  s_waitcnt lgkmcnt(6)
  v_mfma_f32_32x32x16_bf16 v[192:207], v[224:227], v[64:67], v[192:207]
  ds_read_b64_tr_b16 v[224:225], v244 offset:6208
  ds_read_b64_tr_b16 v[226:227], v244 offset:6976
  s_waitcnt vmcnt(15)
  v_mfma_f32_32x32x16_bf16 v[160:175], v[228:231], v[68:71], v[160:175]
  buffer_load_dwordx4 v[132:135], v247, s[28:31], s72 offen offset:1024
  ds_read_b64_tr_b16 v[228:229], v244 offset:6272
  ds_read_b64_tr_b16 v[230:231], v244 offset:7040
  s_waitcnt lgkmcnt(6)
  v_mfma_f32_32x32x16_bf16 v[176:191], v[232:235], v[68:71], v[176:191]
  ds_read_b64_tr_b16 v[232:233], v244 offset:9216
  ds_read_b64_tr_b16 v[234:235], v244 offset:9984
  v_mfma_f32_32x32x16_bf16 v[192:207], v[236:239], v[68:71], v[192:207]
  buffer_load_dwordx4 v[136:139], v247, s[28:31], s72 offen offset:2048
  ds_read_b64_tr_b16 v[236:237], v244 offset:9280
  ds_read_b64_tr_b16 v[238:239], v244 offset:10048
  s_waitcnt vmcnt(16)
  s_waitcnt lgkmcnt(6)
  v_mfma_f32_32x32x16_bf16 v[160:175], v[240:243], v[72:75], v[160:175]
  ds_read_b64_tr_b16 v[240:241], v244 offset:9344
  ds_read_b64_tr_b16 v[242:243], v244 offset:10112
  v_mfma_f32_32x32x16_bf16 v[176:191], v[224:227], v[72:75], v[176:191]
  buffer_load_dwordx4 v[140:143], v247, s[28:31], s72 offen offset:3072
  ds_read_b64_tr_b16 v[224:225], v244 offset:12288
  ds_read_b64_tr_b16 v[226:227], v244 offset:13056
  s_waitcnt lgkmcnt(6)
  v_mfma_f32_32x32x16_bf16 v[192:207], v[228:231], v[72:75], v[192:207]
  ds_read_b64_tr_b16 v[228:229], v244 offset:12352
  ds_read_b64_tr_b16 v[230:231], v244 offset:13120
  s_waitcnt vmcnt(16)
  v_mfma_f32_32x32x16_bf16 v[160:175], v[232:235], v[76:79], v[160:175]
  s_add_u32 s72, s72, 4096
  buffer_load_dwordx4 v[144:147], v247, s[28:31], s72 offen offset:0
  ds_read_b64_tr_b16 v[232:233], v244 offset:12416
  ds_read_b64_tr_b16 v[234:235], v244 offset:13184
  s_waitcnt lgkmcnt(6)
  v_mfma_f32_32x32x16_bf16 v[176:191], v[236:239], v[76:79], v[176:191]
  ds_read_b64_tr_b16 v[236:237], v244 offset:15360
  ds_read_b64_tr_b16 v[238:239], v244 offset:16128
  v_mfma_f32_32x32x16_bf16 v[192:207], v[240:243], v[76:79], v[192:207]
  buffer_load_dwordx4 v[148:151], v247, s[28:31], s72 offen offset:1024
  ds_read_b64_tr_b16 v[240:241], v244 offset:15424
  ds_read_b64_tr_b16 v[242:243], v244 offset:16192
  s_waitcnt vmcnt(17)
  s_waitcnt lgkmcnt(6)
  v_mfma_f32_32x32x16_bf16 v[160:175], v[224:227], v[80:83], v[160:175]
  ds_read_b64_tr_b16 v[224:225], v244 offset:15488
  ds_read_b64_tr_b16 v[226:227], v244 offset:16256
  v_mfma_f32_32x32x16_bf16 v[176:191], v[228:231], v[80:83], v[176:191]
  buffer_load_dwordx4 v[152:155], v247, s[28:31], s72 offen offset:2048
  ds_read_b64_tr_b16 v[228:229], v244 offset:18432
  ds_read_b64_tr_b16 v[230:231], v244 offset:19200
  s_waitcnt lgkmcnt(6)
  v_mfma_f32_32x32x16_bf16 v[192:207], v[232:235], v[80:83], v[192:207]
  ds_read_b64_tr_b16 v[232:233], v244 offset:18496
  ds_read_b64_tr_b16 v[234:235], v244 offset:19264
  s_waitcnt vmcnt(17)
  v_mfma_f32_32x32x16_bf16 v[160:175], v[236:239], v[84:87], v[160:175]
  buffer_load_dwordx4 v[156:159], v247, s[28:31], s72 offen offset:3072
  ds_read_b64_tr_b16 v[236:237], v244 offset:18560
  ds_read_b64_tr_b16 v[238:239], v244 offset:19328
  s_waitcnt lgkmcnt(6)
  v_mfma_f32_32x32x16_bf16 v[176:191], v[240:243], v[84:87], v[176:191]
  ds_read_b64_tr_b16 v[240:241], v244 offset:21504
  ds_read_b64_tr_b16 v[242:243], v244 offset:22272
  v_mfma_f32_32x32x16_bf16 v[192:207], v[224:227], v[84:87], v[192:207]
  ds_read_b64_tr_b16 v[224:225], v244 offset:21568
  ds_read_b64_tr_b16 v[226:227], v244 offset:22336
  s_waitcnt vmcnt(17)
  s_waitcnt lgkmcnt(6)
  v_mfma_f32_32x32x16_bf16 v[160:175], v[228:231], v[88:91], v[160:175]
  ds_read_b64_tr_b16 v[228:229], v244 offset:21632
  ds_read_b64_tr_b16 v[230:231], v244 offset:22400
  v_mfma_f32_32x32x16_bf16 v[176:191], v[232:235], v[88:91], v[176:191]
  s_barrier
  v_add_u32 v244, 73728, v255
  ds_read_b64_tr_b16 v[232:233], v244 offset:0
  ds_read_b64_tr_b16 v[234:235], v244 offset:768
  s_waitcnt lgkmcnt(6)
  v_mfma_f32_32x32x16_bf16 v[192:207], v[236:239], v[88:91], v[192:207]
  ds_read_b64_tr_b16 v[236:237], v244 offset:64
  ds_read_b64_tr_b16 v[238:239], v244 offset:832
  s_waitcnt vmcnt(16)
  v_mfma_f32_32x32x16_bf16 v[160:175], v[240:243], v[92:95], v[160:175]
  ds_read_b64_tr_b16 v[240:241], v244 offset:128
  ds_read_b64_tr_b16 v[242:243], v244 offset:896
  s_waitcnt lgkmcnt(6)
  v_mfma_f32_32x32x16_bf16 v[176:191], v[224:227], v[92:95], v[176:191]
  ds_read_b64_tr_b16 v[224:225], v244 offset:3072
  ds_read_b64_tr_b16 v[226:227], v244 offset:3840
  v_mfma_f32_32x32x16_bf16 v[192:207], v[228:231], v[92:95], v[192:207]
  ds_read_b64_tr_b16 v[228:229], v244 offset:3136
  ds_read_b64_tr_b16 v[230:231], v244 offset:3904
  s_waitcnt vmcnt(15)
  s_waitcnt lgkmcnt(6)
  v_mfma_f32_32x32x16_bf16 v[160:175], v[232:235], v[96:99], v[160:175]
  ds_read_b64_tr_b16 v[232:233], v244 offset:3200
  ds_read_b64_tr_b16 v[234:235], v244 offset:3968
  v_mfma_f32_32x32x16_bf16 v[176:191], v[236:239], v[96:99], v[176:191]
  ds_read_b64_tr_b16 v[236:237], v244 offset:6144
  ds_read_b64_tr_b16 v[238:239], v244 offset:6912
  s_waitcnt lgkmcnt(6)
  v_mfma_f32_32x32x16_bf16 v[192:207], v[240:243], v[96:99], v[192:207]
  ds_read_b64_tr_b16 v[240:241], v244 offset:6208
  ds_read_b64_tr_b16 v[242:243], v244 offset:6976
  s_waitcnt vmcnt(14)
  v_mfma_f32_32x32x16_bf16 v[160:175], v[224:227], v[100:103], v[160:175]
  ds_read_b64_tr_b16 v[224:225], v244 offset:6272
  ds_read_b64_tr_b16 v[226:227], v244 offset:7040
  s_waitcnt lgkmcnt(6)
  v_mfma_f32_32x32x16_bf16 v[176:191], v[228:231], v[100:103], v[176:191]
  ds_read_b64_tr_b16 v[228:229], v244 offset:9216
  ds_read_b64_tr_b16 v[230:231], v244 offset:9984
  v_mfma_f32_32x32x16_bf16 v[192:207], v[232:235], v[100:103], v[192:207]
  ds_read_b64_tr_b16 v[232:233], v244 offset:9280
  ds_read_b64_tr_b16 v[234:235], v244 offset:10048
  s_waitcnt vmcnt(13)
  s_waitcnt lgkmcnt(6)
  v_mfma_f32_32x32x16_bf16 v[160:175], v[236:239], v[104:107], v[160:175]
  ds_read_b64_tr_b16 v[236:237], v244 offset:9344
  ds_read_b64_tr_b16 v[238:239], v244 offset:10112
  v_mfma_f32_32x32x16_bf16 v[176:191], v[240:243], v[104:107], v[176:191]
  ds_read_b64_tr_b16 v[240:241], v244 offset:12288
  ds_read_b64_tr_b16 v[242:243], v244 offset:13056
  s_waitcnt lgkmcnt(6)
  v_mfma_f32_32x32x16_bf16 v[192:207], v[224:227], v[104:107], v[192:207]
  ds_read_b64_tr_b16 v[224:225], v244 offset:12352
  ds_read_b64_tr_b16 v[226:227], v244 offset:13120
  s_waitcnt vmcnt(12)
  v_mfma_f32_32x32x16_bf16 v[160:175], v[228:231], v[108:111], v[160:175]
  ds_read_b64_tr_b16 v[228:229], v244 offset:12416
  ds_read_b64_tr_b16 v[230:231], v244 offset:13184
  s_waitcnt lgkmcnt(6)
  v_mfma_f32_32x32x16_bf16 v[176:191], v[232:235], v[108:111], v[176:191]
  ds_read_b64_tr_b16 v[232:233], v244 offset:15360
  ds_read_b64_tr_b16 v[234:235], v244 offset:16128
  v_mfma_f32_32x32x16_bf16 v[192:207], v[236:239], v[108:111], v[192:207]
  ds_read_b64_tr_b16 v[236:237], v244 offset:15424
  ds_read_b64_tr_b16 v[238:239], v244 offset:16192
  s_waitcnt vmcnt(11)
  s_waitcnt lgkmcnt(6)
  v_mfma_f32_32x32x16_bf16 v[160:175], v[240:243], v[112:115], v[160:175]
  ds_read_b64_tr_b16 v[240:241], v244 offset:15488
  ds_read_b64_tr_b16 v[242:243], v244 offset:16256
  v_mfma_f32_32x32x16_bf16 v[176:191], v[224:227], v[112:115], v[176:191]
  ds_read_b64_tr_b16 v[224:225], v244 offset:18432
  ds_read_b64_tr_b16 v[226:227], v244 offset:19200
  s_waitcnt lgkmcnt(6)
  v_mfma_f32_32x32x16_bf16 v[192:207], v[228:231], v[112:115], v[192:207]
  ds_read_b64_tr_b16 v[228:229], v244 offset:18496
  ds_read_b64_tr_b16 v[230:231], v244 offset:19264
  s_waitcnt vmcnt(10)
  v_mfma_f32_32x32x16_bf16 v[160:175], v[232:235], v[116:119], v[160:175]
  ds_read_b64_tr_b16 v[232:233], v244 offset:18560
  ds_read_b64_tr_b16 v[234:235], v244 offset:19328
  s_waitcnt lgkmcnt(6)
  v_mfma_f32_32x32x16_bf16 v[176:191], v[236:239], v[116:119], v[176:191]
  ds_read_b64_tr_b16 v[236:237], v244 offset:21504
  ds_read_b64_tr_b16 v[238:239], v244 offset:22272
  v_mfma_f32_32x32x16_bf16 v[192:207], v[240:243], v[116:119], v[192:207]
  ds_read_b64_tr_b16 v[240:241], v244 offset:21568
  ds_read_b64_tr_b16 v[242:243], v244 offset:22336
  s_waitcnt vmcnt(9)
  s_waitcnt lgkmcnt(6)
  v_mfma_f32_32x32x16_bf16 v[160:175], v[224:227], v[120:123], v[160:175]
  ds_read_b64_tr_b16 v[224:225], v244 offset:21632
  ds_read_b64_tr_b16 v[226:227], v244 offset:22400
  v_mfma_f32_32x32x16_bf16 v[176:191], v[228:231], v[120:123], v[176:191]
  s_barrier
  v_add_u32 v244, 0, v255
  ds_read_b64_tr_b16 v[228:229], v244 offset:0
  ds_read_b64_tr_b16 v[230:231], v244 offset:768
  s_waitcnt lgkmcnt(6)
  v_mfma_f32_32x32x16_bf16 v[192:207], v[232:235], v[120:123], v[192:207]
  ds_read_b64_tr_b16 v[232:233], v244 offset:64
  ds_read_b64_tr_b16 v[234:235], v244 offset:832
  s_waitcnt vmcnt(8)
  v_mfma_f32_32x32x16_bf16 v[160:175], v[236:239], v[124:127], v[160:175]
  ds_read_b64_tr_b16 v[236:237], v244 offset:128
  ds_read_b64_tr_b16 v[238:239], v244 offset:896
  s_waitcnt lgkmcnt(6)
  v_mfma_f32_32x32x16_bf16 v[176:191], v[240:243], v[124:127], v[176:191]
  ds_read_b64_tr_b16 v[240:241], v244 offset:3072
  ds_read_b64_tr_b16 v[242:243], v244 offset:3840
  v_mfma_f32_32x32x16_bf16 v[192:207], v[224:227], v[124:127], v[192:207]
  ds_read_b64_tr_b16 v[224:225], v244 offset:3136
  ds_read_b64_tr_b16 v[226:227], v244 offset:3904
  s_waitcnt vmcnt(7)
  s_waitcnt lgkmcnt(6)
  v_mfma_f32_32x32x16_bf16 v[160:175], v[228:231], v[128:131], v[160:175]
  ds_read_b64_tr_b16 v[228:229], v244 offset:3200
  ds_read_b64_tr_b16 v[230:231], v244 offset:3968
  v_mfma_f32_32x32x16_bf16 v[176:191], v[232:235], v[128:131], v[176:191]
  ds_read_b64_tr_b16 v[232:233], v244 offset:6144
  ds_read_b64_tr_b16 v[234:235], v244 offset:6912
  s_waitcnt lgkmcnt(6)
  v_mfma_f32_32x32x16_bf16 v[192:207], v[236:239], v[128:131], v[192:207]
  ds_read_b64_tr_b16 v[236:237], v244 offset:6208
  ds_read_b64_tr_b16 v[238:239], v244 offset:6976
  s_waitcnt vmcnt(6)
  v_mfma_f32_32x32x16_bf16 v[160:175], v[240:243], v[132:135], v[160:175]
  ds_read_b64_tr_b16 v[240:241], v244 offset:6272
  ds_read_b64_tr_b16 v[242:243], v244 offset:7040
  s_waitcnt lgkmcnt(6)
  v_mfma_f32_32x32x16_bf16 v[176:191], v[224:227], v[132:135], v[176:191]
  ds_read_b64_tr_b16 v[224:225], v244 offset:9216
  ds_read_b64_tr_b16 v[226:227], v244 offset:9984
  v_mfma_f32_32x32x16_bf16 v[192:207], v[228:231], v[132:135], v[192:207]
  ds_read_b64_tr_b16 v[228:229], v244 offset:9280
  ds_read_b64_tr_b16 v[230:231], v244 offset:10048
  s_waitcnt vmcnt(5)
  s_waitcnt lgkmcnt(6)
  v_mfma_f32_32x32x16_bf16 v[160:175], v[232:235], v[136:139], v[160:175]
  ds_read_b64_tr_b16 v[232:233], v244 offset:9344
  ds_read_b64_tr_b16 v[234:235], v244 offset:10112
  v_mfma_f32_32x32x16_bf16 v[176:191], v[236:239], v[136:139], v[176:191]
  ds_read_b64_tr_b16 v[236:237], v244 offset:12288
  ds_read_b64_tr_b16 v[238:239], v244 offset:13056
  s_waitcnt lgkmcnt(6)
  v_mfma_f32_32x32x16_bf16 v[192:207], v[240:243], v[136:139], v[192:207]
  ds_read_b64_tr_b16 v[240:241], v244 offset:12352
  ds_read_b64_tr_b16 v[242:243], v244 offset:13120
  s_waitcnt vmcnt(4)
  v_mfma_f32_32x32x16_bf16 v[160:175], v[224:227], v[140:143], v[160:175]
  ds_read_b64_tr_b16 v[224:225], v244 offset:12416
  ds_read_b64_tr_b16 v[226:227], v244 offset:13184
  s_waitcnt lgkmcnt(6)
  v_mfma_f32_32x32x16_bf16 v[176:191], v[228:231], v[140:143], v[176:191]
  ds_read_b64_tr_b16 v[228:229], v244 offset:15360
  ds_read_b64_tr_b16 v[230:231], v244 offset:16128
  v_mfma_f32_32x32x16_bf16 v[192:207], v[232:235], v[140:143], v[192:207]
  ds_read_b64_tr_b16 v[232:233], v244 offset:15424
  ds_read_b64_tr_b16 v[234:235], v244 offset:16192
  s_waitcnt vmcnt(3)
  s_waitcnt lgkmcnt(6)
  v_mfma_f32_32x32x16_bf16 v[160:175], v[236:239], v[144:147], v[160:175]
  ds_read_b64_tr_b16 v[236:237], v244 offset:15488
  ds_read_b64_tr_b16 v[238:239], v244 offset:16256
  v_mfma_f32_32x32x16_bf16 v[176:191], v[240:243], v[144:147], v[176:191]
  ds_read_b64_tr_b16 v[240:241], v244 offset:18432
  ds_read_b64_tr_b16 v[242:243], v244 offset:19200
  s_waitcnt lgkmcnt(6)
  v_mfma_f32_32x32x16_bf16 v[192:207], v[224:227], v[144:147], v[192:207]
  ds_read_b64_tr_b16 v[224:225], v244 offset:18496
  ds_read_b64_tr_b16 v[226:227], v244 offset:19264
  s_waitcnt vmcnt(2)
  v_mfma_f32_32x32x16_bf16 v[160:175], v[228:231], v[148:151], v[160:175]
  ds_read_b64_tr_b16 v[228:229], v244 offset:18560
  ds_read_b64_tr_b16 v[230:231], v244 offset:19328
  s_waitcnt lgkmcnt(6)
  v_mfma_f32_32x32x16_bf16 v[176:191], v[232:235], v[148:151], v[176:191]
  ds_read_b64_tr_b16 v[232:233], v244 offset:21504
  ds_read_b64_tr_b16 v[234:235], v244 offset:22272
  v_mfma_f32_32x32x16_bf16 v[192:207], v[236:239], v[148:151], v[192:207]
  ds_read_b64_tr_b16 v[236:237], v244 offset:21568
  ds_read_b64_tr_b16 v[238:239], v244 offset:22336
  s_waitcnt vmcnt(1)
  s_waitcnt lgkmcnt(6)
  v_mfma_f32_32x32x16_bf16 v[160:175], v[240:243], v[152:155], v[160:175]
  ds_read_b64_tr_b16 v[240:241], v244 offset:21632
  ds_read_b64_tr_b16 v[242:243], v244 offset:22400
  v_mfma_f32_32x32x16_bf16 v[176:191], v[224:227], v[152:155], v[176:191]
  s_barrier
  v_add_u32 v244, 24576, v246
  v_xor_b32 v245, 64, v244
  ds_read_b64_tr_b16 v[224:225], v244 offset:0
  ds_read_b64_tr_b16 v[226:227], v244 offset:512
  s_waitcnt lgkmcnt(6)
  v_mfma_f32_32x32x16_bf16 v[192:207], v[228:231], v[152:155], v[192:207]
  ds_read_b64_tr_b16 v[228:229], v244 offset:2048
  ds_read_b64_tr_b16 v[230:231], v244 offset:2560
  s_waitcnt vmcnt(0)
  v_mfma_f32_32x32x16_bf16 v[160:175], v[232:235], v[156:159], v[160:175]
  ds_read_b64_tr_b16 v[232:233], v244 offset:4096
  ds_read_b64_tr_b16 v[234:235], v244 offset:4608
  s_waitcnt lgkmcnt(6)
  v_mfma_f32_32x32x16_bf16 v[176:191], v[236:239], v[156:159], v[176:191]
  ds_read_b64_tr_b16 v[236:237], v244 offset:6144
  ds_read_b64_tr_b16 v[238:239], v244 offset:6656
  v_mfma_f32_32x32x16_bf16 v[192:207], v[240:243], v[156:159], v[192:207]
  ds_read_b64_tr_b16 v[240:241], v244 offset:8192
  ds_read_b64_tr_b16 v[242:243], v244 offset:8704
  s_waitcnt lgkmcnt(6)
  v_mfma_f32_32x32x16_bf16 v[208:223], v[224:227], v[0:3], 0
  ds_read_b64_tr_b16 v[224:225], v244 offset:10240
  ds_read_b64_tr_b16 v[226:227], v244 offset:10752
  v_mfma_f32_32x32x16_bf16 v[208:223], v[228:231], v[4:7], v[208:223]
  ds_read_b64_tr_b16 v[228:229], v244 offset:12288
  ds_read_b64_tr_b16 v[230:231], v244 offset:12800
  s_waitcnt lgkmcnt(6)
  v_mfma_f32_32x32x16_bf16 v[208:223], v[232:235], v[8:11], v[208:223]
  v_mul_f32 v248, s98, v192
  v_mul_f32 v249, s98, v193
  v_mul_f32 v250, s98, v194
  v_mul_f32 v251, s98, v195
  v_exp_f32_e64 v248, v248 clamp
  v_exp_f32_e64 v249, v249 clamp
  v_exp_f32_e64 v250, v250 clamp
  v_exp_f32_e64 v251, v251 clamp
  v_add_f32 v248, s99, v248
  v_add_f32 v249, s99, v249
  v_add_f32 v250, s99, v250
  v_add_f32 v251, s99, v251
  v_add_f32 v192, v192, v248
  v_add_f32 v193, v193, v249
  v_add_f32 v194, v194, v250
  v_add_f32 v195, v195, v251
  v_max_f32 v192, v192, v248
  v_max_f32 v193, v193, v249
  v_max_f32 v194, v194, v250
  v_max_f32 v195, v195, v251
  v_mul_f32 v248, s98, v196
  v_mul_f32 v249, s98, v197
  v_mul_f32 v250, s98, v198
  v_mul_f32 v251, s98, v199
  v_exp_f32_e64 v248, v248 clamp
  v_exp_f32_e64 v249, v249 clamp
  v_exp_f32_e64 v250, v250 clamp
  v_exp_f32_e64 v251, v251 clamp
  v_add_f32 v248, s99, v248
  v_add_f32 v249, s99, v249
  v_add_f32 v250, s99, v250
  v_add_f32 v251, s99, v251
  v_add_f32 v196, v196, v248
  v_add_f32 v197, v197, v249
  v_add_f32 v198, v198, v250
  v_add_f32 v199, v199, v251
  v_max_f32 v196, v196, v248
  v_max_f32 v197, v197, v249
  v_max_f32 v198, v198, v250
  ds_read_b64_tr_b16 v[232:233], v244 offset:14336
  ds_read_b64_tr_b16 v[234:235], v244 offset:14848
  v_mfma_f32_32x32x16_bf16 v[208:223], v[236:239], v[12:15], v[208:223]
  v_max_f32 v199, v199, v251
  v_cvt_pk_bf16_f32 v192, v192, v193
  v_cvt_pk_bf16_f32 v193, v194, v195
  ds_read_b64_tr_b16 v[236:237], v245 offset:0
  ds_read_b64_tr_b16 v[238:239], v245 offset:512
  s_waitcnt lgkmcnt(6)
  v_mfma_f32_32x32x16_bf16 v[208:223], v[240:243], v[16:19], v[208:223]
  v_cvt_pk_bf16_f32 v194, v196, v197
  v_cvt_pk_bf16_f32 v195, v198, v199
  s_lshl_b32 s81, s25, 2
  s_add_u32 s81, s81, s24
  s_lshl_b32 s81, s81, 3
  s_add_u32 s81, s81, s26
  s_mul_i32 s81, s81, 5120
  s_add_u32 s81, s81, 4096
  buffer_store_dwordx4 v[192:195], v247, s[44:47], s81 offen offset:0 sc0 sc1
  ds_read_b64_tr_b16 v[240:241], v245 offset:2048
  ds_read_b64_tr_b16 v[242:243], v245 offset:2560
  v_mfma_f32_32x32x16_bf16 v[208:223], v[224:227], v[20:23], v[208:223]
  ds_read_b64_tr_b16 v[224:225], v245 offset:4096
  ds_read_b64_tr_b16 v[226:227], v245 offset:4608
  s_waitcnt lgkmcnt(6)
  v_mfma_f32_32x32x16_bf16 v[208:223], v[228:231], v[24:27], v[208:223]
  ds_read_b64_tr_b16 v[228:229], v245 offset:6144
  ds_read_b64_tr_b16 v[230:231], v245 offset:6656
  v_mfma_f32_32x32x16_bf16 v[208:223], v[232:235], v[28:31], v[208:223]
  ds_read_b64_tr_b16 v[232:233], v245 offset:8192
  ds_read_b64_tr_b16 v[234:235], v245 offset:8704
  s_waitcnt lgkmcnt(6)
  v_mfma_f32_32x32x16_bf16 v[192:207], v[236:239], v[0:3], 0
  v_mul_f32 v248, s98, v160
  v_mul_f32 v249, s98, v161
  v_mul_f32 v250, s98, v162
  ds_read_b64_tr_b16 v[236:237], v245 offset:10240
  ds_read_b64_tr_b16 v[238:239], v245 offset:10752
  v_mfma_f32_32x32x16_bf16 v[192:207], v[240:243], v[4:7], v[192:207]
  v_mul_f32 v251, s98, v163
  v_exp_f32_e64 v248, v248 clamp
  ds_read_b64_tr_b16 v[240:241], v245 offset:12288
  ds_read_b64_tr_b16 v[242:243], v245 offset:12800
  s_waitcnt lgkmcnt(6)
  v_mfma_f32_32x32x16_bf16 v[192:207], v[224:227], v[8:11], v[192:207]
  v_exp_f32_e64 v249, v249 clamp
  ds_read_b64_tr_b16 v[224:225], v245 offset:14336
  ds_read_b64_tr_b16 v[226:227], v245 offset:14848
  v_mfma_f32_32x32x16_bf16 v[192:207], v[228:231], v[12:15], v[192:207]
  v_exp_f32_e64 v250, v250 clamp
  s_barrier
  v_add_u32 v244, 40960, v246
  v_xor_b32 v245, 64, v244
  ds_read_b64_tr_b16 v[228:229], v244 offset:0
  ds_read_b64_tr_b16 v[230:231], v244 offset:512
  s_waitcnt lgkmcnt(6)
  v_mfma_f32_32x32x16_bf16 v[192:207], v[232:235], v[16:19], v[192:207]
  v_exp_f32_e64 v251, v251 clamp
  v_add_f32 v248, s99, v248
  ds_read_b64_tr_b16 v[232:233], v245 offset:0
  ds_read_b64_tr_b16 v[234:235], v245 offset:512
  v_mfma_f32_32x32x16_bf16 v[192:207], v[236:239], v[20:23], v[192:207]
  v_add_f32 v249, s99, v249
  v_add_f32 v250, s99, v250
  v_add_f32 v251, s99, v251
  ds_read_b64_tr_b16 v[236:237], v244 offset:2048
  ds_read_b64_tr_b16 v[238:239], v244 offset:2560
  s_waitcnt lgkmcnt(6)
  v_mfma_f32_32x32x16_bf16 v[192:207], v[240:243], v[24:27], v[192:207]
  v_add_f32 v160, v160, v248
  v_add_f32 v161, v161, v249
  v_add_f32 v162, v162, v250
  ds_read_b64_tr_b16 v[240:241], v245 offset:2048
  ds_read_b64_tr_b16 v[242:243], v245 offset:2560
  v_mfma_f32_32x32x16_bf16 v[192:207], v[224:227], v[28:31], v[192:207]
  v_add_f32 v163, v163, v251
  v_max_f32 v160, v160, v248
  v_max_f32 v161, v161, v249
  ds_read_b64_tr_b16 v[224:225], v244 offset:4096
  ds_read_b64_tr_b16 v[226:227], v244 offset:4608
  s_waitcnt lgkmcnt(6)
  v_mfma_f32_32x32x16_bf16 v[208:223], v[228:231], v[32:35], v[208:223]
  v_max_f32 v162, v162, v250
  v_max_f32 v163, v163, v251
  v_mul_f32 v248, s98, v164
  ds_read_b64_tr_b16 v[228:229], v245 offset:4096
  ds_read_b64_tr_b16 v[230:231], v245 offset:4608
  v_mfma_f32_32x32x16_bf16 v[192:207], v[232:235], v[32:35], v[192:207]
  v_mul_f32 v249, s98, v165
  v_mul_f32 v250, s98, v166
  v_mul_f32 v251, s98, v167
  ds_read_b64_tr_b16 v[232:233], v244 offset:6144
  ds_read_b64_tr_b16 v[234:235], v244 offset:6656
  s_waitcnt lgkmcnt(6)
  v_mfma_f32_32x32x16_bf16 v[208:223], v[236:239], v[36:39], v[208:223]
  v_exp_f32_e64 v248, v248 clamp
  ds_read_b64_tr_b16 v[236:237], v245 offset:6144
  ds_read_b64_tr_b16 v[238:239], v245 offset:6656
  v_mfma_f32_32x32x16_bf16 v[192:207], v[240:243], v[36:39], v[192:207]
  v_exp_f32_e64 v249, v249 clamp
  ds_read_b64_tr_b16 v[240:241], v244 offset:8192
  ds_read_b64_tr_b16 v[242:243], v244 offset:8704
  s_waitcnt lgkmcnt(6)
  v_mfma_f32_32x32x16_bf16 v[208:223], v[224:227], v[40:43], v[208:223]
  v_exp_f32_e64 v250, v250 clamp
  v_exp_f32_e64 v251, v251 clamp
  v_add_f32 v248, s99, v248
  ds_read_b64_tr_b16 v[224:225], v245 offset:8192
  ds_read_b64_tr_b16 v[226:227], v245 offset:8704
  v_mfma_f32_32x32x16_bf16 v[192:207], v[228:231], v[40:43], v[192:207]
  v_add_f32 v249, s99, v249
  v_add_f32 v250, s99, v250
  v_add_f32 v251, s99, v251
  ds_read_b64_tr_b16 v[228:229], v244 offset:10240
  ds_read_b64_tr_b16 v[230:231], v244 offset:10752
  s_waitcnt lgkmcnt(6)
  v_mfma_f32_32x32x16_bf16 v[208:223], v[232:235], v[44:47], v[208:223]
  v_add_f32 v164, v164, v248
  v_add_f32 v165, v165, v249
  v_add_f32 v166, v166, v250
  ds_read_b64_tr_b16 v[232:233], v245 offset:10240
  ds_read_b64_tr_b16 v[234:235], v245 offset:10752
  v_mfma_f32_32x32x16_bf16 v[192:207], v[236:239], v[44:47], v[192:207]
  v_add_f32 v167, v167, v251
  v_max_f32 v164, v164, v248
  v_max_f32 v165, v165, v249
  ds_read_b64_tr_b16 v[236:237], v244 offset:12288
  ds_read_b64_tr_b16 v[238:239], v244 offset:12800
  s_waitcnt lgkmcnt(6)
  v_mfma_f32_32x32x16_bf16 v[208:223], v[240:243], v[48:51], v[208:223]
  v_max_f32 v166, v166, v250
  v_max_f32 v167, v167, v251
  v_mul_f32 v248, s98, v168
  ds_read_b64_tr_b16 v[240:241], v245 offset:12288
  ds_read_b64_tr_b16 v[242:243], v245 offset:12800
  v_mfma_f32_32x32x16_bf16 v[192:207], v[224:227], v[48:51], v[192:207]
  v_mul_f32 v249, s98, v169
  v_mul_f32 v250, s98, v170
  v_mul_f32 v251, s98, v171
  ds_read_b64_tr_b16 v[224:225], v244 offset:14336
  ds_read_b64_tr_b16 v[226:227], v244 offset:14848
  s_waitcnt lgkmcnt(6)
  v_mfma_f32_32x32x16_bf16 v[208:223], v[228:231], v[52:55], v[208:223]
  v_exp_f32_e64 v248, v248 clamp
  v_exp_f32_e64 v249, v249 clamp
  v_exp_f32_e64 v250, v250 clamp
  ds_read_b64_tr_b16 v[228:229], v245 offset:14336
  ds_read_b64_tr_b16 v[230:231], v245 offset:14848
  v_mfma_f32_32x32x16_bf16 v[192:207], v[232:235], v[52:55], v[192:207]
  v_exp_f32_e64 v251, v251 clamp
  v_add_f32 v248, s99, v248
  v_add_f32 v249, s99, v249
  s_barrier
  v_add_u32 v244, 57344, v246
  v_xor_b32 v245, 64, v244
  ds_read_b64_tr_b16 v[232:233], v244 offset:0
  ds_read_b64_tr_b16 v[234:235], v244 offset:512
  s_waitcnt lgkmcnt(6)
  v_mfma_f32_32x32x16_bf16 v[208:223], v[236:239], v[56:59], v[208:223]
  v_add_f32 v250, s99, v250
  v_add_f32 v251, s99, v251
  v_add_f32 v168, v168, v248
  ds_read_b64_tr_b16 v[236:237], v245 offset:0
  ds_read_b64_tr_b16 v[238:239], v245 offset:512
  v_mfma_f32_32x32x16_bf16 v[192:207], v[240:243], v[56:59], v[192:207]
  v_add_f32 v169, v169, v249
  v_add_f32 v170, v170, v250
  v_add_f32 v171, v171, v251
  ds_read_b64_tr_b16 v[240:241], v244 offset:2048
  ds_read_b64_tr_b16 v[242:243], v244 offset:2560
  s_waitcnt lgkmcnt(6)
  v_mfma_f32_32x32x16_bf16 v[208:223], v[224:227], v[60:63], v[208:223]
  v_max_f32 v168, v168, v248
  v_max_f32 v169, v169, v249
  v_max_f32 v170, v170, v250
  ds_read_b64_tr_b16 v[224:225], v245 offset:2048
  ds_read_b64_tr_b16 v[226:227], v245 offset:2560
  v_mfma_f32_32x32x16_bf16 v[192:207], v[228:231], v[60:63], v[192:207]
  v_max_f32 v171, v171, v251
  v_mul_f32 v248, s98, v172
  v_mul_f32 v249, s98, v173
  ds_read_b64_tr_b16 v[228:229], v244 offset:4096
  ds_read_b64_tr_b16 v[230:231], v244 offset:4608
  s_waitcnt lgkmcnt(6)
  v_mfma_f32_32x32x16_bf16 v[208:223], v[232:235], v[64:67], v[208:223]
  v_mul_f32 v250, s98, v174
  v_mul_f32 v251, s98, v175
  v_exp_f32_e64 v248, v248 clamp
  ds_read_b64_tr_b16 v[232:233], v245 offset:4096
  ds_read_b64_tr_b16 v[234:235], v245 offset:4608
  v_mfma_f32_32x32x16_bf16 v[192:207], v[236:239], v[64:67], v[192:207]
  v_exp_f32_e64 v249, v249 clamp
  v_exp_f32_e64 v250, v250 clamp
  v_exp_f32_e64 v251, v251 clamp
  ds_read_b64_tr_b16 v[236:237], v244 offset:6144
  ds_read_b64_tr_b16 v[238:239], v244 offset:6656
  s_waitcnt lgkmcnt(6)
  v_mfma_f32_32x32x16_bf16 v[208:223], v[240:243], v[68:71], v[208:223]
  v_add_f32 v248, s99, v248
  v_add_f32 v249, s99, v249
  v_add_f32 v250, s99, v250
  ds_read_b64_tr_b16 v[240:241], v245 offset:6144
  ds_read_b64_tr_b16 v[242:243], v245 offset:6656
  v_mfma_f32_32x32x16_bf16 v[192:207], v[224:227], v[68:71], v[192:207]
  v_add_f32 v251, s99, v251
  v_add_f32 v172, v172, v248
  v_add_f32 v173, v173, v249
  ds_read_b64_tr_b16 v[224:225], v244 offset:8192
  ds_read_b64_tr_b16 v[226:227], v244 offset:8704
  s_waitcnt lgkmcnt(6)
  v_mfma_f32_32x32x16_bf16 v[208:223], v[228:231], v[72:75], v[208:223]
  v_add_f32 v174, v174, v250
  v_add_f32 v175, v175, v251
  v_max_f32 v172, v172, v248
  ds_read_b64_tr_b16 v[228:229], v245 offset:8192
  ds_read_b64_tr_b16 v[230:231], v245 offset:8704
  v_mfma_f32_32x32x16_bf16 v[192:207], v[232:235], v[72:75], v[192:207]
  v_max_f32 v173, v173, v249
  v_max_f32 v174, v174, v250
  v_max_f32 v175, v175, v251
  ds_read_b64_tr_b16 v[232:233], v244 offset:10240
  ds_read_b64_tr_b16 v[234:235], v244 offset:10752
  s_waitcnt lgkmcnt(6)
  v_mfma_f32_32x32x16_bf16 v[208:223], v[236:239], v[76:79], v[208:223]
  v_cvt_pk_bf16_f32 v160, v160, v161
  v_cvt_pk_bf16_f32 v161, v162, v163
  v_cvt_pk_bf16_f32 v162, v164, v165
  v_cvt_pk_bf16_f32 v163, v166, v167
  ds_read_b64_tr_b16 v[236:237], v245 offset:10240
  ds_read_b64_tr_b16 v[238:239], v245 offset:10752
  v_mfma_f32_32x32x16_bf16 v[192:207], v[240:243], v[76:79], v[192:207]
  s_lshl_b32 s81, s25, 2
  s_add_u32 s81, s81, s24
  s_lshl_b32 s81, s81, 3
  s_add_u32 s81, s81, s26
  s_mul_i32 s81, s81, 5120
  buffer_store_dwordx4 v[160:163], v247, s[44:47], s81 offen offset:0 sc0 sc1
  ds_read_b64_tr_b16 v[240:241], v244 offset:12288
  ds_read_b64_tr_b16 v[242:243], v244 offset:12800
  s_waitcnt lgkmcnt(6)
  v_mfma_f32_32x32x16_bf16 v[208:223], v[224:227], v[80:83], v[208:223]
  v_cvt_pk_bf16_f32 v168, v168, v169
  v_cvt_pk_bf16_f32 v169, v170, v171
  ds_read_b64_tr_b16 v[224:225], v245 offset:12288
  ds_read_b64_tr_b16 v[226:227], v245 offset:12800
  v_mfma_f32_32x32x16_bf16 v[192:207], v[228:231], v[80:83], v[192:207]
  v_cvt_pk_bf16_f32 v170, v172, v173
  v_cvt_pk_bf16_f32 v171, v174, v175
  ds_read_b64_tr_b16 v[228:229], v244 offset:14336
  ds_read_b64_tr_b16 v[230:231], v244 offset:14848
  s_waitcnt lgkmcnt(6)
  v_mfma_f32_32x32x16_bf16 v[208:223], v[232:235], v[84:87], v[208:223]
  s_lshl_b32 s81, s25, 2
  s_add_u32 s81, s81, s24
  s_lshl_b32 s81, s81, 3
  s_add_u32 s81, s81, s26
  s_mul_i32 s81, s81, 5120
  buffer_store_dwordx4 v[168:171], v247, s[44:47], s81 offen offset:1024 sc0 sc1
  ds_read_b64_tr_b16 v[232:233], v245 offset:14336
  ds_read_b64_tr_b16 v[234:235], v245 offset:14848
  v_mfma_f32_32x32x16_bf16 v[192:207], v[236:239], v[84:87], v[192:207]
  v_mul_f32 v248, s98, v176
  v_mul_f32 v249, s98, v177
  v_mul_f32 v250, s98, v178
  s_barrier
  v_add_u32 v244, 73728, v246
  v_xor_b32 v245, 64, v244
  ds_read_b64_tr_b16 v[236:237], v244 offset:0
  ds_read_b64_tr_b16 v[238:239], v244 offset:512
  s_waitcnt lgkmcnt(6)
  v_mfma_f32_32x32x16_bf16 v[208:223], v[240:243], v[88:91], v[208:223]
  v_mul_f32 v251, s98, v179
  v_exp_f32_e64 v248, v248 clamp
  ds_read_b64_tr_b16 v[240:241], v245 offset:0
  ds_read_b64_tr_b16 v[242:243], v245 offset:512
  v_mfma_f32_32x32x16_bf16 v[192:207], v[224:227], v[88:91], v[192:207]
  v_exp_f32_e64 v249, v249 clamp
  ds_read_b64_tr_b16 v[224:225], v244 offset:2048
  ds_read_b64_tr_b16 v[226:227], v244 offset:2560
  s_waitcnt lgkmcnt(6)
  v_mfma_f32_32x32x16_bf16 v[208:223], v[228:231], v[92:95], v[208:223]
  v_exp_f32_e64 v250, v250 clamp
  ds_read_b64_tr_b16 v[228:229], v245 offset:2048
  ds_read_b64_tr_b16 v[230:231], v245 offset:2560
  v_mfma_f32_32x32x16_bf16 v[192:207], v[232:235], v[92:95], v[192:207]
  v_exp_f32_e64 v251, v251 clamp
  v_add_f32 v248, s99, v248
  v_add_f32 v249, s99, v249
  ds_read_b64_tr_b16 v[232:233], v244 offset:4096
  ds_read_b64_tr_b16 v[234:235], v244 offset:4608
  s_waitcnt lgkmcnt(6)
  v_mfma_f32_32x32x16_bf16 v[208:223], v[236:239], v[96:99], v[208:223]
  v_add_f32 v250, s99, v250
  v_add_f32 v251, s99, v251
  v_add_f32 v176, v176, v248
  ds_read_b64_tr_b16 v[236:237], v245 offset:4096
  ds_read_b64_tr_b16 v[238:239], v245 offset:4608
  v_mfma_f32_32x32x16_bf16 v[192:207], v[240:243], v[96:99], v[192:207]
  v_add_f32 v177, v177, v249
  v_add_f32 v178, v178, v250
  v_add_f32 v179, v179, v251
  ds_read_b64_tr_b16 v[240:241], v244 offset:6144
  ds_read_b64_tr_b16 v[242:243], v244 offset:6656
  s_waitcnt lgkmcnt(6)
  v_mfma_f32_32x32x16_bf16 v[208:223], v[224:227], v[100:103], v[208:223]
  v_max_f32 v176, v176, v248
  v_max_f32 v177, v177, v249
  v_max_f32 v178, v178, v250
  ds_read_b64_tr_b16 v[224:225], v245 offset:6144
  ds_read_b64_tr_b16 v[226:227], v245 offset:6656
  v_mfma_f32_32x32x16_bf16 v[192:207], v[228:231], v[100:103], v[192:207]
  v_max_f32 v179, v179, v251
  v_mul_f32 v248, s98, v180
  v_mul_f32 v249, s98, v181
  ds_read_b64_tr_b16 v[228:229], v244 offset:8192
  ds_read_b64_tr_b16 v[230:231], v244 offset:8704
  s_waitcnt lgkmcnt(6)
  v_mfma_f32_32x32x16_bf16 v[208:223], v[232:235], v[104:107], v[208:223]
  v_mul_f32 v250, s98, v182
  v_mul_f32 v251, s98, v183
  v_exp_f32_e64 v248, v248 clamp
  ds_read_b64_tr_b16 v[232:233], v245 offset:8192
  ds_read_b64_tr_b16 v[234:235], v245 offset:8704
  v_mfma_f32_32x32x16_bf16 v[192:207], v[236:239], v[104:107], v[192:207]
  v_exp_f32_e64 v249, v249 clamp
  v_exp_f32_e64 v250, v250 clamp
  v_exp_f32_e64 v251, v251 clamp
  ds_read_b64_tr_b16 v[236:237], v244 offset:10240
  ds_read_b64_tr_b16 v[238:239], v244 offset:10752
  s_waitcnt lgkmcnt(6)
  v_mfma_f32_32x32x16_bf16 v[208:223], v[240:243], v[108:111], v[208:223]
  v_add_f32 v248, s99, v248
  v_add_f32 v249, s99, v249
  v_add_f32 v250, s99, v250
  ds_read_b64_tr_b16 v[240:241], v245 offset:10240
  ds_read_b64_tr_b16 v[242:243], v245 offset:10752
  v_mfma_f32_32x32x16_bf16 v[192:207], v[224:227], v[108:111], v[192:207]
  v_add_f32 v251, s99, v251
  v_add_f32 v180, v180, v248
  v_add_f32 v181, v181, v249
  ds_read_b64_tr_b16 v[224:225], v244 offset:12288
  ds_read_b64_tr_b16 v[226:227], v244 offset:12800
  s_waitcnt lgkmcnt(6)
  v_mfma_f32_32x32x16_bf16 v[208:223], v[228:231], v[112:115], v[208:223]
  v_add_f32 v182, v182, v250
  v_add_f32 v183, v183, v251
  v_max_f32 v180, v180, v248
  ds_read_b64_tr_b16 v[228:229], v245 offset:12288
  ds_read_b64_tr_b16 v[230:231], v245 offset:12800
  v_mfma_f32_32x32x16_bf16 v[192:207], v[232:235], v[112:115], v[192:207]
  v_max_f32 v181, v181, v249
  v_max_f32 v182, v182, v250
  v_max_f32 v183, v183, v251
  ds_read_b64_tr_b16 v[232:233], v244 offset:14336
  ds_read_b64_tr_b16 v[234:235], v244 offset:14848
  s_waitcnt lgkmcnt(6)
  v_mfma_f32_32x32x16_bf16 v[208:223], v[236:239], v[116:119], v[208:223]
  v_mul_f32 v248, s98, v184
  v_mul_f32 v249, s98, v185
  v_mul_f32 v250, s98, v186
  ds_read_b64_tr_b16 v[236:237], v245 offset:14336
  ds_read_b64_tr_b16 v[238:239], v245 offset:14848
  v_mfma_f32_32x32x16_bf16 v[192:207], v[240:243], v[116:119], v[192:207]
  v_mul_f32 v251, s98, v187
  v_exp_f32_e64 v248, v248 clamp
  v_exp_f32_e64 v249, v249 clamp
  s_barrier
  v_add_u32 v244, 90112, v246
  v_xor_b32 v245, 64, v244
  ds_read_b64_tr_b16 v[240:241], v244 offset:0
  ds_read_b64_tr_b16 v[242:243], v244 offset:512
  s_waitcnt lgkmcnt(6)
  v_mfma_f32_32x32x16_bf16 v[208:223], v[224:227], v[120:123], v[208:223]
  v_exp_f32_e64 v250, v250 clamp
  v_exp_f32_e64 v251, v251 clamp
  v_add_f32 v248, s99, v248
  ds_read_b64_tr_b16 v[224:225], v245 offset:0
  ds_read_b64_tr_b16 v[226:227], v245 offset:512
  v_mfma_f32_32x32x16_bf16 v[192:207], v[228:231], v[120:123], v[192:207]
  v_add_f32 v249, s99, v249
  v_add_f32 v250, s99, v250
  v_add_f32 v251, s99, v251
  ds_read_b64_tr_b16 v[228:229], v244 offset:2048
  ds_read_b64_tr_b16 v[230:231], v244 offset:2560
  s_waitcnt lgkmcnt(6)
  v_mfma_f32_32x32x16_bf16 v[208:223], v[232:235], v[124:127], v[208:223]
  v_add_f32 v184, v184, v248
  v_add_f32 v185, v185, v249
  v_add_f32 v186, v186, v250
  ds_read_b64_tr_b16 v[232:233], v245 offset:2048
  ds_read_b64_tr_b16 v[234:235], v245 offset:2560
  v_mfma_f32_32x32x16_bf16 v[192:207], v[236:239], v[124:127], v[192:207]
  v_add_f32 v187, v187, v251
  v_max_f32 v184, v184, v248
  v_max_f32 v185, v185, v249
  ds_read_b64_tr_b16 v[236:237], v244 offset:4096
  ds_read_b64_tr_b16 v[238:239], v244 offset:4608
  s_waitcnt lgkmcnt(6)
  v_mfma_f32_32x32x16_bf16 v[208:223], v[240:243], v[128:131], v[208:223]
  v_max_f32 v186, v186, v250
  v_max_f32 v187, v187, v251
  v_mul_f32 v248, s98, v188
  ds_read_b64_tr_b16 v[240:241], v245 offset:4096
  ds_read_b64_tr_b16 v[242:243], v245 offset:4608
  v_mfma_f32_32x32x16_bf16 v[192:207], v[224:227], v[128:131], v[192:207]
  v_mul_f32 v249, s98, v189
  v_mul_f32 v250, s98, v190
  v_mul_f32 v251, s98, v191
  ds_read_b64_tr_b16 v[224:225], v244 offset:6144
  ds_read_b64_tr_b16 v[226:227], v244 offset:6656
  s_waitcnt lgkmcnt(6)
  v_mfma_f32_32x32x16_bf16 v[208:223], v[228:231], v[132:135], v[208:223]
  v_exp_f32_e64 v248, v248 clamp
  v_exp_f32_e64 v249, v249 clamp
  v_exp_f32_e64 v250, v250 clamp
  ds_read_b64_tr_b16 v[228:229], v245 offset:6144
  ds_read_b64_tr_b16 v[230:231], v245 offset:6656
  v_mfma_f32_32x32x16_bf16 v[192:207], v[232:235], v[132:135], v[192:207]
  v_exp_f32_e64 v251, v251 clamp
  v_add_f32 v248, s99, v248
  v_add_f32 v249, s99, v249
  ds_read_b64_tr_b16 v[232:233], v244 offset:8192
  ds_read_b64_tr_b16 v[234:235], v244 offset:8704
  s_waitcnt lgkmcnt(6)
  v_mfma_f32_32x32x16_bf16 v[208:223], v[236:239], v[136:139], v[208:223]
  v_add_f32 v250, s99, v250
  v_add_f32 v251, s99, v251
  v_add_f32 v188, v188, v248
  ds_read_b64_tr_b16 v[236:237], v245 offset:8192
  ds_read_b64_tr_b16 v[238:239], v245 offset:8704
  v_mfma_f32_32x32x16_bf16 v[192:207], v[240:243], v[136:139], v[192:207]
  v_add_f32 v189, v189, v249
  v_add_f32 v190, v190, v250
  v_add_f32 v191, v191, v251
  ds_read_b64_tr_b16 v[240:241], v244 offset:10240
  ds_read_b64_tr_b16 v[242:243], v244 offset:10752
  s_waitcnt lgkmcnt(6)
  v_mfma_f32_32x32x16_bf16 v[208:223], v[224:227], v[140:143], v[208:223]
  v_max_f32 v188, v188, v248
  v_max_f32 v189, v189, v249
  v_max_f32 v190, v190, v250
  ds_read_b64_tr_b16 v[224:225], v245 offset:10240
  ds_read_b64_tr_b16 v[226:227], v245 offset:10752
  v_mfma_f32_32x32x16_bf16 v[192:207], v[228:231], v[140:143], v[192:207]
  v_max_f32 v191, v191, v251
  v_cvt_pk_bf16_f32 v176, v176, v177
  v_cvt_pk_bf16_f32 v177, v178, v179
  ds_read_b64_tr_b16 v[228:229], v244 offset:12288
  ds_read_b64_tr_b16 v[230:231], v244 offset:12800
  s_waitcnt lgkmcnt(6)
  v_mfma_f32_32x32x16_bf16 v[208:223], v[232:235], v[144:147], v[208:223]
  v_cvt_pk_bf16_f32 v178, v180, v181
  v_cvt_pk_bf16_f32 v179, v182, v183
  s_lshl_b32 s81, s25, 2
  s_add_u32 s81, s81, s24
  s_lshl_b32 s81, s81, 3
  s_add_u32 s81, s81, s26
  s_mul_i32 s81, s81, 5120
  buffer_store_dwordx4 v[176:179], v247, s[44:47], s81 offen offset:2048 sc0 sc1
  ds_read_b64_tr_b16 v[232:233], v245 offset:12288
  ds_read_b64_tr_b16 v[234:235], v245 offset:12800
  v_mfma_f32_32x32x16_bf16 v[192:207], v[236:239], v[144:147], v[192:207]
  v_cvt_pk_bf16_f32 v184, v184, v185
  v_cvt_pk_bf16_f32 v185, v186, v187
  ds_read_b64_tr_b16 v[236:237], v244 offset:14336
  ds_read_b64_tr_b16 v[238:239], v244 offset:14848
  s_waitcnt lgkmcnt(6)
  v_mfma_f32_32x32x16_bf16 v[208:223], v[240:243], v[148:151], v[208:223]
  v_cvt_pk_bf16_f32 v186, v188, v189
  v_cvt_pk_bf16_f32 v187, v190, v191
  ds_read_b64_tr_b16 v[240:241], v245 offset:14336
  ds_read_b64_tr_b16 v[242:243], v245 offset:14848
  v_mfma_f32_32x32x16_bf16 v[192:207], v[224:227], v[148:151], v[192:207]
  s_barrier
  v_add_u32 v244, 0, v246
  v_xor_b32 v245, 64, v244
  ds_read_b64_tr_b16 v[224:225], v244 offset:0
  ds_read_b64_tr_b16 v[226:227], v244 offset:512
  s_waitcnt lgkmcnt(6)
  v_mfma_f32_32x32x16_bf16 v[208:223], v[228:231], v[152:155], v[208:223]
  s_lshl_b32 s81, s25, 2
  s_add_u32 s81, s81, s24
  s_lshl_b32 s81, s81, 3
  s_add_u32 s81, s81, s26
  s_mul_i32 s81, s81, 5120
  buffer_store_dwordx4 v[184:187], v247, s[44:47], s81 offen offset:3072 sc0 sc1
  ds_read_b64_tr_b16 v[228:229], v245 offset:0
  ds_read_b64_tr_b16 v[230:231], v245 offset:512
  v_mfma_f32_32x32x16_bf16 v[192:207], v[232:235], v[152:155], v[192:207]
  ds_read_b64_tr_b16 v[232:233], v244 offset:2048
  ds_read_b64_tr_b16 v[234:235], v244 offset:2560
  s_waitcnt lgkmcnt(6)
  v_mfma_f32_32x32x16_bf16 v[208:223], v[236:239], v[156:159], v[208:223]
  ds_read_b64_tr_b16 v[236:237], v245 offset:2048
  ds_read_b64_tr_b16 v[238:239], v245 offset:2560
  v_mfma_f32_32x32x16_bf16 v[192:207], v[240:243], v[156:159], v[192:207]
  ds_read_b64_tr_b16 v[240:241], v244 offset:4096
  ds_read_b64_tr_b16 v[242:243], v244 offset:4608
  s_waitcnt lgkmcnt(6)
  v_mfma_f32_32x32x16_bf16 v[160:175], v[224:227], v[0:3], 0
  ds_read_b64_tr_b16 v[224:225], v245 offset:4096
  ds_read_b64_tr_b16 v[226:227], v245 offset:4608
  v_mfma_f32_32x32x16_bf16 v[176:191], v[228:231], v[0:3], 0
  ds_read_b64_tr_b16 v[228:229], v244 offset:6144
  ds_read_b64_tr_b16 v[230:231], v244 offset:6656
  s_waitcnt lgkmcnt(6)
  v_mfma_f32_32x32x16_bf16 v[160:175], v[232:235], v[4:7], v[160:175]
  ds_read_b64_tr_b16 v[232:233], v245 offset:6144
  ds_read_b64_tr_b16 v[234:235], v245 offset:6656
  v_mfma_f32_32x32x16_bf16 v[176:191], v[236:239], v[4:7], v[176:191]
  v_mul_f32 v208, s97, v208
  v_mul_f32 v209, s97, v209
  v_mul_f32 v210, s97, v210
  ds_read_b64_tr_b16 v[236:237], v244 offset:8192
  ds_read_b64_tr_b16 v[238:239], v244 offset:8704
  s_waitcnt lgkmcnt(6)
  v_mfma_f32_32x32x16_bf16 v[160:175], v[240:243], v[8:11], v[160:175]
  v_mul_f32 v211, s97, v211
  v_exp_f32 v208, v208
  ds_read_b64_tr_b16 v[240:241], v245 offset:8192
  ds_read_b64_tr_b16 v[242:243], v245 offset:8704
  v_mfma_f32_32x32x16_bf16 v[176:191], v[224:227], v[8:11], v[176:191]
  v_exp_f32 v209, v209
  ds_read_b64_tr_b16 v[224:225], v244 offset:10240
  ds_read_b64_tr_b16 v[226:227], v244 offset:10752
  s_waitcnt lgkmcnt(6)
  v_mfma_f32_32x32x16_bf16 v[160:175], v[228:231], v[12:15], v[160:175]
  v_exp_f32 v210, v210
  ds_read_b64_tr_b16 v[228:229], v245 offset:10240
  ds_read_b64_tr_b16 v[230:231], v245 offset:10752
  v_mfma_f32_32x32x16_bf16 v[176:191], v[232:235], v[12:15], v[176:191]
  v_exp_f32 v211, v211
  v_add_f32 v208, 1.0, v208
  s_waitcnt vmcnt(0)
  ds_read_b64_tr_b16 v[232:233], v244 offset:12288
  ds_read_b64_tr_b16 v[234:235], v244 offset:12800
  s_waitcnt lgkmcnt(6)
  v_mfma_f32_32x32x16_bf16 v[160:175], v[236:239], v[16:19], v[160:175]
  v_add_f32 v209, 1.0, v209
  v_add_f32 v210, 1.0, v210
  v_add_f32 v211, 1.0, v211
  ds_read_b64_tr_b16 v[236:237], v245 offset:12288
  ds_read_b64_tr_b16 v[238:239], v245 offset:12800
  v_mfma_f32_32x32x16_bf16 v[176:191], v[240:243], v[16:19], v[176:191]
  v_rcp_f32 v208, v208
  ds_read_b64_tr_b16 v[240:241], v244 offset:14336
  ds_read_b64_tr_b16 v[242:243], v244 offset:14848
  s_waitcnt lgkmcnt(6)
  v_mfma_f32_32x32x16_bf16 v[160:175], v[224:227], v[20:23], v[160:175]
  v_rcp_f32 v209, v209
  ds_read_b64_tr_b16 v[224:225], v245 offset:14336
  ds_read_b64_tr_b16 v[226:227], v245 offset:14848
  v_mfma_f32_32x32x16_bf16 v[176:191], v[228:231], v[20:23], v[176:191]
  v_rcp_f32 v210, v210
  s_barrier
  v_add_u32 v244, 16384, v246
  v_xor_b32 v245, 64, v244
  ds_read_b64_tr_b16 v[228:229], v244 offset:0
  ds_read_b64_tr_b16 v[230:231], v244 offset:512
  s_waitcnt lgkmcnt(6)
  v_mfma_f32_32x32x16_bf16 v[160:175], v[232:235], v[24:27], v[160:175]
  v_rcp_f32 v211, v211
  v_mul_f32 v212, s97, v212
  ds_read_b64_tr_b16 v[232:233], v245 offset:0
  ds_read_b64_tr_b16 v[234:235], v245 offset:512
  v_mfma_f32_32x32x16_bf16 v[176:191], v[236:239], v[24:27], v[176:191]
  v_mul_f32 v213, s97, v213
  v_mul_f32 v214, s97, v214
  v_mul_f32 v215, s97, v215
  ds_read_b64_tr_b16 v[236:237], v244 offset:2048
  ds_read_b64_tr_b16 v[238:239], v244 offset:2560
  s_waitcnt lgkmcnt(6)
  v_mfma_f32_32x32x16_bf16 v[160:175], v[240:243], v[28:31], v[160:175]
  v_exp_f32 v212, v212
  ds_read_b64_tr_b16 v[240:241], v245 offset:2048
  ds_read_b64_tr_b16 v[242:243], v245 offset:2560
  v_mfma_f32_32x32x16_bf16 v[176:191], v[224:227], v[28:31], v[176:191]
  v_exp_f32 v213, v213
  ds_read_b64_tr_b16 v[224:225], v244 offset:4096
  ds_read_b64_tr_b16 v[226:227], v244 offset:4608
  s_waitcnt lgkmcnt(6)
  v_mfma_f32_32x32x16_bf16 v[160:175], v[228:231], v[32:35], v[160:175]
  v_exp_f32 v214, v214
  ds_read_b64_tr_b16 v[228:229], v245 offset:4096
  ds_read_b64_tr_b16 v[230:231], v245 offset:4608
  v_mfma_f32_32x32x16_bf16 v[176:191], v[232:235], v[32:35], v[176:191]
  v_exp_f32 v215, v215
  v_add_f32 v212, 1.0, v212
  ds_read_b64_tr_b16 v[232:233], v244 offset:6144
  ds_read_b64_tr_b16 v[234:235], v244 offset:6656
  s_waitcnt lgkmcnt(6)
  v_mfma_f32_32x32x16_bf16 v[160:175], v[236:239], v[36:39], v[160:175]
  v_add_f32 v213, 1.0, v213
  v_add_f32 v214, 1.0, v214
  v_add_f32 v215, 1.0, v215
  ds_read_b64_tr_b16 v[236:237], v245 offset:6144
  ds_read_b64_tr_b16 v[238:239], v245 offset:6656
  v_mfma_f32_32x32x16_bf16 v[176:191], v[240:243], v[36:39], v[176:191]
  v_rcp_f32 v212, v212
  ds_read_b64_tr_b16 v[240:241], v244 offset:8192
  ds_read_b64_tr_b16 v[242:243], v244 offset:8704
  s_waitcnt lgkmcnt(6)
  v_mfma_f32_32x32x16_bf16 v[160:175], v[224:227], v[40:43], v[160:175]
  v_rcp_f32 v213, v213
  ds_read_b64_tr_b16 v[224:225], v245 offset:8192
  ds_read_b64_tr_b16 v[226:227], v245 offset:8704
  v_mfma_f32_32x32x16_bf16 v[176:191], v[228:231], v[40:43], v[176:191]
  v_rcp_f32 v214, v214
  ds_read_b64_tr_b16 v[228:229], v244 offset:10240
  ds_read_b64_tr_b16 v[230:231], v244 offset:10752
  s_waitcnt lgkmcnt(6)
  v_mfma_f32_32x32x16_bf16 v[160:175], v[232:235], v[44:47], v[160:175]
  v_rcp_f32 v215, v215
  v_mul_f32 v216, s97, v216
  ds_read_b64_tr_b16 v[232:233], v245 offset:10240
  ds_read_b64_tr_b16 v[234:235], v245 offset:10752
  v_mfma_f32_32x32x16_bf16 v[176:191], v[236:239], v[44:47], v[176:191]
  v_mul_f32 v217, s97, v217
  v_mul_f32 v218, s97, v218
  v_mul_f32 v219, s97, v219
  ds_read_b64_tr_b16 v[236:237], v244 offset:12288
  ds_read_b64_tr_b16 v[238:239], v244 offset:12800
  s_waitcnt lgkmcnt(6)
  v_mfma_f32_32x32x16_bf16 v[160:175], v[240:243], v[48:51], v[160:175]
  v_exp_f32 v216, v216
  ds_read_b64_tr_b16 v[240:241], v245 offset:12288
  ds_read_b64_tr_b16 v[242:243], v245 offset:12800
  v_mfma_f32_32x32x16_bf16 v[176:191], v[224:227], v[48:51], v[176:191]
  v_exp_f32 v217, v217
  ds_read_b64_tr_b16 v[224:225], v244 offset:14336
  ds_read_b64_tr_b16 v[226:227], v244 offset:14848
  s_waitcnt lgkmcnt(6)
  v_mfma_f32_32x32x16_bf16 v[160:175], v[228:231], v[52:55], v[160:175]
  v_exp_f32 v218, v218
  ds_read_b64_tr_b16 v[228:229], v245 offset:14336
  ds_read_b64_tr_b16 v[230:231], v245 offset:14848
  v_mfma_f32_32x32x16_bf16 v[176:191], v[232:235], v[52:55], v[176:191]
  v_exp_f32 v219, v219
  v_add_f32 v216, 1.0, v216
  s_barrier
  v_add_u32 v244, 32768, v246
  v_xor_b32 v245, 64, v244
  ds_read_b64_tr_b16 v[232:233], v244 offset:0
  ds_read_b64_tr_b16 v[234:235], v244 offset:512
  s_waitcnt lgkmcnt(6)
  v_mfma_f32_32x32x16_bf16 v[160:175], v[236:239], v[56:59], v[160:175]
  v_add_f32 v217, 1.0, v217
  v_add_f32 v218, 1.0, v218
  v_add_f32 v219, 1.0, v219
  ds_read_b64_tr_b16 v[236:237], v245 offset:0
  ds_read_b64_tr_b16 v[238:239], v245 offset:512
  v_mfma_f32_32x32x16_bf16 v[176:191], v[240:243], v[56:59], v[176:191]
  v_rcp_f32 v216, v216
  ds_read_b64_tr_b16 v[240:241], v244 offset:2048
  ds_read_b64_tr_b16 v[242:243], v244 offset:2560
  s_waitcnt lgkmcnt(6)
  v_mfma_f32_32x32x16_bf16 v[160:175], v[224:227], v[60:63], v[160:175]
  v_rcp_f32 v217, v217
  ds_read_b64_tr_b16 v[224:225], v245 offset:2048
  ds_read_b64_tr_b16 v[226:227], v245 offset:2560
  v_mfma_f32_32x32x16_bf16 v[176:191], v[228:231], v[60:63], v[176:191]
  v_rcp_f32 v218, v218
  ds_read_b64_tr_b16 v[228:229], v244 offset:4096
  ds_read_b64_tr_b16 v[230:231], v244 offset:4608
  s_waitcnt lgkmcnt(6)
  v_mfma_f32_32x32x16_bf16 v[160:175], v[232:235], v[64:67], v[160:175]
  v_rcp_f32 v219, v219
  v_mul_f32 v220, s97, v220
  ds_read_b64_tr_b16 v[232:233], v245 offset:4096
  ds_read_b64_tr_b16 v[234:235], v245 offset:4608
  v_mfma_f32_32x32x16_bf16 v[176:191], v[236:239], v[64:67], v[176:191]
  v_mul_f32 v221, s97, v221
  v_mul_f32 v222, s97, v222
  v_mul_f32 v223, s97, v223
  ds_read_b64_tr_b16 v[236:237], v244 offset:6144
  ds_read_b64_tr_b16 v[238:239], v244 offset:6656
  s_waitcnt lgkmcnt(6)
  v_mfma_f32_32x32x16_bf16 v[160:175], v[240:243], v[68:71], v[160:175]
  v_exp_f32 v220, v220
  ds_read_b64_tr_b16 v[240:241], v245 offset:6144
  ds_read_b64_tr_b16 v[242:243], v245 offset:6656
  v_mfma_f32_32x32x16_bf16 v[176:191], v[224:227], v[68:71], v[176:191]
  v_exp_f32 v221, v221
  ds_read_b64_tr_b16 v[224:225], v244 offset:8192
  ds_read_b64_tr_b16 v[226:227], v244 offset:8704
  s_waitcnt lgkmcnt(6)
  v_mfma_f32_32x32x16_bf16 v[160:175], v[228:231], v[72:75], v[160:175]
  v_exp_f32 v222, v222
  ds_read_b64_tr_b16 v[228:229], v245 offset:8192
  ds_read_b64_tr_b16 v[230:231], v245 offset:8704
  v_mfma_f32_32x32x16_bf16 v[176:191], v[232:235], v[72:75], v[176:191]
  v_exp_f32 v223, v223
  v_add_f32 v220, 1.0, v220
  ds_read_b64_tr_b16 v[232:233], v244 offset:10240
  ds_read_b64_tr_b16 v[234:235], v244 offset:10752
  s_waitcnt lgkmcnt(6)
  v_mfma_f32_32x32x16_bf16 v[160:175], v[236:239], v[76:79], v[160:175]
  v_add_f32 v221, 1.0, v221
  v_add_f32 v222, 1.0, v222
  v_add_f32 v223, 1.0, v223
  ds_read_b64_tr_b16 v[236:237], v245 offset:10240
  ds_read_b64_tr_b16 v[238:239], v245 offset:10752
  v_mfma_f32_32x32x16_bf16 v[176:191], v[240:243], v[76:79], v[176:191]
  v_rcp_f32 v220, v220
  ds_read_b64_tr_b16 v[240:241], v244 offset:12288
  ds_read_b64_tr_b16 v[242:243], v244 offset:12800
  s_waitcnt lgkmcnt(6)
  v_mfma_f32_32x32x16_bf16 v[160:175], v[224:227], v[80:83], v[160:175]
  v_rcp_f32 v221, v221
  ds_read_b64_tr_b16 v[224:225], v245 offset:12288
  ds_read_b64_tr_b16 v[226:227], v245 offset:12800
  v_mfma_f32_32x32x16_bf16 v[176:191], v[228:231], v[80:83], v[176:191]
  v_rcp_f32 v222, v222
  ds_read_b64_tr_b16 v[228:229], v244 offset:14336
  ds_read_b64_tr_b16 v[230:231], v244 offset:14848
  s_waitcnt lgkmcnt(6)
  v_mfma_f32_32x32x16_bf16 v[160:175], v[232:235], v[84:87], v[160:175]
  v_rcp_f32 v223, v223
  v_mul_f32 v192, s97, v192
  ds_read_b64_tr_b16 v[232:233], v245 offset:14336
  ds_read_b64_tr_b16 v[234:235], v245 offset:14848
  v_mfma_f32_32x32x16_bf16 v[176:191], v[236:239], v[84:87], v[176:191]
  v_mul_f32 v193, s97, v193
  v_mul_f32 v194, s97, v194
  v_mul_f32 v195, s97, v195
  s_barrier
  v_add_u32 v244, 49152, v246
  v_xor_b32 v245, 64, v244
  ds_read_b64_tr_b16 v[236:237], v244 offset:0
  ds_read_b64_tr_b16 v[238:239], v244 offset:512
  s_waitcnt lgkmcnt(6)
  v_mfma_f32_32x32x16_bf16 v[160:175], v[240:243], v[88:91], v[160:175]
  v_exp_f32 v192, v192
  ds_read_b64_tr_b16 v[240:241], v245 offset:0
  ds_read_b64_tr_b16 v[242:243], v245 offset:512
  v_mfma_f32_32x32x16_bf16 v[176:191], v[224:227], v[88:91], v[176:191]
  v_exp_f32 v193, v193
  ds_read_b64_tr_b16 v[224:225], v244 offset:2048
  ds_read_b64_tr_b16 v[226:227], v244 offset:2560
  s_waitcnt lgkmcnt(6)
  v_mfma_f32_32x32x16_bf16 v[160:175], v[228:231], v[92:95], v[160:175]
  v_exp_f32 v194, v194
  ds_read_b64_tr_b16 v[228:229], v245 offset:2048
  ds_read_b64_tr_b16 v[230:231], v245 offset:2560
  v_mfma_f32_32x32x16_bf16 v[176:191], v[232:235], v[92:95], v[176:191]
  v_exp_f32 v195, v195
  v_add_f32 v192, 1.0, v192
  ds_read_b64_tr_b16 v[232:233], v244 offset:4096
  ds_read_b64_tr_b16 v[234:235], v244 offset:4608
  s_waitcnt lgkmcnt(6)
  v_mfma_f32_32x32x16_bf16 v[160:175], v[236:239], v[96:99], v[160:175]
  v_add_f32 v193, 1.0, v193
  v_add_f32 v194, 1.0, v194
  v_add_f32 v195, 1.0, v195
  ds_read_b64_tr_b16 v[236:237], v245 offset:4096
  ds_read_b64_tr_b16 v[238:239], v245 offset:4608
  v_mfma_f32_32x32x16_bf16 v[176:191], v[240:243], v[96:99], v[176:191]
  v_rcp_f32 v192, v192
  ds_read_b64_tr_b16 v[240:241], v244 offset:6144
  ds_read_b64_tr_b16 v[242:243], v244 offset:6656
  s_waitcnt lgkmcnt(6)
  v_mfma_f32_32x32x16_bf16 v[160:175], v[224:227], v[100:103], v[160:175]
  v_rcp_f32 v193, v193
  ds_read_b64_tr_b16 v[224:225], v245 offset:6144
  ds_read_b64_tr_b16 v[226:227], v245 offset:6656
  v_mfma_f32_32x32x16_bf16 v[176:191], v[228:231], v[100:103], v[176:191]
  v_rcp_f32 v194, v194
  ds_read_b64_tr_b16 v[228:229], v244 offset:8192
  ds_read_b64_tr_b16 v[230:231], v244 offset:8704
  s_waitcnt lgkmcnt(6)
  v_mfma_f32_32x32x16_bf16 v[160:175], v[232:235], v[104:107], v[160:175]
  v_rcp_f32 v195, v195
  v_mul_f32 v196, s97, v196
  ds_read_b64_tr_b16 v[232:233], v245 offset:8192
  ds_read_b64_tr_b16 v[234:235], v245 offset:8704
  v_mfma_f32_32x32x16_bf16 v[176:191], v[236:239], v[104:107], v[176:191]
  v_mul_f32 v197, s97, v197
  v_mul_f32 v198, s97, v198
  v_mul_f32 v199, s97, v199
  ds_read_b64_tr_b16 v[236:237], v244 offset:10240
  ds_read_b64_tr_b16 v[238:239], v244 offset:10752
  s_waitcnt lgkmcnt(6)
  v_mfma_f32_32x32x16_bf16 v[160:175], v[240:243], v[108:111], v[160:175]
  v_exp_f32 v196, v196
  ds_read_b64_tr_b16 v[240:241], v245 offset:10240
  ds_read_b64_tr_b16 v[242:243], v245 offset:10752
  v_mfma_f32_32x32x16_bf16 v[176:191], v[224:227], v[108:111], v[176:191]
  v_exp_f32 v197, v197
  ds_read_b64_tr_b16 v[224:225], v244 offset:12288
  ds_read_b64_tr_b16 v[226:227], v244 offset:12800
  s_waitcnt lgkmcnt(6)
  v_mfma_f32_32x32x16_bf16 v[160:175], v[228:231], v[112:115], v[160:175]
  v_exp_f32 v198, v198
  ds_read_b64_tr_b16 v[228:229], v245 offset:12288
  ds_read_b64_tr_b16 v[230:231], v245 offset:12800
  v_mfma_f32_32x32x16_bf16 v[176:191], v[232:235], v[112:115], v[176:191]
  v_exp_f32 v199, v199
  v_add_f32 v196, 1.0, v196
  ds_read_b64_tr_b16 v[232:233], v244 offset:14336
  ds_read_b64_tr_b16 v[234:235], v244 offset:14848
  s_waitcnt lgkmcnt(6)
  v_mfma_f32_32x32x16_bf16 v[160:175], v[236:239], v[116:119], v[160:175]
  v_add_f32 v197, 1.0, v197
  v_add_f32 v198, 1.0, v198
  v_add_f32 v199, 1.0, v199
  ds_read_b64_tr_b16 v[236:237], v245 offset:14336
  ds_read_b64_tr_b16 v[238:239], v245 offset:14848
  v_mfma_f32_32x32x16_bf16 v[176:191], v[240:243], v[116:119], v[176:191]
  v_rcp_f32 v196, v196
  s_barrier
  v_add_u32 v244, 65536, v246
  v_xor_b32 v245, 64, v244
  ds_read_b64_tr_b16 v[240:241], v244 offset:0
  ds_read_b64_tr_b16 v[242:243], v244 offset:512
  s_waitcnt lgkmcnt(6)
  v_mfma_f32_32x32x16_bf16 v[160:175], v[224:227], v[120:123], v[160:175]
  v_rcp_f32 v197, v197
  ds_read_b64_tr_b16 v[224:225], v245 offset:0
  ds_read_b64_tr_b16 v[226:227], v245 offset:512
  v_mfma_f32_32x32x16_bf16 v[176:191], v[228:231], v[120:123], v[176:191]
  v_rcp_f32 v198, v198
  ds_read_b64_tr_b16 v[228:229], v244 offset:2048
  ds_read_b64_tr_b16 v[230:231], v244 offset:2560
  s_waitcnt lgkmcnt(6)
  v_mfma_f32_32x32x16_bf16 v[160:175], v[232:235], v[124:127], v[160:175]
  v_rcp_f32 v199, v199
  v_mul_f32 v200, s97, v200
  ds_read_b64_tr_b16 v[232:233], v245 offset:2048
  ds_read_b64_tr_b16 v[234:235], v245 offset:2560
  v_mfma_f32_32x32x16_bf16 v[176:191], v[236:239], v[124:127], v[176:191]
  v_mul_f32 v201, s97, v201
  v_mul_f32 v202, s97, v202
  v_mul_f32 v203, s97, v203
  ds_read_b64_tr_b16 v[236:237], v244 offset:4096
  ds_read_b64_tr_b16 v[238:239], v244 offset:4608
  s_waitcnt lgkmcnt(6)
  v_mfma_f32_32x32x16_bf16 v[160:175], v[240:243], v[128:131], v[160:175]
  v_exp_f32 v200, v200
  ds_read_b64_tr_b16 v[240:241], v245 offset:4096
  ds_read_b64_tr_b16 v[242:243], v245 offset:4608
  v_mfma_f32_32x32x16_bf16 v[176:191], v[224:227], v[128:131], v[176:191]
  v_exp_f32 v201, v201
  ds_read_b64_tr_b16 v[224:225], v244 offset:6144
  ds_read_b64_tr_b16 v[226:227], v244 offset:6656
  s_waitcnt lgkmcnt(6)
  v_mfma_f32_32x32x16_bf16 v[160:175], v[228:231], v[132:135], v[160:175]
  v_exp_f32 v202, v202
  ds_read_b64_tr_b16 v[228:229], v245 offset:6144
  ds_read_b64_tr_b16 v[230:231], v245 offset:6656
  v_mfma_f32_32x32x16_bf16 v[176:191], v[232:235], v[132:135], v[176:191]
  v_exp_f32 v203, v203
  v_add_f32 v200, 1.0, v200
  ds_read_b64_tr_b16 v[232:233], v244 offset:8192
  ds_read_b64_tr_b16 v[234:235], v244 offset:8704
  s_waitcnt lgkmcnt(6)
  v_mfma_f32_32x32x16_bf16 v[160:175], v[236:239], v[136:139], v[160:175]
  v_add_f32 v201, 1.0, v201
  v_add_f32 v202, 1.0, v202
  v_add_f32 v203, 1.0, v203
  ds_read_b64_tr_b16 v[236:237], v245 offset:8192
  ds_read_b64_tr_b16 v[238:239], v245 offset:8704
  v_mfma_f32_32x32x16_bf16 v[176:191], v[240:243], v[136:139], v[176:191]
  v_rcp_f32 v200, v200
  ds_read_b64_tr_b16 v[240:241], v244 offset:10240
  ds_read_b64_tr_b16 v[242:243], v244 offset:10752
  s_waitcnt lgkmcnt(6)
  v_mfma_f32_32x32x16_bf16 v[160:175], v[224:227], v[140:143], v[160:175]
  v_rcp_f32 v201, v201
  ds_read_b64_tr_b16 v[224:225], v245 offset:10240
  ds_read_b64_tr_b16 v[226:227], v245 offset:10752
  v_mfma_f32_32x32x16_bf16 v[176:191], v[228:231], v[140:143], v[176:191]
  v_rcp_f32 v202, v202
  ds_read_b64_tr_b16 v[228:229], v244 offset:12288
  ds_read_b64_tr_b16 v[230:231], v244 offset:12800
  s_waitcnt lgkmcnt(6)
  v_mfma_f32_32x32x16_bf16 v[160:175], v[232:235], v[144:147], v[160:175]
  v_rcp_f32 v203, v203
  v_mul_f32 v204, s97, v204
  ds_read_b64_tr_b16 v[232:233], v245 offset:12288
  ds_read_b64_tr_b16 v[234:235], v245 offset:12800
  v_mfma_f32_32x32x16_bf16 v[176:191], v[236:239], v[144:147], v[176:191]
  v_mul_f32 v205, s97, v205
  v_mul_f32 v206, s97, v206
  v_mul_f32 v207, s97, v207
  ds_read_b64_tr_b16 v[236:237], v244 offset:14336
  ds_read_b64_tr_b16 v[238:239], v244 offset:14848
  s_waitcnt lgkmcnt(6)
  v_mfma_f32_32x32x16_bf16 v[160:175], v[240:243], v[148:151], v[160:175]
  v_exp_f32 v204, v204
  ds_read_b64_tr_b16 v[240:241], v245 offset:14336
  ds_read_b64_tr_b16 v[242:243], v245 offset:14848
  v_mfma_f32_32x32x16_bf16 v[176:191], v[224:227], v[148:151], v[176:191]
  v_exp_f32 v205, v205
  v_exp_f32 v206, v206
  s_barrier
  v_add_u32 v244, 81920, v246
  v_xor_b32 v245, 64, v244
  ds_read_b64_tr_b16 v[224:225], v244 offset:0
  ds_read_b64_tr_b16 v[226:227], v244 offset:512
  s_waitcnt lgkmcnt(6)
  v_mfma_f32_32x32x16_bf16 v[160:175], v[228:231], v[152:155], v[160:175]
  v_exp_f32 v207, v207
  v_add_f32 v204, 1.0, v204
  v_add_f32 v205, 1.0, v205
  ds_read_b64_tr_b16 v[228:229], v245 offset:0
  ds_read_b64_tr_b16 v[230:231], v245 offset:512
  v_mfma_f32_32x32x16_bf16 v[176:191], v[232:235], v[152:155], v[176:191]
  v_add_f32 v206, 1.0, v206
  v_add_f32 v207, 1.0, v207
  v_rcp_f32 v204, v204
  ds_read_b64_tr_b16 v[232:233], v244 offset:2048
  ds_read_b64_tr_b16 v[234:235], v244 offset:2560
  s_waitcnt lgkmcnt(6)
  v_mfma_f32_32x32x16_bf16 v[160:175], v[236:239], v[156:159], v[160:175]
  v_rcp_f32 v205, v205
  v_rcp_f32 v206, v206
  v_rcp_f32 v207, v207
  ds_read_b64_tr_b16 v[236:237], v245 offset:2048
  ds_read_b64_tr_b16 v[238:239], v245 offset:2560
  v_mfma_f32_32x32x16_bf16 v[176:191], v[240:243], v[156:159], v[176:191]
  s_nop 3
  s_nop 7
  v_mul_f32 v160, v160, v208
  v_mul_f32 v161, v161, v209
  v_mul_f32 v162, v162, v210
  v_mul_f32 v163, v163, v211
  v_mul_f32 v164, v164, v212
  v_mul_f32 v165, v165, v213
  v_mul_f32 v166, v166, v214
  v_mul_f32 v167, v167, v215
  v_mul_f32 v168, v168, v216
  v_mul_f32 v169, v169, v217
  v_mul_f32 v170, v170, v218
  v_mul_f32 v171, v171, v219
  v_mul_f32 v172, v172, v220
  v_mul_f32 v173, v173, v221
  v_mul_f32 v174, v174, v222
  v_mul_f32 v175, v175, v223
  v_mul_f32 v176, v176, v192
  v_mul_f32 v177, v177, v193
  v_mul_f32 v178, v178, v194
  v_mul_f32 v179, v179, v195
  v_mul_f32 v180, v180, v196
  v_mul_f32 v181, v181, v197
  v_mul_f32 v182, v182, v198
  v_mul_f32 v183, v183, v199
  v_mul_f32 v184, v184, v200
  v_mul_f32 v185, v185, v201
  v_mul_f32 v186, v186, v202
  v_mul_f32 v187, v187, v203
  v_mul_f32 v188, v188, v204
  v_mul_f32 v189, v189, v205
  v_mul_f32 v190, v190, v206
  v_mul_f32 v191, v191, v207
  ds_read_b64_tr_b16 v[240:241], v244 offset:4096
  ds_read_b64_tr_b16 v[242:243], v244 offset:4608
  s_waitcnt lgkmcnt(6)
  v_mfma_f32_32x32x16_bf16 v[192:207], v[224:227], v[0:3], 0
  v_cvt_pk_bf16_f32 v160, v160, v161
  v_cvt_pk_bf16_f32 v161, v162, v163
  ds_read_b64_tr_b16 v[224:225], v245 offset:4096
  ds_read_b64_tr_b16 v[226:227], v245 offset:4608
  v_mfma_f32_32x32x16_bf16 v[208:223], v[228:231], v[0:3], 0
  v_cvt_pk_bf16_f32 v162, v164, v165
  v_cvt_pk_bf16_f32 v163, v166, v167
  ds_read_b64_tr_b16 v[228:229], v244 offset:6144
  ds_read_b64_tr_b16 v[230:231], v244 offset:6656
  s_waitcnt lgkmcnt(6)
  v_mfma_f32_32x32x16_bf16 v[192:207], v[232:235], v[4:7], v[192:207]
  ds_read_b64_tr_b16 v[232:233], v245 offset:6144
  ds_read_b64_tr_b16 v[234:235], v245 offset:6656
  v_mfma_f32_32x32x16_bf16 v[208:223], v[236:239], v[4:7], v[208:223]
  ds_read_b64_tr_b16 v[236:237], v244 offset:8192
  ds_read_b64_tr_b16 v[238:239], v244 offset:8704
  s_waitcnt lgkmcnt(6)
  v_mfma_f32_32x32x16_bf16 v[192:207], v[240:243], v[8:11], v[192:207]
  ds_read_b64_tr_b16 v[240:241], v245 offset:8192
  ds_read_b64_tr_b16 v[242:243], v245 offset:8704
  v_mfma_f32_32x32x16_bf16 v[208:223], v[224:227], v[8:11], v[208:223]
  ds_read_b64_tr_b16 v[224:225], v244 offset:10240
  ds_read_b64_tr_b16 v[226:227], v244 offset:10752
  s_waitcnt lgkmcnt(6)
  v_mfma_f32_32x32x16_bf16 v[192:207], v[228:231], v[12:15], v[192:207]
  ds_read_b64_tr_b16 v[228:229], v245 offset:10240
  ds_read_b64_tr_b16 v[230:231], v245 offset:10752
  v_mfma_f32_32x32x16_bf16 v[208:223], v[232:235], v[12:15], v[208:223]
  ds_read_b64_tr_b16 v[232:233], v244 offset:12288
  ds_read_b64_tr_b16 v[234:235], v244 offset:12800
  s_waitcnt lgkmcnt(6)
  v_mfma_f32_32x32x16_bf16 v[192:207], v[236:239], v[16:19], v[192:207]
  ds_read_b64_tr_b16 v[236:237], v245 offset:12288
  ds_read_b64_tr_b16 v[238:239], v245 offset:12800
  v_mfma_f32_32x32x16_bf16 v[208:223], v[240:243], v[16:19], v[208:223]
  ds_read_b64_tr_b16 v[240:241], v244 offset:14336
  ds_read_b64_tr_b16 v[242:243], v244 offset:14848
  s_waitcnt lgkmcnt(6)
  v_mfma_f32_32x32x16_bf16 v[192:207], v[224:227], v[20:23], v[192:207]
  ds_read_b64_tr_b16 v[224:225], v245 offset:14336
  ds_read_b64_tr_b16 v[226:227], v245 offset:14848
  v_mfma_f32_32x32x16_bf16 v[208:223], v[228:231], v[20:23], v[208:223]
  s_barrier
  v_add_u32 v244, 98304, v246
  v_xor_b32 v245, 64, v244
  ds_read_b64_tr_b16 v[228:229], v244 offset:0
  ds_read_b64_tr_b16 v[230:231], v244 offset:512
  s_waitcnt lgkmcnt(6)
  v_mfma_f32_32x32x16_bf16 v[192:207], v[232:235], v[24:27], v[192:207]
  ds_read_b64_tr_b16 v[232:233], v245 offset:0
  ds_read_b64_tr_b16 v[234:235], v245 offset:512
  v_mfma_f32_32x32x16_bf16 v[208:223], v[236:239], v[24:27], v[208:223]
  ds_read_b64_tr_b16 v[236:237], v244 offset:2048
  ds_read_b64_tr_b16 v[238:239], v244 offset:2560
  s_waitcnt lgkmcnt(6)
  v_mfma_f32_32x32x16_bf16 v[192:207], v[240:243], v[28:31], v[192:207]
  ds_read_b64_tr_b16 v[240:241], v245 offset:2048
  ds_read_b64_tr_b16 v[242:243], v245 offset:2560
  v_mfma_f32_32x32x16_bf16 v[208:223], v[224:227], v[28:31], v[208:223]
  ds_read_b64_tr_b16 v[224:225], v244 offset:4096
  ds_read_b64_tr_b16 v[226:227], v244 offset:4608
  s_waitcnt lgkmcnt(6)
  v_mfma_f32_32x32x16_bf16 v[192:207], v[228:231], v[32:35], v[192:207]
  ds_read_b64_tr_b16 v[228:229], v245 offset:4096
  ds_read_b64_tr_b16 v[230:231], v245 offset:4608
  v_mfma_f32_32x32x16_bf16 v[208:223], v[232:235], v[32:35], v[208:223]
  ds_read_b64_tr_b16 v[232:233], v244 offset:6144
  ds_read_b64_tr_b16 v[234:235], v244 offset:6656
  s_waitcnt lgkmcnt(6)
  v_mfma_f32_32x32x16_bf16 v[192:207], v[236:239], v[36:39], v[192:207]
  ds_read_b64_tr_b16 v[236:237], v245 offset:6144
  ds_read_b64_tr_b16 v[238:239], v245 offset:6656
  v_mfma_f32_32x32x16_bf16 v[208:223], v[240:243], v[36:39], v[208:223]
  ds_read_b64_tr_b16 v[240:241], v244 offset:8192
  ds_read_b64_tr_b16 v[242:243], v244 offset:8704
  s_waitcnt lgkmcnt(6)
  v_mfma_f32_32x32x16_bf16 v[192:207], v[224:227], v[40:43], v[192:207]
  ds_read_b64_tr_b16 v[224:225], v245 offset:8192
  ds_read_b64_tr_b16 v[226:227], v245 offset:8704
  v_mfma_f32_32x32x16_bf16 v[208:223], v[228:231], v[40:43], v[208:223]
  ds_read_b64_tr_b16 v[228:229], v244 offset:10240
  ds_read_b64_tr_b16 v[230:231], v244 offset:10752
  s_waitcnt lgkmcnt(6)
  v_mfma_f32_32x32x16_bf16 v[192:207], v[232:235], v[44:47], v[192:207]
  ds_read_b64_tr_b16 v[232:233], v245 offset:10240
  ds_read_b64_tr_b16 v[234:235], v245 offset:10752
  v_mfma_f32_32x32x16_bf16 v[208:223], v[236:239], v[44:47], v[208:223]
  ds_read_b64_tr_b16 v[236:237], v244 offset:12288
  ds_read_b64_tr_b16 v[238:239], v244 offset:12800
  s_waitcnt lgkmcnt(6)
  v_mfma_f32_32x32x16_bf16 v[192:207], v[240:243], v[48:51], v[192:207]
  ds_read_b64_tr_b16 v[240:241], v245 offset:12288
  ds_read_b64_tr_b16 v[242:243], v245 offset:12800
  v_mfma_f32_32x32x16_bf16 v[208:223], v[224:227], v[48:51], v[208:223]
  ds_read_b64_tr_b16 v[224:225], v244 offset:14336
  ds_read_b64_tr_b16 v[226:227], v244 offset:14848
  s_waitcnt lgkmcnt(6)
  v_mfma_f32_32x32x16_bf16 v[192:207], v[228:231], v[52:55], v[192:207]
  ds_read_b64_tr_b16 v[228:229], v245 offset:14336
  ds_read_b64_tr_b16 v[230:231], v245 offset:14848
  v_mfma_f32_32x32x16_bf16 v[208:223], v[232:235], v[52:55], v[208:223]
  s_barrier
  v_add_u32 v244, 0, v246
  v_xor_b32 v245, 64, v244
  ds_read_b64_tr_b16 v[232:233], v244 offset:0
  ds_read_b64_tr_b16 v[234:235], v244 offset:512
  s_waitcnt lgkmcnt(6)
  v_mfma_f32_32x32x16_bf16 v[192:207], v[236:239], v[56:59], v[192:207]
  ds_read_b64_tr_b16 v[236:237], v245 offset:0
  ds_read_b64_tr_b16 v[238:239], v245 offset:512
  v_mfma_f32_32x32x16_bf16 v[208:223], v[240:243], v[56:59], v[208:223]
  ds_read_b64_tr_b16 v[240:241], v244 offset:2048
  ds_read_b64_tr_b16 v[242:243], v244 offset:2560
  s_waitcnt lgkmcnt(6)
  v_mfma_f32_32x32x16_bf16 v[192:207], v[224:227], v[60:63], v[192:207]
  ds_read_b64_tr_b16 v[224:225], v245 offset:2048
  ds_read_b64_tr_b16 v[226:227], v245 offset:2560
  v_mfma_f32_32x32x16_bf16 v[208:223], v[228:231], v[60:63], v[208:223]
  ds_read_b64_tr_b16 v[228:229], v244 offset:4096
  ds_read_b64_tr_b16 v[230:231], v244 offset:4608
  s_waitcnt lgkmcnt(6)
  v_mfma_f32_32x32x16_bf16 v[192:207], v[232:235], v[64:67], v[192:207]
  ds_read_b64_tr_b16 v[232:233], v245 offset:4096
  ds_read_b64_tr_b16 v[234:235], v245 offset:4608
  v_mfma_f32_32x32x16_bf16 v[208:223], v[236:239], v[64:67], v[208:223]
  ds_read_b64_tr_b16 v[236:237], v244 offset:6144
  ds_read_b64_tr_b16 v[238:239], v244 offset:6656
  s_waitcnt lgkmcnt(6)
  v_mfma_f32_32x32x16_bf16 v[192:207], v[240:243], v[68:71], v[192:207]
  ds_read_b64_tr_b16 v[240:241], v245 offset:6144
  ds_read_b64_tr_b16 v[242:243], v245 offset:6656
  v_mfma_f32_32x32x16_bf16 v[208:223], v[224:227], v[68:71], v[208:223]
  ds_read_b64_tr_b16 v[224:225], v244 offset:8192
  ds_read_b64_tr_b16 v[226:227], v244 offset:8704
  s_waitcnt lgkmcnt(6)
  v_mfma_f32_32x32x16_bf16 v[192:207], v[228:231], v[72:75], v[192:207]
  ds_read_b64_tr_b16 v[228:229], v245 offset:8192
  ds_read_b64_tr_b16 v[230:231], v245 offset:8704
  v_mfma_f32_32x32x16_bf16 v[208:223], v[232:235], v[72:75], v[208:223]
  ds_read_b64_tr_b16 v[232:233], v244 offset:10240
  ds_read_b64_tr_b16 v[234:235], v244 offset:10752
  s_waitcnt lgkmcnt(6)
  v_mfma_f32_32x32x16_bf16 v[192:207], v[236:239], v[76:79], v[192:207]
  ds_read_b64_tr_b16 v[236:237], v245 offset:10240
  ds_read_b64_tr_b16 v[238:239], v245 offset:10752
  v_mfma_f32_32x32x16_bf16 v[208:223], v[240:243], v[76:79], v[208:223]
  ds_read_b64_tr_b16 v[240:241], v244 offset:12288
  ds_read_b64_tr_b16 v[242:243], v244 offset:12800
  s_waitcnt lgkmcnt(6)
  v_mfma_f32_32x32x16_bf16 v[192:207], v[224:227], v[80:83], v[192:207]
  ds_read_b64_tr_b16 v[224:225], v245 offset:12288
  ds_read_b64_tr_b16 v[226:227], v245 offset:12800
  v_mfma_f32_32x32x16_bf16 v[208:223], v[228:231], v[80:83], v[208:223]
  ds_read_b64_tr_b16 v[228:229], v244 offset:14336
  ds_read_b64_tr_b16 v[230:231], v244 offset:14848
  s_waitcnt lgkmcnt(6)
  v_mfma_f32_32x32x16_bf16 v[192:207], v[232:235], v[84:87], v[192:207]
  ds_read_b64_tr_b16 v[232:233], v245 offset:14336
  ds_read_b64_tr_b16 v[234:235], v245 offset:14848
  v_mfma_f32_32x32x16_bf16 v[208:223], v[236:239], v[84:87], v[208:223]
  s_barrier
  v_add_u32 v244, 16384, v246
  v_xor_b32 v245, 64, v244
  ds_read_b64_tr_b16 v[236:237], v244 offset:0
  ds_read_b64_tr_b16 v[238:239], v244 offset:512
  s_waitcnt lgkmcnt(6)
  v_mfma_f32_32x32x16_bf16 v[192:207], v[240:243], v[88:91], v[192:207]
  ds_read_b64_tr_b16 v[240:241], v245 offset:0
  ds_read_b64_tr_b16 v[242:243], v245 offset:512
  v_mfma_f32_32x32x16_bf16 v[208:223], v[224:227], v[88:91], v[208:223]
  ds_read_b64_tr_b16 v[224:225], v244 offset:2048
  ds_read_b64_tr_b16 v[226:227], v244 offset:2560
  s_waitcnt lgkmcnt(6)
  v_mfma_f32_32x32x16_bf16 v[192:207], v[228:231], v[92:95], v[192:207]
  ds_read_b64_tr_b16 v[228:229], v245 offset:2048
  ds_read_b64_tr_b16 v[230:231], v245 offset:2560
  v_mfma_f32_32x32x16_bf16 v[208:223], v[232:235], v[92:95], v[208:223]
  ds_read_b64_tr_b16 v[232:233], v244 offset:4096
  ds_read_b64_tr_b16 v[234:235], v244 offset:4608
  s_waitcnt lgkmcnt(6)
  v_mfma_f32_32x32x16_bf16 v[192:207], v[236:239], v[96:99], v[192:207]
  ds_read_b64_tr_b16 v[236:237], v245 offset:4096
  ds_read_b64_tr_b16 v[238:239], v245 offset:4608
  v_mfma_f32_32x32x16_bf16 v[208:223], v[240:243], v[96:99], v[208:223]
  ds_read_b64_tr_b16 v[240:241], v244 offset:6144
  ds_read_b64_tr_b16 v[242:243], v244 offset:6656
  s_waitcnt lgkmcnt(6)
  v_mfma_f32_32x32x16_bf16 v[192:207], v[224:227], v[100:103], v[192:207]
  ds_read_b64_tr_b16 v[224:225], v245 offset:6144
  ds_read_b64_tr_b16 v[226:227], v245 offset:6656
  v_mfma_f32_32x32x16_bf16 v[208:223], v[228:231], v[100:103], v[208:223]
  ds_read_b64_tr_b16 v[228:229], v244 offset:8192
  ds_read_b64_tr_b16 v[230:231], v244 offset:8704
  s_waitcnt lgkmcnt(6)
  v_mfma_f32_32x32x16_bf16 v[192:207], v[232:235], v[104:107], v[192:207]
  ds_read_b64_tr_b16 v[232:233], v245 offset:8192
  ds_read_b64_tr_b16 v[234:235], v245 offset:8704
  v_mfma_f32_32x32x16_bf16 v[208:223], v[236:239], v[104:107], v[208:223]
  ds_read_b64_tr_b16 v[236:237], v244 offset:10240
  ds_read_b64_tr_b16 v[238:239], v244 offset:10752
  s_waitcnt lgkmcnt(6)
  v_mfma_f32_32x32x16_bf16 v[192:207], v[240:243], v[108:111], v[192:207]
  ds_read_b64_tr_b16 v[240:241], v245 offset:10240
  ds_read_b64_tr_b16 v[242:243], v245 offset:10752
  v_mfma_f32_32x32x16_bf16 v[208:223], v[224:227], v[108:111], v[208:223]
  ds_read_b64_tr_b16 v[224:225], v244 offset:12288
  ds_read_b64_tr_b16 v[226:227], v244 offset:12800
  s_waitcnt lgkmcnt(6)
  v_mfma_f32_32x32x16_bf16 v[192:207], v[228:231], v[112:115], v[192:207]
  ds_read_b64_tr_b16 v[228:229], v245 offset:12288
  ds_read_b64_tr_b16 v[230:231], v245 offset:12800
  v_mfma_f32_32x32x16_bf16 v[208:223], v[232:235], v[112:115], v[208:223]
  ds_read_b64_tr_b16 v[232:233], v244 offset:14336
  ds_read_b64_tr_b16 v[234:235], v244 offset:14848
  s_waitcnt lgkmcnt(6)
  v_mfma_f32_32x32x16_bf16 v[192:207], v[236:239], v[116:119], v[192:207]
  ds_read_b64_tr_b16 v[236:237], v245 offset:14336
  ds_read_b64_tr_b16 v[238:239], v245 offset:14848
  v_mfma_f32_32x32x16_bf16 v[208:223], v[240:243], v[116:119], v[208:223]
  s_barrier
  v_add_u32 v244, 32768, v246
  v_xor_b32 v245, 64, v244
  ds_read_b64_tr_b16 v[240:241], v244 offset:0
  ds_read_b64_tr_b16 v[242:243], v244 offset:512
  s_waitcnt lgkmcnt(6)
  v_mfma_f32_32x32x16_bf16 v[192:207], v[224:227], v[120:123], v[192:207]
  ds_read_b64_tr_b16 v[224:225], v245 offset:0
  ds_read_b64_tr_b16 v[226:227], v245 offset:512
  v_mfma_f32_32x32x16_bf16 v[208:223], v[228:231], v[120:123], v[208:223]
  ds_read_b64_tr_b16 v[228:229], v244 offset:2048
  ds_read_b64_tr_b16 v[230:231], v244 offset:2560
  s_waitcnt lgkmcnt(6)
  v_mfma_f32_32x32x16_bf16 v[192:207], v[232:235], v[124:127], v[192:207]
  ds_read_b64_tr_b16 v[232:233], v245 offset:2048
  ds_read_b64_tr_b16 v[234:235], v245 offset:2560
  v_mfma_f32_32x32x16_bf16 v[208:223], v[236:239], v[124:127], v[208:223]
  s_lshl_b32 s82, s26, 3
  s_add_u32 s82, s82, 40
  s_lshl_b32 s81, s25, 2
  s_add_u32 s81, s81, s24
  s_mul_i32 s81, s81, 148
  s_add_u32 s81, s81, s82
  s_lshl_b32 s81, s81, 10
  buffer_store_dwordx4 v[160:163], v247, s[40:43], s81 offen offset:0 sc0 sc1
  ds_read_b64_tr_b16 v[236:237], v244 offset:4096
  ds_read_b64_tr_b16 v[238:239], v244 offset:4608
  s_waitcnt lgkmcnt(6)
  v_mfma_f32_32x32x16_bf16 v[192:207], v[240:243], v[128:131], v[192:207]
  v_cvt_pk_bf16_f32 v168, v168, v169
  v_cvt_pk_bf16_f32 v169, v170, v171
  ds_read_b64_tr_b16 v[240:241], v245 offset:4096
  ds_read_b64_tr_b16 v[242:243], v245 offset:4608
  v_mfma_f32_32x32x16_bf16 v[208:223], v[224:227], v[128:131], v[208:223]
  v_cvt_pk_bf16_f32 v170, v172, v173
  v_cvt_pk_bf16_f32 v171, v174, v175
  ds_read_b64_tr_b16 v[224:225], v244 offset:6144
  ds_read_b64_tr_b16 v[226:227], v244 offset:6656
  s_waitcnt lgkmcnt(6)
  v_mfma_f32_32x32x16_bf16 v[192:207], v[228:231], v[132:135], v[192:207]
  ds_read_b64_tr_b16 v[228:229], v245 offset:6144
  ds_read_b64_tr_b16 v[230:231], v245 offset:6656
  v_mfma_f32_32x32x16_bf16 v[208:223], v[232:235], v[132:135], v[208:223]
  s_lshl_b32 s82, s26, 3
  s_add_u32 s82, s82, 40
  s_lshl_b32 s81, s25, 2
  s_add_u32 s81, s81, s24
  s_mul_i32 s81, s81, 148
  s_add_u32 s81, s81, s82
  s_lshl_b32 s81, s81, 10
  buffer_store_dwordx4 v[168:171], v247, s[40:43], s81 offen offset:1024 sc0 sc1
  ds_read_b64_tr_b16 v[232:233], v244 offset:8192
  ds_read_b64_tr_b16 v[234:235], v244 offset:8704
  s_waitcnt lgkmcnt(6)
  v_mfma_f32_32x32x16_bf16 v[192:207], v[236:239], v[136:139], v[192:207]
  v_cvt_pk_bf16_f32 v176, v176, v177
  v_cvt_pk_bf16_f32 v177, v178, v179
  ds_read_b64_tr_b16 v[236:237], v245 offset:8192
  ds_read_b64_tr_b16 v[238:239], v245 offset:8704
  v_mfma_f32_32x32x16_bf16 v[208:223], v[240:243], v[136:139], v[208:223]
  v_cvt_pk_bf16_f32 v178, v180, v181
  v_cvt_pk_bf16_f32 v179, v182, v183
  ds_read_b64_tr_b16 v[240:241], v244 offset:10240
  ds_read_b64_tr_b16 v[242:243], v244 offset:10752
  s_waitcnt lgkmcnt(6)
  v_mfma_f32_32x32x16_bf16 v[192:207], v[224:227], v[140:143], v[192:207]
  ds_read_b64_tr_b16 v[224:225], v245 offset:10240
  ds_read_b64_tr_b16 v[226:227], v245 offset:10752
  v_mfma_f32_32x32x16_bf16 v[208:223], v[228:231], v[140:143], v[208:223]
  s_lshl_b32 s82, s26, 3
  s_add_u32 s82, s82, 40
  s_lshl_b32 s81, s25, 2
  s_add_u32 s81, s81, s24
  s_mul_i32 s81, s81, 148
  s_add_u32 s81, s81, s82
  s_lshl_b32 s81, s81, 10
  buffer_store_dwordx4 v[176:179], v247, s[40:43], s81 offen offset:2048 sc0 sc1
  ds_read_b64_tr_b16 v[228:229], v244 offset:12288
  ds_read_b64_tr_b16 v[230:231], v244 offset:12800
  s_waitcnt lgkmcnt(6)
  v_mfma_f32_32x32x16_bf16 v[192:207], v[232:235], v[144:147], v[192:207]
  v_cvt_pk_bf16_f32 v184, v184, v185
  v_cvt_pk_bf16_f32 v185, v186, v187
  ds_read_b64_tr_b16 v[232:233], v245 offset:12288
  ds_read_b64_tr_b16 v[234:235], v245 offset:12800
  v_mfma_f32_32x32x16_bf16 v[208:223], v[236:239], v[144:147], v[208:223]
  v_cvt_pk_bf16_f32 v186, v188, v189
  v_cvt_pk_bf16_f32 v187, v190, v191
  ds_read_b64_tr_b16 v[236:237], v244 offset:14336
  ds_read_b64_tr_b16 v[238:239], v244 offset:14848
  s_waitcnt lgkmcnt(6)
  v_mfma_f32_32x32x16_bf16 v[192:207], v[240:243], v[148:151], v[192:207]
  ds_read_b64_tr_b16 v[240:241], v245 offset:14336
  ds_read_b64_tr_b16 v[242:243], v245 offset:14848
  v_mfma_f32_32x32x16_bf16 v[208:223], v[224:227], v[148:151], v[208:223]
  s_lshl_b32 s82, s26, 3
  s_add_u32 s82, s82, 40
  s_lshl_b32 s81, s25, 2
  s_add_u32 s81, s81, s24
  s_mul_i32 s81, s81, 148
  s_add_u32 s81, s81, s82
  s_lshl_b32 s81, s81, 10
  buffer_store_dwordx4 v[184:187], v247, s[40:43], s81 offen offset:3072 sc0 sc1
  s_barrier
  v_add_u32 v244, 49152, v246
  v_xor_b32 v245, 64, v244
  ds_read_b64_tr_b16 v[224:225], v244 offset:0
  ds_read_b64_tr_b16 v[226:227], v244 offset:512
  s_waitcnt lgkmcnt(6)
  v_mfma_f32_32x32x16_bf16 v[192:207], v[228:231], v[152:155], v[192:207]
  ds_read_b64_tr_b16 v[228:229], v245 offset:0
  ds_read_b64_tr_b16 v[230:231], v245 offset:512
  v_mfma_f32_32x32x16_bf16 v[208:223], v[232:235], v[152:155], v[208:223]
  ds_read_b64_tr_b16 v[232:233], v244 offset:2048
  ds_read_b64_tr_b16 v[234:235], v244 offset:2560
  s_waitcnt lgkmcnt(6)
  v_mfma_f32_32x32x16_bf16 v[192:207], v[236:239], v[156:159], v[192:207]
  ds_read_b64_tr_b16 v[236:237], v245 offset:2048
  ds_read_b64_tr_b16 v[238:239], v245 offset:2560
  v_mfma_f32_32x32x16_bf16 v[208:223], v[240:243], v[156:159], v[208:223]
  ds_read_b64_tr_b16 v[240:241], v244 offset:4096
  ds_read_b64_tr_b16 v[242:243], v244 offset:4608
  s_waitcnt lgkmcnt(6)
  v_mfma_f32_32x32x16_bf16 v[160:175], v[224:227], v[0:3], 0
  ds_read_b64_tr_b16 v[224:225], v245 offset:4096
  ds_read_b64_tr_b16 v[226:227], v245 offset:4608
  v_mfma_f32_32x32x16_bf16 v[176:191], v[228:231], v[0:3], 0
  ds_read_b64_tr_b16 v[228:229], v244 offset:6144
  ds_read_b64_tr_b16 v[230:231], v244 offset:6656
  s_waitcnt lgkmcnt(6)
  v_mfma_f32_32x32x16_bf16 v[160:175], v[232:235], v[4:7], v[160:175]
  ds_read_b64_tr_b16 v[232:233], v245 offset:6144
  ds_read_b64_tr_b16 v[234:235], v245 offset:6656
  v_mfma_f32_32x32x16_bf16 v[176:191], v[236:239], v[4:7], v[176:191]
  v_mul_f32 v192, s97, v192
  v_mul_f32 v193, s97, v193
  v_mul_f32 v194, s97, v194
  ds_read_b64_tr_b16 v[236:237], v244 offset:8192
  ds_read_b64_tr_b16 v[238:239], v244 offset:8704
  s_waitcnt lgkmcnt(6)
  v_mfma_f32_32x32x16_bf16 v[160:175], v[240:243], v[8:11], v[160:175]
  v_mul_f32 v195, s97, v195
  v_exp_f32 v192, v192
  ds_read_b64_tr_b16 v[240:241], v245 offset:8192
  ds_read_b64_tr_b16 v[242:243], v245 offset:8704
  v_mfma_f32_32x32x16_bf16 v[176:191], v[224:227], v[8:11], v[176:191]
  v_exp_f32 v193, v193
  ds_read_b64_tr_b16 v[224:225], v244 offset:10240
  ds_read_b64_tr_b16 v[226:227], v244 offset:10752
  s_waitcnt lgkmcnt(6)
  v_mfma_f32_32x32x16_bf16 v[160:175], v[228:231], v[12:15], v[160:175]
  v_exp_f32 v194, v194
  ds_read_b64_tr_b16 v[228:229], v245 offset:10240
  ds_read_b64_tr_b16 v[230:231], v245 offset:10752
  v_mfma_f32_32x32x16_bf16 v[176:191], v[232:235], v[12:15], v[176:191]
  v_exp_f32 v195, v195
  v_add_f32 v192, 1.0, v192
  ds_read_b64_tr_b16 v[232:233], v244 offset:12288
  ds_read_b64_tr_b16 v[234:235], v244 offset:12800
  s_waitcnt lgkmcnt(6)
  v_mfma_f32_32x32x16_bf16 v[160:175], v[236:239], v[16:19], v[160:175]
  v_add_f32 v193, 1.0, v193
  v_add_f32 v194, 1.0, v194
  v_add_f32 v195, 1.0, v195
  ds_read_b64_tr_b16 v[236:237], v245 offset:12288
  ds_read_b64_tr_b16 v[238:239], v245 offset:12800
  v_mfma_f32_32x32x16_bf16 v[176:191], v[240:243], v[16:19], v[176:191]
  v_rcp_f32 v192, v192
  ds_read_b64_tr_b16 v[240:241], v244 offset:14336
  ds_read_b64_tr_b16 v[242:243], v244 offset:14848
  s_waitcnt lgkmcnt(6)
  v_mfma_f32_32x32x16_bf16 v[160:175], v[224:227], v[20:23], v[160:175]
  v_rcp_f32 v193, v193
  ds_read_b64_tr_b16 v[224:225], v245 offset:14336
  ds_read_b64_tr_b16 v[226:227], v245 offset:14848
  v_mfma_f32_32x32x16_bf16 v[176:191], v[228:231], v[20:23], v[176:191]
  v_rcp_f32 v194, v194
  s_barrier
  v_add_u32 v244, 65536, v246
  v_xor_b32 v245, 64, v244
  ds_read_b64_tr_b16 v[228:229], v244 offset:0
  ds_read_b64_tr_b16 v[230:231], v244 offset:512
  s_waitcnt lgkmcnt(6)
  v_mfma_f32_32x32x16_bf16 v[160:175], v[232:235], v[24:27], v[160:175]
  v_rcp_f32 v195, v195
  v_mul_f32 v196, s97, v196
  ds_read_b64_tr_b16 v[232:233], v245 offset:0
  ds_read_b64_tr_b16 v[234:235], v245 offset:512
  v_mfma_f32_32x32x16_bf16 v[176:191], v[236:239], v[24:27], v[176:191]
  v_mul_f32 v197, s97, v197
  v_mul_f32 v198, s97, v198
  v_mul_f32 v199, s97, v199
  ds_read_b64_tr_b16 v[236:237], v244 offset:2048
  ds_read_b64_tr_b16 v[238:239], v244 offset:2560
  s_waitcnt lgkmcnt(6)
  v_mfma_f32_32x32x16_bf16 v[160:175], v[240:243], v[28:31], v[160:175]
  v_exp_f32 v196, v196
  ds_read_b64_tr_b16 v[240:241], v245 offset:2048
  ds_read_b64_tr_b16 v[242:243], v245 offset:2560
  v_mfma_f32_32x32x16_bf16 v[176:191], v[224:227], v[28:31], v[176:191]
  v_exp_f32 v197, v197
  ds_read_b64_tr_b16 v[224:225], v244 offset:4096
  ds_read_b64_tr_b16 v[226:227], v244 offset:4608
  s_waitcnt lgkmcnt(6)
  v_mfma_f32_32x32x16_bf16 v[160:175], v[228:231], v[32:35], v[160:175]
  v_exp_f32 v198, v198
  ds_read_b64_tr_b16 v[228:229], v245 offset:4096
  ds_read_b64_tr_b16 v[230:231], v245 offset:4608
  v_mfma_f32_32x32x16_bf16 v[176:191], v[232:235], v[32:35], v[176:191]
  v_exp_f32 v199, v199
  v_add_f32 v196, 1.0, v196
  ds_read_b64_tr_b16 v[232:233], v244 offset:6144
  ds_read_b64_tr_b16 v[234:235], v244 offset:6656
  s_waitcnt lgkmcnt(6)
  v_mfma_f32_32x32x16_bf16 v[160:175], v[236:239], v[36:39], v[160:175]
  v_add_f32 v197, 1.0, v197
  v_add_f32 v198, 1.0, v198
  v_add_f32 v199, 1.0, v199
  ds_read_b64_tr_b16 v[236:237], v245 offset:6144
  ds_read_b64_tr_b16 v[238:239], v245 offset:6656
  v_mfma_f32_32x32x16_bf16 v[176:191], v[240:243], v[36:39], v[176:191]
  v_rcp_f32 v196, v196
  ds_read_b64_tr_b16 v[240:241], v244 offset:8192
  ds_read_b64_tr_b16 v[242:243], v244 offset:8704
  s_waitcnt lgkmcnt(6)
  v_mfma_f32_32x32x16_bf16 v[160:175], v[224:227], v[40:43], v[160:175]
  v_rcp_f32 v197, v197
  ds_read_b64_tr_b16 v[224:225], v245 offset:8192
  ds_read_b64_tr_b16 v[226:227], v245 offset:8704
  v_mfma_f32_32x32x16_bf16 v[176:191], v[228:231], v[40:43], v[176:191]
  v_rcp_f32 v198, v198
  ds_read_b64_tr_b16 v[228:229], v244 offset:10240
  ds_read_b64_tr_b16 v[230:231], v244 offset:10752
  s_waitcnt lgkmcnt(6)
  v_mfma_f32_32x32x16_bf16 v[160:175], v[232:235], v[44:47], v[160:175]
  v_rcp_f32 v199, v199
  v_mul_f32 v200, s97, v200
  ds_read_b64_tr_b16 v[232:233], v245 offset:10240
  ds_read_b64_tr_b16 v[234:235], v245 offset:10752
  v_mfma_f32_32x32x16_bf16 v[176:191], v[236:239], v[44:47], v[176:191]
  v_mul_f32 v201, s97, v201
  v_mul_f32 v202, s97, v202
  v_mul_f32 v203, s97, v203
  ds_read_b64_tr_b16 v[236:237], v244 offset:12288
  ds_read_b64_tr_b16 v[238:239], v244 offset:12800
  s_waitcnt lgkmcnt(6)
  v_mfma_f32_32x32x16_bf16 v[160:175], v[240:243], v[48:51], v[160:175]
  v_exp_f32 v200, v200
  ds_read_b64_tr_b16 v[240:241], v245 offset:12288
  ds_read_b64_tr_b16 v[242:243], v245 offset:12800
  v_mfma_f32_32x32x16_bf16 v[176:191], v[224:227], v[48:51], v[176:191]
  v_exp_f32 v201, v201
  ds_read_b64_tr_b16 v[224:225], v244 offset:14336
  ds_read_b64_tr_b16 v[226:227], v244 offset:14848
  s_waitcnt lgkmcnt(6)
  v_mfma_f32_32x32x16_bf16 v[160:175], v[228:231], v[52:55], v[160:175]
  v_exp_f32 v202, v202
  ds_read_b64_tr_b16 v[228:229], v245 offset:14336
  ds_read_b64_tr_b16 v[230:231], v245 offset:14848
  v_mfma_f32_32x32x16_bf16 v[176:191], v[232:235], v[52:55], v[176:191]
  v_exp_f32 v203, v203
  v_add_f32 v200, 1.0, v200
  s_barrier
  v_add_u32 v244, 81920, v246
  v_xor_b32 v245, 64, v244
  ds_read_b64_tr_b16 v[232:233], v244 offset:0
  ds_read_b64_tr_b16 v[234:235], v244 offset:512
  s_waitcnt lgkmcnt(6)
  v_mfma_f32_32x32x16_bf16 v[160:175], v[236:239], v[56:59], v[160:175]
  v_add_f32 v201, 1.0, v201
  v_add_f32 v202, 1.0, v202
  v_add_f32 v203, 1.0, v203
  ds_read_b64_tr_b16 v[236:237], v245 offset:0
  ds_read_b64_tr_b16 v[238:239], v245 offset:512
  v_mfma_f32_32x32x16_bf16 v[176:191], v[240:243], v[56:59], v[176:191]
  v_rcp_f32 v200, v200
  ds_read_b64_tr_b16 v[240:241], v244 offset:2048
  ds_read_b64_tr_b16 v[242:243], v244 offset:2560
  s_waitcnt lgkmcnt(6)
  v_mfma_f32_32x32x16_bf16 v[160:175], v[224:227], v[60:63], v[160:175]
  v_rcp_f32 v201, v201
  ds_read_b64_tr_b16 v[224:225], v245 offset:2048
  ds_read_b64_tr_b16 v[226:227], v245 offset:2560
  v_mfma_f32_32x32x16_bf16 v[176:191], v[228:231], v[60:63], v[176:191]
  v_rcp_f32 v202, v202
  ds_read_b64_tr_b16 v[228:229], v244 offset:4096
  ds_read_b64_tr_b16 v[230:231], v244 offset:4608
  s_waitcnt lgkmcnt(6)
  v_mfma_f32_32x32x16_bf16 v[160:175], v[232:235], v[64:67], v[160:175]
  v_rcp_f32 v203, v203
  v_mul_f32 v204, s97, v204
  ds_read_b64_tr_b16 v[232:233], v245 offset:4096
  ds_read_b64_tr_b16 v[234:235], v245 offset:4608
  v_mfma_f32_32x32x16_bf16 v[176:191], v[236:239], v[64:67], v[176:191]
  v_mul_f32 v205, s97, v205
  v_mul_f32 v206, s97, v206
  v_mul_f32 v207, s97, v207
  ds_read_b64_tr_b16 v[236:237], v244 offset:6144
  ds_read_b64_tr_b16 v[238:239], v244 offset:6656
  s_waitcnt lgkmcnt(6)
  v_mfma_f32_32x32x16_bf16 v[160:175], v[240:243], v[68:71], v[160:175]
  v_exp_f32 v204, v204
  ds_read_b64_tr_b16 v[240:241], v245 offset:6144
  ds_read_b64_tr_b16 v[242:243], v245 offset:6656
  v_mfma_f32_32x32x16_bf16 v[176:191], v[224:227], v[68:71], v[176:191]
  v_exp_f32 v205, v205
  ds_read_b64_tr_b16 v[224:225], v244 offset:8192
  ds_read_b64_tr_b16 v[226:227], v244 offset:8704
  s_waitcnt lgkmcnt(6)
  v_mfma_f32_32x32x16_bf16 v[160:175], v[228:231], v[72:75], v[160:175]
  v_exp_f32 v206, v206
  ds_read_b64_tr_b16 v[228:229], v245 offset:8192
  ds_read_b64_tr_b16 v[230:231], v245 offset:8704
  v_mfma_f32_32x32x16_bf16 v[176:191], v[232:235], v[72:75], v[176:191]
  v_exp_f32 v207, v207
  v_add_f32 v204, 1.0, v204
  ds_read_b64_tr_b16 v[232:233], v244 offset:10240
  ds_read_b64_tr_b16 v[234:235], v244 offset:10752
  s_waitcnt lgkmcnt(6)
  v_mfma_f32_32x32x16_bf16 v[160:175], v[236:239], v[76:79], v[160:175]
  v_add_f32 v205, 1.0, v205
  v_add_f32 v206, 1.0, v206
  v_add_f32 v207, 1.0, v207
  ds_read_b64_tr_b16 v[236:237], v245 offset:10240
  ds_read_b64_tr_b16 v[238:239], v245 offset:10752
  v_mfma_f32_32x32x16_bf16 v[176:191], v[240:243], v[76:79], v[176:191]
  v_rcp_f32 v204, v204
  ds_read_b64_tr_b16 v[240:241], v244 offset:12288
  ds_read_b64_tr_b16 v[242:243], v244 offset:12800
  s_waitcnt lgkmcnt(6)
  v_mfma_f32_32x32x16_bf16 v[160:175], v[224:227], v[80:83], v[160:175]
  v_rcp_f32 v205, v205
  ds_read_b64_tr_b16 v[224:225], v245 offset:12288
  ds_read_b64_tr_b16 v[226:227], v245 offset:12800
  v_mfma_f32_32x32x16_bf16 v[176:191], v[228:231], v[80:83], v[176:191]
  v_rcp_f32 v206, v206
  ds_read_b64_tr_b16 v[228:229], v244 offset:14336
  ds_read_b64_tr_b16 v[230:231], v244 offset:14848
  s_waitcnt lgkmcnt(6)
  v_mfma_f32_32x32x16_bf16 v[160:175], v[232:235], v[84:87], v[160:175]
  v_rcp_f32 v207, v207
  v_mul_f32 v208, s97, v208
  ds_read_b64_tr_b16 v[232:233], v245 offset:14336
  ds_read_b64_tr_b16 v[234:235], v245 offset:14848
  v_mfma_f32_32x32x16_bf16 v[176:191], v[236:239], v[84:87], v[176:191]
  v_mul_f32 v209, s97, v209
  v_mul_f32 v210, s97, v210
  v_mul_f32 v211, s97, v211
  s_barrier
  v_add_u32 v244, 98304, v246
  v_xor_b32 v245, 64, v244
  ds_read_b64_tr_b16 v[236:237], v244 offset:0
  ds_read_b64_tr_b16 v[238:239], v244 offset:512
  s_waitcnt lgkmcnt(6)
  v_mfma_f32_32x32x16_bf16 v[160:175], v[240:243], v[88:91], v[160:175]
  v_exp_f32 v208, v208
  ds_read_b64_tr_b16 v[240:241], v245 offset:0
  ds_read_b64_tr_b16 v[242:243], v245 offset:512
  v_mfma_f32_32x32x16_bf16 v[176:191], v[224:227], v[88:91], v[176:191]
  v_exp_f32 v209, v209
  ds_read_b64_tr_b16 v[224:225], v244 offset:2048
  ds_read_b64_tr_b16 v[226:227], v244 offset:2560
  s_waitcnt lgkmcnt(6)
  v_mfma_f32_32x32x16_bf16 v[160:175], v[228:231], v[92:95], v[160:175]
  v_exp_f32 v210, v210
  ds_read_b64_tr_b16 v[228:229], v245 offset:2048
  ds_read_b64_tr_b16 v[230:231], v245 offset:2560
  v_mfma_f32_32x32x16_bf16 v[176:191], v[232:235], v[92:95], v[176:191]
  v_exp_f32 v211, v211
  v_add_f32 v208, 1.0, v208
  ds_read_b64_tr_b16 v[232:233], v244 offset:4096
  ds_read_b64_tr_b16 v[234:235], v244 offset:4608
  s_waitcnt lgkmcnt(6)
  v_mfma_f32_32x32x16_bf16 v[160:175], v[236:239], v[96:99], v[160:175]
  v_add_f32 v209, 1.0, v209
  v_add_f32 v210, 1.0, v210
  v_add_f32 v211, 1.0, v211
  ds_read_b64_tr_b16 v[236:237], v245 offset:4096
  ds_read_b64_tr_b16 v[238:239], v245 offset:4608
  v_mfma_f32_32x32x16_bf16 v[176:191], v[240:243], v[96:99], v[176:191]
  v_rcp_f32 v208, v208
  ds_read_b64_tr_b16 v[240:241], v244 offset:6144
  ds_read_b64_tr_b16 v[242:243], v244 offset:6656
  s_waitcnt lgkmcnt(6)
  v_mfma_f32_32x32x16_bf16 v[160:175], v[224:227], v[100:103], v[160:175]
  v_rcp_f32 v209, v209
  ds_read_b64_tr_b16 v[224:225], v245 offset:6144
  ds_read_b64_tr_b16 v[226:227], v245 offset:6656
  v_mfma_f32_32x32x16_bf16 v[176:191], v[228:231], v[100:103], v[176:191]
  v_rcp_f32 v210, v210
  ds_read_b64_tr_b16 v[228:229], v244 offset:8192
  ds_read_b64_tr_b16 v[230:231], v244 offset:8704
  s_waitcnt lgkmcnt(6)
  v_mfma_f32_32x32x16_bf16 v[160:175], v[232:235], v[104:107], v[160:175]
  v_rcp_f32 v211, v211
  v_mul_f32 v212, s97, v212
  ds_read_b64_tr_b16 v[232:233], v245 offset:8192
  ds_read_b64_tr_b16 v[234:235], v245 offset:8704
  v_mfma_f32_32x32x16_bf16 v[176:191], v[236:239], v[104:107], v[176:191]
  v_mul_f32 v213, s97, v213
  v_mul_f32 v214, s97, v214
  v_mul_f32 v215, s97, v215
  ds_read_b64_tr_b16 v[236:237], v244 offset:10240
  ds_read_b64_tr_b16 v[238:239], v244 offset:10752
  s_waitcnt lgkmcnt(6)
  v_mfma_f32_32x32x16_bf16 v[160:175], v[240:243], v[108:111], v[160:175]
  v_exp_f32 v212, v212
  ds_read_b64_tr_b16 v[240:241], v245 offset:10240
  ds_read_b64_tr_b16 v[242:243], v245 offset:10752
  v_mfma_f32_32x32x16_bf16 v[176:191], v[224:227], v[108:111], v[176:191]
  v_exp_f32 v213, v213
  ds_read_b64_tr_b16 v[224:225], v244 offset:12288
  ds_read_b64_tr_b16 v[226:227], v244 offset:12800
  s_waitcnt lgkmcnt(6)
  v_mfma_f32_32x32x16_bf16 v[160:175], v[228:231], v[112:115], v[160:175]
  v_exp_f32 v214, v214
  ds_read_b64_tr_b16 v[228:229], v245 offset:12288
  ds_read_b64_tr_b16 v[230:231], v245 offset:12800
  v_mfma_f32_32x32x16_bf16 v[176:191], v[232:235], v[112:115], v[176:191]
  v_exp_f32 v215, v215
  v_add_f32 v212, 1.0, v212
  ds_read_b64_tr_b16 v[232:233], v244 offset:14336
  ds_read_b64_tr_b16 v[234:235], v244 offset:14848
  s_waitcnt lgkmcnt(6)
  v_mfma_f32_32x32x16_bf16 v[160:175], v[236:239], v[116:119], v[160:175]
  v_add_f32 v213, 1.0, v213
  v_add_f32 v214, 1.0, v214
  v_add_f32 v215, 1.0, v215
  ds_read_b64_tr_b16 v[236:237], v245 offset:14336
  ds_read_b64_tr_b16 v[238:239], v245 offset:14848
  v_mfma_f32_32x32x16_bf16 v[176:191], v[240:243], v[116:119], v[176:191]
  v_rcp_f32 v212, v212
  s_barrier
  v_add_u32 v244, 0, v246
  v_xor_b32 v245, 64, v244
  ds_read_b64_tr_b16 v[240:241], v244 offset:0
  ds_read_b64_tr_b16 v[242:243], v244 offset:512
  s_waitcnt lgkmcnt(6)
  v_mfma_f32_32x32x16_bf16 v[160:175], v[224:227], v[120:123], v[160:175]
  v_rcp_f32 v213, v213
  ds_read_b64_tr_b16 v[224:225], v245 offset:0
  ds_read_b64_tr_b16 v[226:227], v245 offset:512
  v_mfma_f32_32x32x16_bf16 v[176:191], v[228:231], v[120:123], v[176:191]
  v_rcp_f32 v214, v214
  ds_read_b64_tr_b16 v[228:229], v244 offset:2048
  ds_read_b64_tr_b16 v[230:231], v244 offset:2560
  s_waitcnt lgkmcnt(6)
  v_mfma_f32_32x32x16_bf16 v[160:175], v[232:235], v[124:127], v[160:175]
  v_rcp_f32 v215, v215
  v_mul_f32 v216, s97, v216
  ds_read_b64_tr_b16 v[232:233], v245 offset:2048
  ds_read_b64_tr_b16 v[234:235], v245 offset:2560
  v_mfma_f32_32x32x16_bf16 v[176:191], v[236:239], v[124:127], v[176:191]
  v_mul_f32 v217, s97, v217
  v_mul_f32 v218, s97, v218
  v_mul_f32 v219, s97, v219
  ds_read_b64_tr_b16 v[236:237], v244 offset:4096
  ds_read_b64_tr_b16 v[238:239], v244 offset:4608
  s_waitcnt lgkmcnt(6)
  v_mfma_f32_32x32x16_bf16 v[160:175], v[240:243], v[128:131], v[160:175]
  v_exp_f32 v216, v216
  ds_read_b64_tr_b16 v[240:241], v245 offset:4096
  ds_read_b64_tr_b16 v[242:243], v245 offset:4608
  v_mfma_f32_32x32x16_bf16 v[176:191], v[224:227], v[128:131], v[176:191]
  v_exp_f32 v217, v217
  ds_read_b64_tr_b16 v[224:225], v244 offset:6144
  ds_read_b64_tr_b16 v[226:227], v244 offset:6656
  s_waitcnt lgkmcnt(6)
  v_mfma_f32_32x32x16_bf16 v[160:175], v[228:231], v[132:135], v[160:175]
  v_exp_f32 v218, v218
  ds_read_b64_tr_b16 v[228:229], v245 offset:6144
  ds_read_b64_tr_b16 v[230:231], v245 offset:6656
  v_mfma_f32_32x32x16_bf16 v[176:191], v[232:235], v[132:135], v[176:191]
  v_exp_f32 v219, v219
  v_add_f32 v216, 1.0, v216
  ds_read_b64_tr_b16 v[232:233], v244 offset:8192
  ds_read_b64_tr_b16 v[234:235], v244 offset:8704
  s_waitcnt lgkmcnt(6)
  v_mfma_f32_32x32x16_bf16 v[160:175], v[236:239], v[136:139], v[160:175]
  v_add_f32 v217, 1.0, v217
  v_add_f32 v218, 1.0, v218
  v_add_f32 v219, 1.0, v219
  ds_read_b64_tr_b16 v[236:237], v245 offset:8192
  ds_read_b64_tr_b16 v[238:239], v245 offset:8704
  v_mfma_f32_32x32x16_bf16 v[176:191], v[240:243], v[136:139], v[176:191]
  v_rcp_f32 v216, v216
  ds_read_b64_tr_b16 v[240:241], v244 offset:10240
  ds_read_b64_tr_b16 v[242:243], v244 offset:10752
  s_waitcnt lgkmcnt(6)
  v_mfma_f32_32x32x16_bf16 v[160:175], v[224:227], v[140:143], v[160:175]
  v_rcp_f32 v217, v217
  ds_read_b64_tr_b16 v[224:225], v245 offset:10240
  ds_read_b64_tr_b16 v[226:227], v245 offset:10752
  v_mfma_f32_32x32x16_bf16 v[176:191], v[228:231], v[140:143], v[176:191]
  v_rcp_f32 v218, v218
  ds_read_b64_tr_b16 v[228:229], v244 offset:12288
  ds_read_b64_tr_b16 v[230:231], v244 offset:12800
  s_waitcnt lgkmcnt(6)
  v_mfma_f32_32x32x16_bf16 v[160:175], v[232:235], v[144:147], v[160:175]
  v_rcp_f32 v219, v219
  v_mul_f32 v220, s97, v220
  ds_read_b64_tr_b16 v[232:233], v245 offset:12288
  ds_read_b64_tr_b16 v[234:235], v245 offset:12800
  v_mfma_f32_32x32x16_bf16 v[176:191], v[236:239], v[144:147], v[176:191]
  v_mul_f32 v221, s97, v221
  v_mul_f32 v222, s97, v222
  v_mul_f32 v223, s97, v223
  ds_read_b64_tr_b16 v[236:237], v244 offset:14336
  ds_read_b64_tr_b16 v[238:239], v244 offset:14848
  s_waitcnt lgkmcnt(6)
  v_mfma_f32_32x32x16_bf16 v[160:175], v[240:243], v[148:151], v[160:175]
  v_exp_f32 v220, v220
  ds_read_b64_tr_b16 v[240:241], v245 offset:14336
  ds_read_b64_tr_b16 v[242:243], v245 offset:14848
  v_mfma_f32_32x32x16_bf16 v[176:191], v[224:227], v[148:151], v[176:191]
  v_exp_f32 v221, v221
  v_exp_f32 v222, v222
  s_waitcnt lgkmcnt(4)
  v_mfma_f32_32x32x16_bf16 v[160:175], v[228:231], v[152:155], v[160:175]
  v_exp_f32 v223, v223
  v_add_f32 v220, 1.0, v220
  v_add_f32 v221, 1.0, v221
  v_mfma_f32_32x32x16_bf16 v[176:191], v[232:235], v[152:155], v[176:191]
  v_add_f32 v222, 1.0, v222
  v_add_f32 v223, 1.0, v223
  v_rcp_f32 v220, v220
  s_waitcnt lgkmcnt(0)
  v_mfma_f32_32x32x16_bf16 v[160:175], v[236:239], v[156:159], v[160:175]
  v_rcp_f32 v221, v221
  v_rcp_f32 v222, v222
  v_rcp_f32 v223, v223
  v_mfma_f32_32x32x16_bf16 v[176:191], v[240:243], v[156:159], v[176:191]
  s_nop 3
  s_nop 7
  v_mul_f32 v160, v160, v192
  v_mul_f32 v161, v161, v193
  v_mul_f32 v162, v162, v194
  v_mul_f32 v163, v163, v195
  v_mul_f32 v164, v164, v196
  v_mul_f32 v165, v165, v197
  v_mul_f32 v166, v166, v198
  v_mul_f32 v167, v167, v199
  v_mul_f32 v168, v168, v200
  v_mul_f32 v169, v169, v201
  v_mul_f32 v170, v170, v202
  v_mul_f32 v171, v171, v203
  v_mul_f32 v172, v172, v204
  v_mul_f32 v173, v173, v205
  v_mul_f32 v174, v174, v206
  v_mul_f32 v175, v175, v207
  v_mul_f32 v176, v176, v208
  v_mul_f32 v177, v177, v209
  v_mul_f32 v178, v178, v210
  v_mul_f32 v179, v179, v211
  v_mul_f32 v180, v180, v212
  v_mul_f32 v181, v181, v213
  v_mul_f32 v182, v182, v214
  v_mul_f32 v183, v183, v215
  v_mul_f32 v184, v184, v216
  v_mul_f32 v185, v185, v217
  v_mul_f32 v186, v186, v218
  v_mul_f32 v187, v187, v219
  v_mul_f32 v188, v188, v220
  v_mul_f32 v189, v189, v221
  v_mul_f32 v190, v190, v222
  v_mul_f32 v191, v191, v223
  v_cvt_pk_bf16_f32 v160, v160, v161
  v_cvt_pk_bf16_f32 v161, v162, v163
  v_cvt_pk_bf16_f32 v162, v164, v165
  v_cvt_pk_bf16_f32 v163, v166, v167
  s_lshl_b32 s82, s26, 3
  s_add_u32 s82, s82, 44
  s_lshl_b32 s81, s25, 2
  s_add_u32 s81, s81, s24
  s_mul_i32 s81, s81, 148
  s_add_u32 s81, s81, s82
  s_lshl_b32 s81, s81, 10
  buffer_store_dwordx4 v[160:163], v247, s[40:43], s81 offen offset:0 sc0 sc1
  v_cvt_pk_bf16_f32 v168, v168, v169
  v_cvt_pk_bf16_f32 v169, v170, v171
  v_cvt_pk_bf16_f32 v170, v172, v173
  v_cvt_pk_bf16_f32 v171, v174, v175
  s_lshl_b32 s82, s26, 3
  s_add_u32 s82, s82, 44
  s_lshl_b32 s81, s25, 2
  s_add_u32 s81, s81, s24
  s_mul_i32 s81, s81, 148
  s_add_u32 s81, s81, s82
  s_lshl_b32 s81, s81, 10
  buffer_store_dwordx4 v[168:171], v247, s[40:43], s81 offen offset:1024 sc0 sc1
  v_cvt_pk_bf16_f32 v176, v176, v177
  v_cvt_pk_bf16_f32 v177, v178, v179
  v_cvt_pk_bf16_f32 v178, v180, v181
  v_cvt_pk_bf16_f32 v179, v182, v183
  s_lshl_b32 s82, s26, 3
  s_add_u32 s82, s82, 44
  s_lshl_b32 s81, s25, 2
  s_add_u32 s81, s81, s24
  s_mul_i32 s81, s81, 148
  s_add_u32 s81, s81, s82
  s_lshl_b32 s81, s81, 10
  buffer_store_dwordx4 v[176:179], v247, s[40:43], s81 offen offset:2048 sc0 sc1
  v_cvt_pk_bf16_f32 v184, v184, v185
  v_cvt_pk_bf16_f32 v185, v186, v187
  v_cvt_pk_bf16_f32 v186, v188, v189
  v_cvt_pk_bf16_f32 v187, v190, v191
  s_lshl_b32 s82, s26, 3
  s_add_u32 s82, s82, 44
  s_lshl_b32 s81, s25, 2
  s_add_u32 s81, s81, s24
  s_mul_i32 s81, s81, 148
  s_add_u32 s81, s81, s82
  s_lshl_b32 s81, s81, 10
  buffer_store_dwordx4 v[184:187], v247, s[40:43], s81 offen offset:3072 sc0 sc1
  s_endpgm
front_kernel_ckv:
  s_barrier
  v_add_u32 v244, 0, v255
  ds_read_b64_tr_b16 v[224:225], v244 offset:0
  ds_read_b64_tr_b16 v[226:227], v244 offset:768
  ds_read_b64_tr_b16 v[228:229], v244 offset:64
  ds_read_b64_tr_b16 v[230:231], v244 offset:832
  ds_read_b64_tr_b16 v[232:233], v244 offset:128
  ds_read_b64_tr_b16 v[234:235], v244 offset:896
  ds_read_b64_tr_b16 v[236:237], v244 offset:3072
  ds_read_b64_tr_b16 v[238:239], v244 offset:3840
  ds_read_b64_tr_b16 v[240:241], v244 offset:3136
  ds_read_b64_tr_b16 v[242:243], v244 offset:3904
  s_waitcnt vmcnt(7)
  s_waitcnt lgkmcnt(6)
  v_mfma_f32_32x32x16_bf16 v[160:175], v[0:3], v[224:227], 0
  ds_read_b64_tr_b16 v[224:225], v244 offset:3200
  ds_read_b64_tr_b16 v[226:227], v244 offset:3968
  v_mfma_f32_32x32x16_bf16 v[176:191], v[0:3], v[228:231], 0
  s_add_u32 s72, s72, 4096
  buffer_load_dwordx4 v[32:35], v247, s[28:31], s72 offen offset:0
  ds_read_b64_tr_b16 v[228:229], v244 offset:6144
  ds_read_b64_tr_b16 v[230:231], v244 offset:6912
  s_waitcnt lgkmcnt(6)
  v_mfma_f32_32x32x16_bf16 v[192:207], v[0:3], v[232:235], 0
  ds_read_b64_tr_b16 v[232:233], v244 offset:6208
  ds_read_b64_tr_b16 v[234:235], v244 offset:6976
  s_waitcnt vmcnt(7)
  v_mfma_f32_32x32x16_bf16 v[160:175], v[4:7], v[236:239], v[160:175]
  buffer_load_dwordx4 v[36:39], v247, s[28:31], s72 offen offset:1024
  ds_read_b64_tr_b16 v[236:237], v244 offset:6272
  ds_read_b64_tr_b16 v[238:239], v244 offset:7040
  s_waitcnt lgkmcnt(6)
  v_mfma_f32_32x32x16_bf16 v[176:191], v[4:7], v[240:243], v[176:191]
  ds_read_b64_tr_b16 v[240:241], v244 offset:9216
  ds_read_b64_tr_b16 v[242:243], v244 offset:9984
  v_mfma_f32_32x32x16_bf16 v[192:207], v[4:7], v[224:227], v[192:207]
  buffer_load_dwordx4 v[40:43], v247, s[28:31], s72 offen offset:2048
  ds_read_b64_tr_b16 v[224:225], v244 offset:9280
  ds_read_b64_tr_b16 v[226:227], v244 offset:10048
  s_waitcnt vmcnt(8)
  s_waitcnt lgkmcnt(6)
  v_mfma_f32_32x32x16_bf16 v[160:175], v[8:11], v[228:231], v[160:175]
  ds_read_b64_tr_b16 v[228:229], v244 offset:9344
  ds_read_b64_tr_b16 v[230:231], v244 offset:10112
  v_mfma_f32_32x32x16_bf16 v[176:191], v[8:11], v[232:235], v[176:191]
  buffer_load_dwordx4 v[44:47], v247, s[28:31], s72 offen offset:3072
  ds_read_b64_tr_b16 v[232:233], v244 offset:12288
  ds_read_b64_tr_b16 v[234:235], v244 offset:13056
  s_waitcnt lgkmcnt(6)
  v_mfma_f32_32x32x16_bf16 v[192:207], v[8:11], v[236:239], v[192:207]
  ds_read_b64_tr_b16 v[236:237], v244 offset:12352
  ds_read_b64_tr_b16 v[238:239], v244 offset:13120
  s_waitcnt vmcnt(8)
  v_mfma_f32_32x32x16_bf16 v[160:175], v[12:15], v[240:243], v[160:175]
  s_add_u32 s72, s72, 4096
  buffer_load_dwordx4 v[48:51], v247, s[28:31], s72 offen offset:0
  ds_read_b64_tr_b16 v[240:241], v244 offset:12416
  ds_read_b64_tr_b16 v[242:243], v244 offset:13184
  s_waitcnt lgkmcnt(6)
  v_mfma_f32_32x32x16_bf16 v[176:191], v[12:15], v[224:227], v[176:191]
  ds_read_b64_tr_b16 v[224:225], v244 offset:15360
  ds_read_b64_tr_b16 v[226:227], v244 offset:16128
  v_mfma_f32_32x32x16_bf16 v[192:207], v[12:15], v[228:231], v[192:207]
  buffer_load_dwordx4 v[52:55], v247, s[28:31], s72 offen offset:1024
  ds_read_b64_tr_b16 v[228:229], v244 offset:15424
  ds_read_b64_tr_b16 v[230:231], v244 offset:16192
  s_waitcnt vmcnt(9)
  s_waitcnt lgkmcnt(6)
  v_mfma_f32_32x32x16_bf16 v[160:175], v[16:19], v[232:235], v[160:175]
  ds_read_b64_tr_b16 v[232:233], v244 offset:15488
  ds_read_b64_tr_b16 v[234:235], v244 offset:16256
  v_mfma_f32_32x32x16_bf16 v[176:191], v[16:19], v[236:239], v[176:191]
  buffer_load_dwordx4 v[56:59], v247, s[28:31], s72 offen offset:2048
  ds_read_b64_tr_b16 v[236:237], v244 offset:18432
  ds_read_b64_tr_b16 v[238:239], v244 offset:19200
  s_waitcnt lgkmcnt(6)
  v_mfma_f32_32x32x16_bf16 v[192:207], v[16:19], v[240:243], v[192:207]
  ds_read_b64_tr_b16 v[240:241], v244 offset:18496
  ds_read_b64_tr_b16 v[242:243], v244 offset:19264
  s_waitcnt vmcnt(9)
  v_mfma_f32_32x32x16_bf16 v[160:175], v[20:23], v[224:227], v[160:175]
  buffer_load_dwordx4 v[60:63], v247, s[28:31], s72 offen offset:3072
  ds_read_b64_tr_b16 v[224:225], v244 offset:18560
  ds_read_b64_tr_b16 v[226:227], v244 offset:19328
  s_waitcnt lgkmcnt(6)
  v_mfma_f32_32x32x16_bf16 v[176:191], v[20:23], v[228:231], v[176:191]
  ds_read_b64_tr_b16 v[228:229], v244 offset:21504
  ds_read_b64_tr_b16 v[230:231], v244 offset:22272
  v_mfma_f32_32x32x16_bf16 v[192:207], v[20:23], v[232:235], v[192:207]
  s_add_u32 s72, s72, 4096
  buffer_load_dwordx4 v[64:67], v247, s[28:31], s72 offen offset:0
  ds_read_b64_tr_b16 v[232:233], v244 offset:21568
  ds_read_b64_tr_b16 v[234:235], v244 offset:22336
  s_waitcnt vmcnt(10)
  s_waitcnt lgkmcnt(6)
  v_mfma_f32_32x32x16_bf16 v[160:175], v[24:27], v[236:239], v[160:175]
  ds_read_b64_tr_b16 v[236:237], v244 offset:21632
  ds_read_b64_tr_b16 v[238:239], v244 offset:22400
  v_mfma_f32_32x32x16_bf16 v[176:191], v[24:27], v[240:243], v[176:191]
  buffer_load_dwordx4 v[68:71], v247, s[28:31], s72 offen offset:1024
  s_barrier
  v_add_u32 v244, 24576, v255
  ds_read_b64_tr_b16 v[240:241], v244 offset:0
  ds_read_b64_tr_b16 v[242:243], v244 offset:768
  s_waitcnt lgkmcnt(6)
  v_mfma_f32_32x32x16_bf16 v[192:207], v[24:27], v[224:227], v[192:207]
  ds_read_b64_tr_b16 v[224:225], v244 offset:64
  ds_read_b64_tr_b16 v[226:227], v244 offset:832
  s_waitcnt vmcnt(10)
  v_mfma_f32_32x32x16_bf16 v[160:175], v[28:31], v[228:231], v[160:175]
  buffer_load_dwordx4 v[72:75], v247, s[28:31], s72 offen offset:2048
  ds_read_b64_tr_b16 v[228:229], v244 offset:128
  ds_read_b64_tr_b16 v[230:231], v244 offset:896
  s_waitcnt lgkmcnt(6)
  v_mfma_f32_32x32x16_bf16 v[176:191], v[28:31], v[232:235], v[176:191]
  ds_read_b64_tr_b16 v[232:233], v244 offset:3072
  ds_read_b64_tr_b16 v[234:235], v244 offset:3840
  v_mfma_f32_32x32x16_bf16 v[192:207], v[28:31], v[236:239], v[192:207]
  buffer_load_dwordx4 v[76:79], v247, s[28:31], s72 offen offset:3072
  ds_read_b64_tr_b16 v[236:237], v244 offset:3136
  ds_read_b64_tr_b16 v[238:239], v244 offset:3904
  s_waitcnt vmcnt(11)
  s_waitcnt lgkmcnt(6)
  v_mfma_f32_32x32x16_bf16 v[160:175], v[32:35], v[240:243], v[160:175]
  ds_read_b64_tr_b16 v[240:241], v244 offset:3200
  ds_read_b64_tr_b16 v[242:243], v244 offset:3968
  v_mfma_f32_32x32x16_bf16 v[176:191], v[32:35], v[224:227], v[176:191]
  s_add_u32 s72, s72, 4096
  buffer_load_dwordx4 v[80:83], v247, s[28:31], s72 offen offset:0
  ds_read_b64_tr_b16 v[224:225], v244 offset:6144
  ds_read_b64_tr_b16 v[226:227], v244 offset:6912
  s_waitcnt lgkmcnt(6)
  v_mfma_f32_32x32x16_bf16 v[192:207], v[32:35], v[228:231], v[192:207]
  ds_read_b64_tr_b16 v[228:229], v244 offset:6208
  ds_read_b64_tr_b16 v[230:231], v244 offset:6976
  s_waitcnt vmcnt(11)
  v_mfma_f32_32x32x16_bf16 v[160:175], v[36:39], v[232:235], v[160:175]
  buffer_load_dwordx4 v[84:87], v247, s[28:31], s72 offen offset:1024
  ds_read_b64_tr_b16 v[232:233], v244 offset:6272
  ds_read_b64_tr_b16 v[234:235], v244 offset:7040
  s_waitcnt lgkmcnt(6)
  v_mfma_f32_32x32x16_bf16 v[176:191], v[36:39], v[236:239], v[176:191]
  ds_read_b64_tr_b16 v[236:237], v244 offset:9216
  ds_read_b64_tr_b16 v[238:239], v244 offset:9984
  v_mfma_f32_32x32x16_bf16 v[192:207], v[36:39], v[240:243], v[192:207]
  buffer_load_dwordx4 v[88:91], v247, s[28:31], s72 offen offset:2048
  ds_read_b64_tr_b16 v[240:241], v244 offset:9280
  ds_read_b64_tr_b16 v[242:243], v244 offset:10048
  s_waitcnt vmcnt(12)
  s_waitcnt lgkmcnt(6)
  v_mfma_f32_32x32x16_bf16 v[160:175], v[40:43], v[224:227], v[160:175]
  ds_read_b64_tr_b16 v[224:225], v244 offset:9344
  ds_read_b64_tr_b16 v[226:227], v244 offset:10112
  v_mfma_f32_32x32x16_bf16 v[176:191], v[40:43], v[228:231], v[176:191]
  buffer_load_dwordx4 v[92:95], v247, s[28:31], s72 offen offset:3072
  ds_read_b64_tr_b16 v[228:229], v244 offset:12288
  ds_read_b64_tr_b16 v[230:231], v244 offset:13056
  s_waitcnt lgkmcnt(6)
  v_mfma_f32_32x32x16_bf16 v[192:207], v[40:43], v[232:235], v[192:207]
  ds_read_b64_tr_b16 v[232:233], v244 offset:12352
  ds_read_b64_tr_b16 v[234:235], v244 offset:13120
  s_waitcnt vmcnt(12)
  v_mfma_f32_32x32x16_bf16 v[160:175], v[44:47], v[236:239], v[160:175]
  s_add_u32 s72, s72, 4096
  buffer_load_dwordx4 v[96:99], v247, s[28:31], s72 offen offset:0
  ds_read_b64_tr_b16 v[236:237], v244 offset:12416
  ds_read_b64_tr_b16 v[238:239], v244 offset:13184
  s_waitcnt lgkmcnt(6)
  v_mfma_f32_32x32x16_bf16 v[176:191], v[44:47], v[240:243], v[176:191]
  ds_read_b64_tr_b16 v[240:241], v244 offset:15360
  ds_read_b64_tr_b16 v[242:243], v244 offset:16128
  v_mfma_f32_32x32x16_bf16 v[192:207], v[44:47], v[224:227], v[192:207]
  buffer_load_dwordx4 v[100:103], v247, s[28:31], s72 offen offset:1024
  ds_read_b64_tr_b16 v[224:225], v244 offset:15424
  ds_read_b64_tr_b16 v[226:227], v244 offset:16192
  s_waitcnt vmcnt(13)
  s_waitcnt lgkmcnt(6)
  v_mfma_f32_32x32x16_bf16 v[160:175], v[48:51], v[228:231], v[160:175]
  ds_read_b64_tr_b16 v[228:229], v244 offset:15488
  ds_read_b64_tr_b16 v[230:231], v244 offset:16256
  v_mfma_f32_32x32x16_bf16 v[176:191], v[48:51], v[232:235], v[176:191]
  buffer_load_dwordx4 v[104:107], v247, s[28:31], s72 offen offset:2048
  ds_read_b64_tr_b16 v[232:233], v244 offset:18432
  ds_read_b64_tr_b16 v[234:235], v244 offset:19200
  s_waitcnt lgkmcnt(6)
  v_mfma_f32_32x32x16_bf16 v[192:207], v[48:51], v[236:239], v[192:207]
  ds_read_b64_tr_b16 v[236:237], v244 offset:18496
  ds_read_b64_tr_b16 v[238:239], v244 offset:19264
  s_waitcnt vmcnt(13)
  v_mfma_f32_32x32x16_bf16 v[160:175], v[52:55], v[240:243], v[160:175]
  buffer_load_dwordx4 v[108:111], v247, s[28:31], s72 offen offset:3072
  ds_read_b64_tr_b16 v[240:241], v244 offset:18560
  ds_read_b64_tr_b16 v[242:243], v244 offset:19328
  s_waitcnt lgkmcnt(6)
  v_mfma_f32_32x32x16_bf16 v[176:191], v[52:55], v[224:227], v[176:191]
  ds_read_b64_tr_b16 v[224:225], v244 offset:21504
  ds_read_b64_tr_b16 v[226:227], v244 offset:22272
  v_mfma_f32_32x32x16_bf16 v[192:207], v[52:55], v[228:231], v[192:207]
  s_add_u32 s72, s72, 4096
  buffer_load_dwordx4 v[112:115], v247, s[28:31], s72 offen offset:0
  ds_read_b64_tr_b16 v[228:229], v244 offset:21568
  ds_read_b64_tr_b16 v[230:231], v244 offset:22336
  s_waitcnt vmcnt(14)
  s_waitcnt lgkmcnt(6)
  v_mfma_f32_32x32x16_bf16 v[160:175], v[56:59], v[232:235], v[160:175]
  ds_read_b64_tr_b16 v[232:233], v244 offset:21632
  ds_read_b64_tr_b16 v[234:235], v244 offset:22400
  v_mfma_f32_32x32x16_bf16 v[176:191], v[56:59], v[236:239], v[176:191]
  buffer_load_dwordx4 v[116:119], v247, s[28:31], s72 offen offset:1024
  s_barrier
  v_add_u32 v244, 49152, v255
  ds_read_b64_tr_b16 v[236:237], v244 offset:0
  ds_read_b64_tr_b16 v[238:239], v244 offset:768
  s_waitcnt lgkmcnt(6)
  v_mfma_f32_32x32x16_bf16 v[192:207], v[56:59], v[240:243], v[192:207]
  ds_read_b64_tr_b16 v[240:241], v244 offset:64
  ds_read_b64_tr_b16 v[242:243], v244 offset:832
  s_waitcnt vmcnt(14)
  v_mfma_f32_32x32x16_bf16 v[160:175], v[60:63], v[224:227], v[160:175]
  buffer_load_dwordx4 v[120:123], v247, s[28:31], s72 offen offset:2048
  ds_read_b64_tr_b16 v[224:225], v244 offset:128
  ds_read_b64_tr_b16 v[226:227], v244 offset:896
  s_waitcnt lgkmcnt(6)
  v_mfma_f32_32x32x16_bf16 v[176:191], v[60:63], v[228:231], v[176:191]
  ds_read_b64_tr_b16 v[228:229], v244 offset:3072
  ds_read_b64_tr_b16 v[230:231], v244 offset:3840
  v_mfma_f32_32x32x16_bf16 v[192:207], v[60:63], v[232:235], v[192:207]
  buffer_load_dwordx4 v[124:127], v247, s[28:31], s72 offen offset:3072
  ds_read_b64_tr_b16 v[232:233], v244 offset:3136
  ds_read_b64_tr_b16 v[234:235], v244 offset:3904
  s_waitcnt vmcnt(15)
  s_waitcnt lgkmcnt(6)
  v_mfma_f32_32x32x16_bf16 v[160:175], v[64:67], v[236:239], v[160:175]
  ds_read_b64_tr_b16 v[236:237], v244 offset:3200
  ds_read_b64_tr_b16 v[238:239], v244 offset:3968
  v_mfma_f32_32x32x16_bf16 v[176:191], v[64:67], v[240:243], v[176:191]
  s_add_u32 s72, s72, 4096
  buffer_load_dwordx4 v[128:131], v247, s[28:31], s72 offen offset:0
  ds_read_b64_tr_b16 v[240:241], v244 offset:6144
  ds_read_b64_tr_b16 v[242:243], v244 offset:6912
  s_waitcnt lgkmcnt(6)
  v_mfma_f32_32x32x16_bf16 v[192:207], v[64:67], v[224:227], v[192:207]
  ds_read_b64_tr_b16 v[224:225], v244 offset:6208
  ds_read_b64_tr_b16 v[226:227], v244 offset:6976
  s_waitcnt vmcnt(15)
  v_mfma_f32_32x32x16_bf16 v[160:175], v[68:71], v[228:231], v[160:175]
  buffer_load_dwordx4 v[132:135], v247, s[28:31], s72 offen offset:1024
  ds_read_b64_tr_b16 v[228:229], v244 offset:6272
  ds_read_b64_tr_b16 v[230:231], v244 offset:7040
  s_waitcnt lgkmcnt(6)
  v_mfma_f32_32x32x16_bf16 v[176:191], v[68:71], v[232:235], v[176:191]
  ds_read_b64_tr_b16 v[232:233], v244 offset:9216
  ds_read_b64_tr_b16 v[234:235], v244 offset:9984
  v_mfma_f32_32x32x16_bf16 v[192:207], v[68:71], v[236:239], v[192:207]
  buffer_load_dwordx4 v[136:139], v247, s[28:31], s72 offen offset:2048
  ds_read_b64_tr_b16 v[236:237], v244 offset:9280
  ds_read_b64_tr_b16 v[238:239], v244 offset:10048
  s_waitcnt vmcnt(16)
  s_waitcnt lgkmcnt(6)
  v_mfma_f32_32x32x16_bf16 v[160:175], v[72:75], v[240:243], v[160:175]
  ds_read_b64_tr_b16 v[240:241], v244 offset:9344
  ds_read_b64_tr_b16 v[242:243], v244 offset:10112
  v_mfma_f32_32x32x16_bf16 v[176:191], v[72:75], v[224:227], v[176:191]
  buffer_load_dwordx4 v[140:143], v247, s[28:31], s72 offen offset:3072
  ds_read_b64_tr_b16 v[224:225], v244 offset:12288
  ds_read_b64_tr_b16 v[226:227], v244 offset:13056
  s_waitcnt lgkmcnt(6)
  v_mfma_f32_32x32x16_bf16 v[192:207], v[72:75], v[228:231], v[192:207]
  ds_read_b64_tr_b16 v[228:229], v244 offset:12352
  ds_read_b64_tr_b16 v[230:231], v244 offset:13120
  s_waitcnt vmcnt(16)
  v_mfma_f32_32x32x16_bf16 v[160:175], v[76:79], v[232:235], v[160:175]
  s_add_u32 s72, s72, 4096
  buffer_load_dwordx4 v[144:147], v247, s[28:31], s72 offen offset:0
  ds_read_b64_tr_b16 v[232:233], v244 offset:12416
  ds_read_b64_tr_b16 v[234:235], v244 offset:13184
  s_waitcnt lgkmcnt(6)
  v_mfma_f32_32x32x16_bf16 v[176:191], v[76:79], v[236:239], v[176:191]
  ds_read_b64_tr_b16 v[236:237], v244 offset:15360
  ds_read_b64_tr_b16 v[238:239], v244 offset:16128
  v_mfma_f32_32x32x16_bf16 v[192:207], v[76:79], v[240:243], v[192:207]
  buffer_load_dwordx4 v[148:151], v247, s[28:31], s72 offen offset:1024
  ds_read_b64_tr_b16 v[240:241], v244 offset:15424
  ds_read_b64_tr_b16 v[242:243], v244 offset:16192
  s_waitcnt vmcnt(17)
  s_waitcnt lgkmcnt(6)
  v_mfma_f32_32x32x16_bf16 v[160:175], v[80:83], v[224:227], v[160:175]
  ds_read_b64_tr_b16 v[224:225], v244 offset:15488
  ds_read_b64_tr_b16 v[226:227], v244 offset:16256
  v_mfma_f32_32x32x16_bf16 v[176:191], v[80:83], v[228:231], v[176:191]
  buffer_load_dwordx4 v[152:155], v247, s[28:31], s72 offen offset:2048
  ds_read_b64_tr_b16 v[228:229], v244 offset:18432
  ds_read_b64_tr_b16 v[230:231], v244 offset:19200
  s_waitcnt lgkmcnt(6)
  v_mfma_f32_32x32x16_bf16 v[192:207], v[80:83], v[232:235], v[192:207]
  ds_read_b64_tr_b16 v[232:233], v244 offset:18496
  ds_read_b64_tr_b16 v[234:235], v244 offset:19264
  s_waitcnt vmcnt(17)
  v_mfma_f32_32x32x16_bf16 v[160:175], v[84:87], v[236:239], v[160:175]
  buffer_load_dwordx4 v[156:159], v247, s[28:31], s72 offen offset:3072
  ds_read_b64_tr_b16 v[236:237], v244 offset:18560
  ds_read_b64_tr_b16 v[238:239], v244 offset:19328
  s_waitcnt lgkmcnt(6)
  v_mfma_f32_32x32x16_bf16 v[176:191], v[84:87], v[240:243], v[176:191]
  ds_read_b64_tr_b16 v[240:241], v244 offset:21504
  ds_read_b64_tr_b16 v[242:243], v244 offset:22272
  v_mfma_f32_32x32x16_bf16 v[192:207], v[84:87], v[224:227], v[192:207]
  ds_read_b64_tr_b16 v[224:225], v244 offset:21568
  ds_read_b64_tr_b16 v[226:227], v244 offset:22336
  s_waitcnt vmcnt(17)
  s_waitcnt lgkmcnt(6)
  v_mfma_f32_32x32x16_bf16 v[160:175], v[88:91], v[228:231], v[160:175]
  ds_read_b64_tr_b16 v[228:229], v244 offset:21632
  ds_read_b64_tr_b16 v[230:231], v244 offset:22400
  v_mfma_f32_32x32x16_bf16 v[176:191], v[88:91], v[232:235], v[176:191]
  s_barrier
  v_add_u32 v244, 73728, v255
  ds_read_b64_tr_b16 v[232:233], v244 offset:0
  ds_read_b64_tr_b16 v[234:235], v244 offset:768
  s_waitcnt lgkmcnt(6)
  v_mfma_f32_32x32x16_bf16 v[192:207], v[88:91], v[236:239], v[192:207]
  ds_read_b64_tr_b16 v[236:237], v244 offset:64
  ds_read_b64_tr_b16 v[238:239], v244 offset:832
  s_waitcnt vmcnt(16)
  v_mfma_f32_32x32x16_bf16 v[160:175], v[92:95], v[240:243], v[160:175]
  ds_read_b64_tr_b16 v[240:241], v244 offset:128
  ds_read_b64_tr_b16 v[242:243], v244 offset:896
  s_waitcnt lgkmcnt(6)
  v_mfma_f32_32x32x16_bf16 v[176:191], v[92:95], v[224:227], v[176:191]
  ds_read_b64_tr_b16 v[224:225], v244 offset:3072
  ds_read_b64_tr_b16 v[226:227], v244 offset:3840
  v_mfma_f32_32x32x16_bf16 v[192:207], v[92:95], v[228:231], v[192:207]
  ds_read_b64_tr_b16 v[228:229], v244 offset:3136
  ds_read_b64_tr_b16 v[230:231], v244 offset:3904
  s_waitcnt vmcnt(15)
  s_waitcnt lgkmcnt(6)
  v_mfma_f32_32x32x16_bf16 v[160:175], v[96:99], v[232:235], v[160:175]
  ds_read_b64_tr_b16 v[232:233], v244 offset:3200
  ds_read_b64_tr_b16 v[234:235], v244 offset:3968
  v_mfma_f32_32x32x16_bf16 v[176:191], v[96:99], v[236:239], v[176:191]
  ds_read_b64_tr_b16 v[236:237], v244 offset:6144
  ds_read_b64_tr_b16 v[238:239], v244 offset:6912
  s_waitcnt lgkmcnt(6)
  v_mfma_f32_32x32x16_bf16 v[192:207], v[96:99], v[240:243], v[192:207]
  ds_read_b64_tr_b16 v[240:241], v244 offset:6208
  ds_read_b64_tr_b16 v[242:243], v244 offset:6976
  s_waitcnt vmcnt(14)
  v_mfma_f32_32x32x16_bf16 v[160:175], v[100:103], v[224:227], v[160:175]
  ds_read_b64_tr_b16 v[224:225], v244 offset:6272
  ds_read_b64_tr_b16 v[226:227], v244 offset:7040
  s_waitcnt lgkmcnt(6)
  v_mfma_f32_32x32x16_bf16 v[176:191], v[100:103], v[228:231], v[176:191]
  ds_read_b64_tr_b16 v[228:229], v244 offset:9216
  ds_read_b64_tr_b16 v[230:231], v244 offset:9984
  v_mfma_f32_32x32x16_bf16 v[192:207], v[100:103], v[232:235], v[192:207]
  ds_read_b64_tr_b16 v[232:233], v244 offset:9280
  ds_read_b64_tr_b16 v[234:235], v244 offset:10048
  s_waitcnt vmcnt(13)
  s_waitcnt lgkmcnt(6)
  v_mfma_f32_32x32x16_bf16 v[160:175], v[104:107], v[236:239], v[160:175]
  ds_read_b64_tr_b16 v[236:237], v244 offset:9344
  ds_read_b64_tr_b16 v[238:239], v244 offset:10112
  v_mfma_f32_32x32x16_bf16 v[176:191], v[104:107], v[240:243], v[176:191]
  ds_read_b64_tr_b16 v[240:241], v244 offset:12288
  ds_read_b64_tr_b16 v[242:243], v244 offset:13056
  s_waitcnt lgkmcnt(6)
  v_mfma_f32_32x32x16_bf16 v[192:207], v[104:107], v[224:227], v[192:207]
  ds_read_b64_tr_b16 v[224:225], v244 offset:12352
  ds_read_b64_tr_b16 v[226:227], v244 offset:13120
  s_waitcnt vmcnt(12)
  v_mfma_f32_32x32x16_bf16 v[160:175], v[108:111], v[228:231], v[160:175]
  ds_read_b64_tr_b16 v[228:229], v244 offset:12416
  ds_read_b64_tr_b16 v[230:231], v244 offset:13184
  s_waitcnt lgkmcnt(6)
  v_mfma_f32_32x32x16_bf16 v[176:191], v[108:111], v[232:235], v[176:191]
  ds_read_b64_tr_b16 v[232:233], v244 offset:15360
  ds_read_b64_tr_b16 v[234:235], v244 offset:16128
  v_mfma_f32_32x32x16_bf16 v[192:207], v[108:111], v[236:239], v[192:207]
  ds_read_b64_tr_b16 v[236:237], v244 offset:15424
  ds_read_b64_tr_b16 v[238:239], v244 offset:16192
  s_waitcnt vmcnt(11)
  s_waitcnt lgkmcnt(6)
  v_mfma_f32_32x32x16_bf16 v[160:175], v[112:115], v[240:243], v[160:175]
  ds_read_b64_tr_b16 v[240:241], v244 offset:15488
  ds_read_b64_tr_b16 v[242:243], v244 offset:16256
  v_mfma_f32_32x32x16_bf16 v[176:191], v[112:115], v[224:227], v[176:191]
  ds_read_b64_tr_b16 v[224:225], v244 offset:18432
  ds_read_b64_tr_b16 v[226:227], v244 offset:19200
  s_waitcnt lgkmcnt(6)
  v_mfma_f32_32x32x16_bf16 v[192:207], v[112:115], v[228:231], v[192:207]
  ds_read_b64_tr_b16 v[228:229], v244 offset:18496
  ds_read_b64_tr_b16 v[230:231], v244 offset:19264
  s_waitcnt vmcnt(10)
  v_mfma_f32_32x32x16_bf16 v[160:175], v[116:119], v[232:235], v[160:175]
  ds_read_b64_tr_b16 v[232:233], v244 offset:18560
  ds_read_b64_tr_b16 v[234:235], v244 offset:19328
  s_waitcnt lgkmcnt(6)
  v_mfma_f32_32x32x16_bf16 v[176:191], v[116:119], v[236:239], v[176:191]
  ds_read_b64_tr_b16 v[236:237], v244 offset:21504
  ds_read_b64_tr_b16 v[238:239], v244 offset:22272
  v_mfma_f32_32x32x16_bf16 v[192:207], v[116:119], v[240:243], v[192:207]
  ds_read_b64_tr_b16 v[240:241], v244 offset:21568
  ds_read_b64_tr_b16 v[242:243], v244 offset:22336
  s_waitcnt vmcnt(9)
  s_waitcnt lgkmcnt(6)
  v_mfma_f32_32x32x16_bf16 v[160:175], v[120:123], v[224:227], v[160:175]
  ds_read_b64_tr_b16 v[224:225], v244 offset:21632
  ds_read_b64_tr_b16 v[226:227], v244 offset:22400
  v_mfma_f32_32x32x16_bf16 v[176:191], v[120:123], v[228:231], v[176:191]
  s_barrier
  v_add_u32 v244, 0, v255
  ds_read_b64_tr_b16 v[228:229], v244 offset:0
  ds_read_b64_tr_b16 v[230:231], v244 offset:768
  s_waitcnt lgkmcnt(6)
  v_mfma_f32_32x32x16_bf16 v[192:207], v[120:123], v[232:235], v[192:207]
  ds_read_b64_tr_b16 v[232:233], v244 offset:64
  ds_read_b64_tr_b16 v[234:235], v244 offset:832
  s_waitcnt vmcnt(8)
  v_mfma_f32_32x32x16_bf16 v[160:175], v[124:127], v[236:239], v[160:175]
  ds_read_b64_tr_b16 v[236:237], v244 offset:128
  ds_read_b64_tr_b16 v[238:239], v244 offset:896
  s_waitcnt lgkmcnt(6)
  v_mfma_f32_32x32x16_bf16 v[176:191], v[124:127], v[240:243], v[176:191]
  ds_read_b64_tr_b16 v[240:241], v244 offset:3072
  ds_read_b64_tr_b16 v[242:243], v244 offset:3840
  v_mfma_f32_32x32x16_bf16 v[192:207], v[124:127], v[224:227], v[192:207]
  ds_read_b64_tr_b16 v[224:225], v244 offset:3136
  ds_read_b64_tr_b16 v[226:227], v244 offset:3904
  s_waitcnt vmcnt(7)
  s_waitcnt lgkmcnt(6)
  v_mfma_f32_32x32x16_bf16 v[160:175], v[128:131], v[228:231], v[160:175]
  ds_read_b64_tr_b16 v[228:229], v244 offset:3200
  ds_read_b64_tr_b16 v[230:231], v244 offset:3968
  v_mfma_f32_32x32x16_bf16 v[176:191], v[128:131], v[232:235], v[176:191]
  ds_read_b64_tr_b16 v[232:233], v244 offset:6144
  ds_read_b64_tr_b16 v[234:235], v244 offset:6912
  s_waitcnt lgkmcnt(6)
  v_mfma_f32_32x32x16_bf16 v[192:207], v[128:131], v[236:239], v[192:207]
  ds_read_b64_tr_b16 v[236:237], v244 offset:6208
  ds_read_b64_tr_b16 v[238:239], v244 offset:6976
  s_waitcnt vmcnt(6)
  v_mfma_f32_32x32x16_bf16 v[160:175], v[132:135], v[240:243], v[160:175]
  ds_read_b64_tr_b16 v[240:241], v244 offset:6272
  ds_read_b64_tr_b16 v[242:243], v244 offset:7040
  s_waitcnt lgkmcnt(6)
  v_mfma_f32_32x32x16_bf16 v[176:191], v[132:135], v[224:227], v[176:191]
  ds_read_b64_tr_b16 v[224:225], v244 offset:9216
  ds_read_b64_tr_b16 v[226:227], v244 offset:9984
  v_mfma_f32_32x32x16_bf16 v[192:207], v[132:135], v[228:231], v[192:207]
  ds_read_b64_tr_b16 v[228:229], v244 offset:9280
  ds_read_b64_tr_b16 v[230:231], v244 offset:10048
  s_waitcnt vmcnt(5)
  s_waitcnt lgkmcnt(6)
  v_mfma_f32_32x32x16_bf16 v[160:175], v[136:139], v[232:235], v[160:175]
  ds_read_b64_tr_b16 v[232:233], v244 offset:9344
  ds_read_b64_tr_b16 v[234:235], v244 offset:10112
  v_mfma_f32_32x32x16_bf16 v[176:191], v[136:139], v[236:239], v[176:191]
  ds_read_b64_tr_b16 v[236:237], v244 offset:12288
  ds_read_b64_tr_b16 v[238:239], v244 offset:13056
  s_waitcnt lgkmcnt(6)
  v_mfma_f32_32x32x16_bf16 v[192:207], v[136:139], v[240:243], v[192:207]
  ds_read_b64_tr_b16 v[240:241], v244 offset:12352
  ds_read_b64_tr_b16 v[242:243], v244 offset:13120
  s_waitcnt vmcnt(4)
  v_mfma_f32_32x32x16_bf16 v[160:175], v[140:143], v[224:227], v[160:175]
  ds_read_b64_tr_b16 v[224:225], v244 offset:12416
  ds_read_b64_tr_b16 v[226:227], v244 offset:13184
  s_waitcnt lgkmcnt(6)
  v_mfma_f32_32x32x16_bf16 v[176:191], v[140:143], v[228:231], v[176:191]
  ds_read_b64_tr_b16 v[228:229], v244 offset:15360
  ds_read_b64_tr_b16 v[230:231], v244 offset:16128
  v_mfma_f32_32x32x16_bf16 v[192:207], v[140:143], v[232:235], v[192:207]
  ds_read_b64_tr_b16 v[232:233], v244 offset:15424
  ds_read_b64_tr_b16 v[234:235], v244 offset:16192
  s_waitcnt vmcnt(3)
  s_waitcnt lgkmcnt(6)
  v_mfma_f32_32x32x16_bf16 v[160:175], v[144:147], v[236:239], v[160:175]
  ds_read_b64_tr_b16 v[236:237], v244 offset:15488
  ds_read_b64_tr_b16 v[238:239], v244 offset:16256
  v_mfma_f32_32x32x16_bf16 v[176:191], v[144:147], v[240:243], v[176:191]
  ds_read_b64_tr_b16 v[240:241], v244 offset:18432
  ds_read_b64_tr_b16 v[242:243], v244 offset:19200
  s_waitcnt lgkmcnt(6)
  v_mfma_f32_32x32x16_bf16 v[192:207], v[144:147], v[224:227], v[192:207]
  ds_read_b64_tr_b16 v[224:225], v244 offset:18496
  ds_read_b64_tr_b16 v[226:227], v244 offset:19264
  s_waitcnt vmcnt(2)
  v_mfma_f32_32x32x16_bf16 v[160:175], v[148:151], v[228:231], v[160:175]
  ds_read_b64_tr_b16 v[228:229], v244 offset:18560
  ds_read_b64_tr_b16 v[230:231], v244 offset:19328
  s_waitcnt lgkmcnt(6)
  v_mfma_f32_32x32x16_bf16 v[176:191], v[148:151], v[232:235], v[176:191]
  ds_read_b64_tr_b16 v[232:233], v244 offset:21504
  ds_read_b64_tr_b16 v[234:235], v244 offset:22272
  v_mfma_f32_32x32x16_bf16 v[192:207], v[148:151], v[236:239], v[192:207]
  ds_read_b64_tr_b16 v[236:237], v244 offset:21568
  ds_read_b64_tr_b16 v[238:239], v244 offset:22336
  s_waitcnt vmcnt(1)
  s_waitcnt lgkmcnt(6)
  v_mfma_f32_32x32x16_bf16 v[160:175], v[152:155], v[240:243], v[160:175]
  ds_read_b64_tr_b16 v[240:241], v244 offset:21632
  ds_read_b64_tr_b16 v[242:243], v244 offset:22400
  v_mfma_f32_32x32x16_bf16 v[176:191], v[152:155], v[224:227], v[176:191]
  s_barrier
  v_add_u32 v244, 24576, v246
  v_xor_b32 v245, 64, v244
  ds_read_b64_tr_b16 v[224:225], v244 offset:0
  ds_read_b64_tr_b16 v[226:227], v244 offset:512
  s_waitcnt lgkmcnt(6)
  v_mfma_f32_32x32x16_bf16 v[192:207], v[152:155], v[228:231], v[192:207]
  ds_read_b64_tr_b16 v[228:229], v244 offset:2048
  ds_read_b64_tr_b16 v[230:231], v244 offset:2560
  s_waitcnt vmcnt(0)
  v_mfma_f32_32x32x16_bf16 v[160:175], v[156:159], v[232:235], v[160:175]
  ds_read_b64_tr_b16 v[232:233], v244 offset:4096
  ds_read_b64_tr_b16 v[234:235], v244 offset:4608
  s_waitcnt lgkmcnt(6)
  v_mfma_f32_32x32x16_bf16 v[176:191], v[156:159], v[236:239], v[176:191]
  ds_read_b64_tr_b16 v[236:237], v244 offset:6144
  ds_read_b64_tr_b16 v[238:239], v244 offset:6656
  v_mfma_f32_32x32x16_bf16 v[192:207], v[156:159], v[240:243], v[192:207]
  ds_read_b64_tr_b16 v[240:241], v244 offset:8192
  ds_read_b64_tr_b16 v[242:243], v244 offset:8704
  s_waitcnt lgkmcnt(6)
  v_mfma_f32_32x32x16_bf16 v[208:223], v[0:3], v[224:227], 0
  ds_read_b64_tr_b16 v[224:225], v244 offset:10240
  ds_read_b64_tr_b16 v[226:227], v244 offset:10752
  v_mfma_f32_32x32x16_bf16 v[208:223], v[4:7], v[228:231], v[208:223]
  ds_read_b64_tr_b16 v[228:229], v244 offset:12288
  ds_read_b64_tr_b16 v[230:231], v244 offset:12800
  s_waitcnt lgkmcnt(6)
  v_mfma_f32_32x32x16_bf16 v[208:223], v[8:11], v[232:235], v[208:223]
  v_mul_f32 v248, s98, v192
  v_mul_f32 v249, s98, v193
  v_mul_f32 v250, s98, v194
  v_mul_f32 v251, s98, v195
  v_exp_f32_e64 v248, v248 clamp
  v_exp_f32_e64 v249, v249 clamp
  v_exp_f32_e64 v250, v250 clamp
  v_exp_f32_e64 v251, v251 clamp
  v_add_f32 v248, s99, v248
  v_add_f32 v249, s99, v249
  v_add_f32 v250, s99, v250
  v_add_f32 v251, s99, v251
  s_mov_b64 exec, s[76:77]
  v_add_f32 v192, v192, v248
  v_add_f32 v193, v193, v249
  v_add_f32 v194, v194, v250
  v_add_f32 v195, v195, v251
  s_mov_b64 exec, -1
  s_mov_b64 exec, s[76:77]
  v_max_f32 v192, v192, v248
  v_max_f32 v193, v193, v249
  v_max_f32 v194, v194, v250
  v_max_f32 v195, v195, v251
  s_mov_b64 exec, -1
  v_mul_f32 v248, s98, v196
  v_mul_f32 v249, s98, v197
  v_mul_f32 v250, s98, v198
  v_mul_f32 v251, s98, v199
  v_exp_f32_e64 v248, v248 clamp
  v_exp_f32_e64 v249, v249 clamp
  v_exp_f32_e64 v250, v250 clamp
  v_exp_f32_e64 v251, v251 clamp
  v_add_f32 v248, s99, v248
  v_add_f32 v249, s99, v249
  v_add_f32 v250, s99, v250
  v_add_f32 v251, s99, v251
  s_mov_b64 exec, s[76:77]
  v_add_f32 v196, v196, v248
  v_add_f32 v197, v197, v249
  v_add_f32 v198, v198, v250
  v_add_f32 v199, v199, v251
  s_mov_b64 exec, -1
  s_mov_b64 exec, s[76:77]
  v_max_f32 v196, v196, v248
  v_max_f32 v197, v197, v249
  v_max_f32 v198, v198, v250
  v_max_f32 v199, v199, v251
  s_mov_b64 exec, -1
  v_mul_f32 v248, s98, v200
  v_mul_f32 v249, s98, v201
  v_mul_f32 v250, s98, v202
  v_mul_f32 v251, s98, v203
  v_exp_f32_e64 v248, v248 clamp
  v_exp_f32_e64 v249, v249 clamp
  v_exp_f32_e64 v250, v250 clamp
  v_exp_f32_e64 v251, v251 clamp
  v_add_f32 v248, s99, v248
  v_add_f32 v249, s99, v249
  v_add_f32 v250, s99, v250
  v_add_f32 v251, s99, v251
  s_mov_b64 exec, s[76:77]
  v_add_f32 v200, v200, v248
  v_add_f32 v201, v201, v249
  v_add_f32 v202, v202, v250
  v_add_f32 v203, v203, v251
  s_mov_b64 exec, -1
  s_mov_b64 exec, s[76:77]
  v_max_f32 v200, v200, v248
  v_max_f32 v201, v201, v249
  v_max_f32 v202, v202, v250
  v_max_f32 v203, v203, v251
  s_mov_b64 exec, -1
  v_mul_f32 v248, s98, v204
  v_mul_f32 v249, s98, v205
  v_mul_f32 v250, s98, v206
  v_mul_f32 v251, s98, v207
  v_exp_f32_e64 v248, v248 clamp
  v_exp_f32_e64 v249, v249 clamp
  v_exp_f32_e64 v250, v250 clamp
  v_exp_f32_e64 v251, v251 clamp
  v_add_f32 v248, s99, v248
  v_add_f32 v249, s99, v249
  v_add_f32 v250, s99, v250
  v_add_f32 v251, s99, v251
  s_mov_b64 exec, s[76:77]
  v_add_f32 v204, v204, v248
  v_add_f32 v205, v205, v249
  v_add_f32 v206, v206, v250
  v_add_f32 v207, v207, v251
  s_mov_b64 exec, -1
  s_mov_b64 exec, s[76:77]
  v_max_f32 v204, v204, v248
  v_max_f32 v205, v205, v249
  v_max_f32 v206, v206, v250
  v_max_f32 v207, v207, v251
  s_mov_b64 exec, -1
  v_mov_b32 v253, v192
  v_add_f32 v253, v253, v193
  v_add_f32 v253, v253, v194
  v_add_f32 v253, v253, v195
  v_add_f32 v253, v253, v196
  v_add_f32 v253, v253, v197
  v_add_f32 v253, v253, v198
  v_add_f32 v253, v253, v199
  v_add_f32 v253, v253, v200
  v_add_f32 v253, v253, v201
  v_add_f32 v253, v253, v202
  v_add_f32 v253, v253, v203
  v_add_f32 v253, v253, v204
  v_add_f32 v253, v253, v205
  v_add_f32 v253, v253, v206
  v_add_f32 v253, v253, v207
  v_mov_b32 v254, v253
  s_nop 1
  v_permlane32_swap_b32 v253, v254
  s_lshl_b32 s80, s24, 6
  v_add_f32 v253, v253, v254
  v_bfe_u32 v254, v247, 4, 5
  v_lshlrev_b32 v254, 2, v254
  v_add_u32 v254, s80, v254
  v_add_u32 v254, 162368, v254
  s_mov_b64 exec, 0xffff
  ds_write_b32 v254, v253
  s_mov_b64 exec, -1
  ds_read_b64_tr_b16 v[232:233], v244 offset:14336
  ds_read_b64_tr_b16 v[234:235], v244 offset:14848
  v_mfma_f32_32x32x16_bf16 v[208:223], v[12:15], v[236:239], v[208:223]
  v_cvt_pk_bf16_f32 v192, v192, v193
  v_cvt_pk_bf16_f32 v193, v194, v195
  v_cvt_pk_bf16_f32 v194, v196, v197
  v_cvt_pk_bf16_f32 v195, v198, v199
  ds_read_b64_tr_b16 v[236:237], v245 offset:0
  ds_read_b64_tr_b16 v[238:239], v245 offset:512
  s_waitcnt lgkmcnt(7)
  v_mfma_f32_32x32x16_bf16 v[208:223], v[16:19], v[240:243], v[208:223]
  ds_write_b128 v252, v[192:195] offset:16384
  ds_read_b64_tr_b16 v[240:241], v245 offset:2048
  ds_read_b64_tr_b16 v[242:243], v245 offset:2560
  v_mfma_f32_32x32x16_bf16 v[208:223], v[20:23], v[224:227], v[208:223]
  v_cvt_pk_bf16_f32 v200, v200, v201
  v_cvt_pk_bf16_f32 v201, v202, v203
  v_cvt_pk_bf16_f32 v202, v204, v205
  v_cvt_pk_bf16_f32 v203, v206, v207
  ds_read_b64_tr_b16 v[224:225], v245 offset:4096
  ds_read_b64_tr_b16 v[226:227], v245 offset:4608
  s_waitcnt lgkmcnt(7)
  v_mfma_f32_32x32x16_bf16 v[208:223], v[24:27], v[228:231], v[208:223]
  ds_write_b128 v252, v[200:203] offset:20480
  ds_read_b64_tr_b16 v[228:229], v245 offset:6144
  ds_read_b64_tr_b16 v[230:231], v245 offset:6656
  v_mfma_f32_32x32x16_bf16 v[208:223], v[28:31], v[232:235], v[208:223]
  ds_read_b64_tr_b16 v[232:233], v245 offset:8192
  ds_read_b64_tr_b16 v[234:235], v245 offset:8704
  s_waitcnt lgkmcnt(7)
  v_mfma_f32_32x32x16_bf16 v[192:207], v[0:3], v[236:239], 0
  v_mul_f32 v248, s98, v160
  v_mul_f32 v249, s98, v161
  v_mul_f32 v250, s98, v162
  v_mul_f32 v251, s98, v163
  v_exp_f32_e64 v248, v248 clamp
  v_exp_f32_e64 v249, v249 clamp
  v_exp_f32_e64 v250, v250 clamp
  v_exp_f32_e64 v251, v251 clamp
  v_add_f32 v248, s99, v248
  v_add_f32 v249, s99, v249
  v_add_f32 v250, s99, v250
  v_add_f32 v251, s99, v251
  v_add_f32 v160, v160, v248
  v_add_f32 v161, v161, v249
  v_add_f32 v162, v162, v250
  v_add_f32 v163, v163, v251
  v_max_f32 v160, v160, v248
  v_max_f32 v161, v161, v249
  v_max_f32 v162, v162, v250
  v_max_f32 v163, v163, v251
  v_mul_f32 v248, s98, v164
  v_mul_f32 v249, s98, v165
  v_mul_f32 v250, s98, v166
  v_mul_f32 v251, s98, v167
  v_exp_f32_e64 v248, v248 clamp
  v_exp_f32_e64 v249, v249 clamp
  v_exp_f32_e64 v250, v250 clamp
  v_exp_f32_e64 v251, v251 clamp
  v_add_f32 v248, s99, v248
  v_add_f32 v249, s99, v249
  v_add_f32 v250, s99, v250
  ds_read_b64_tr_b16 v[236:237], v245 offset:10240
  ds_read_b64_tr_b16 v[238:239], v245 offset:10752
  v_mfma_f32_32x32x16_bf16 v[192:207], v[4:7], v[240:243], v[192:207]
  v_add_f32 v251, s99, v251
  v_add_f32 v164, v164, v248
  v_add_f32 v165, v165, v249
  ds_read_b64_tr_b16 v[240:241], v245 offset:12288
  ds_read_b64_tr_b16 v[242:243], v245 offset:12800
  s_waitcnt lgkmcnt(6)
  v_mfma_f32_32x32x16_bf16 v[192:207], v[8:11], v[224:227], v[192:207]
  v_add_f32 v166, v166, v250
  v_add_f32 v167, v167, v251
  v_max_f32 v164, v164, v248
  ds_read_b64_tr_b16 v[224:225], v245 offset:14336
  ds_read_b64_tr_b16 v[226:227], v245 offset:14848
  v_mfma_f32_32x32x16_bf16 v[192:207], v[12:15], v[228:231], v[192:207]
  v_max_f32 v165, v165, v249
  v_max_f32 v166, v166, v250
  v_max_f32 v167, v167, v251
  s_barrier
  v_add_u32 v244, 40960, v246
  v_xor_b32 v245, 64, v244
  ds_read_b64_tr_b16 v[228:229], v244 offset:0
  ds_read_b64_tr_b16 v[230:231], v244 offset:512
  s_waitcnt lgkmcnt(6)
  v_mfma_f32_32x32x16_bf16 v[192:207], v[16:19], v[232:235], v[192:207]
  v_mul_f32 v248, s98, v168
  v_mul_f32 v249, s98, v169
  v_mul_f32 v250, s98, v170
  ds_read_b64_tr_b16 v[232:233], v245 offset:0
  ds_read_b64_tr_b16 v[234:235], v245 offset:512
  v_mfma_f32_32x32x16_bf16 v[192:207], v[20:23], v[236:239], v[192:207]
  v_mul_f32 v251, s98, v171
  v_exp_f32_e64 v248, v248 clamp
  v_exp_f32_e64 v249, v249 clamp
  ds_read_b64_tr_b16 v[236:237], v244 offset:2048
  ds_read_b64_tr_b16 v[238:239], v244 offset:2560
  s_waitcnt lgkmcnt(6)
  v_mfma_f32_32x32x16_bf16 v[192:207], v[24:27], v[240:243], v[192:207]
  v_exp_f32_e64 v250, v250 clamp
  v_exp_f32_e64 v251, v251 clamp
  v_add_f32 v248, s99, v248
  ds_read_b64_tr_b16 v[240:241], v245 offset:2048
  ds_read_b64_tr_b16 v[242:243], v245 offset:2560
  v_mfma_f32_32x32x16_bf16 v[192:207], v[28:31], v[224:227], v[192:207]
  v_add_f32 v249, s99, v249
  v_add_f32 v250, s99, v250
  v_add_f32 v251, s99, v251
  ds_read_b64_tr_b16 v[224:225], v244 offset:4096
  ds_read_b64_tr_b16 v[226:227], v244 offset:4608
  s_waitcnt lgkmcnt(6)
  v_mfma_f32_32x32x16_bf16 v[208:223], v[32:35], v[228:231], v[208:223]
  v_add_f32 v168, v168, v248
  v_add_f32 v169, v169, v249
  v_add_f32 v170, v170, v250
  ds_read_b64_tr_b16 v[228:229], v245 offset:4096
  ds_read_b64_tr_b16 v[230:231], v245 offset:4608
  v_mfma_f32_32x32x16_bf16 v[192:207], v[32:35], v[232:235], v[192:207]
  v_add_f32 v171, v171, v251
  v_max_f32 v168, v168, v248
  v_max_f32 v169, v169, v249
  ds_read_b64_tr_b16 v[232:233], v244 offset:6144
  ds_read_b64_tr_b16 v[234:235], v244 offset:6656
  s_waitcnt lgkmcnt(6)
  v_mfma_f32_32x32x16_bf16 v[208:223], v[36:39], v[236:239], v[208:223]
  v_max_f32 v170, v170, v250
  v_max_f32 v171, v171, v251
  v_mul_f32 v248, s98, v172
  ds_read_b64_tr_b16 v[236:237], v245 offset:6144
  ds_read_b64_tr_b16 v[238:239], v245 offset:6656
  v_mfma_f32_32x32x16_bf16 v[192:207], v[36:39], v[240:243], v[192:207]
  v_mul_f32 v249, s98, v173
  v_mul_f32 v250, s98, v174
  v_mul_f32 v251, s98, v175
  ds_read_b64_tr_b16 v[240:241], v244 offset:8192
  ds_read_b64_tr_b16 v[242:243], v244 offset:8704
  s_waitcnt lgkmcnt(6)
  v_mfma_f32_32x32x16_bf16 v[208:223], v[40:43], v[224:227], v[208:223]
  v_exp_f32_e64 v248, v248 clamp
  v_exp_f32_e64 v249, v249 clamp
  v_exp_f32_e64 v250, v250 clamp
  ds_read_b64_tr_b16 v[224:225], v245 offset:8192
  ds_read_b64_tr_b16 v[226:227], v245 offset:8704
  v_mfma_f32_32x32x16_bf16 v[192:207], v[40:43], v[228:231], v[192:207]
  v_exp_f32_e64 v251, v251 clamp
  v_add_f32 v248, s99, v248
  v_add_f32 v249, s99, v249
  ds_read_b64_tr_b16 v[228:229], v244 offset:10240
  ds_read_b64_tr_b16 v[230:231], v244 offset:10752
  s_waitcnt lgkmcnt(6)
  v_mfma_f32_32x32x16_bf16 v[208:223], v[44:47], v[232:235], v[208:223]
  v_add_f32 v250, s99, v250
  v_add_f32 v251, s99, v251
  v_add_f32 v172, v172, v248
  ds_read_b64_tr_b16 v[232:233], v245 offset:10240
  ds_read_b64_tr_b16 v[234:235], v245 offset:10752
  v_mfma_f32_32x32x16_bf16 v[192:207], v[44:47], v[236:239], v[192:207]
  v_add_f32 v173, v173, v249
  v_add_f32 v174, v174, v250
  v_add_f32 v175, v175, v251
  ds_read_b64_tr_b16 v[236:237], v244 offset:12288
  ds_read_b64_tr_b16 v[238:239], v244 offset:12800
  s_waitcnt lgkmcnt(6)
  v_mfma_f32_32x32x16_bf16 v[208:223], v[48:51], v[240:243], v[208:223]
  v_max_f32 v172, v172, v248
  v_max_f32 v173, v173, v249
  v_max_f32 v174, v174, v250
  ds_read_b64_tr_b16 v[240:241], v245 offset:12288
  ds_read_b64_tr_b16 v[242:243], v245 offset:12800
  v_mfma_f32_32x32x16_bf16 v[192:207], v[48:51], v[224:227], v[192:207]
  v_max_f32 v175, v175, v251
  v_mov_b32 v253, v160
  v_add_f32 v253, v253, v161
  ds_read_b64_tr_b16 v[224:225], v244 offset:14336
  ds_read_b64_tr_b16 v[226:227], v244 offset:14848
  s_waitcnt lgkmcnt(6)
  v_mfma_f32_32x32x16_bf16 v[208:223], v[52:55], v[228:231], v[208:223]
  v_add_f32 v253, v253, v162
  v_add_f32 v253, v253, v163
  v_add_f32 v253, v253, v164
  ds_read_b64_tr_b16 v[228:229], v245 offset:14336
  ds_read_b64_tr_b16 v[230:231], v245 offset:14848
  v_mfma_f32_32x32x16_bf16 v[192:207], v[52:55], v[232:235], v[192:207]
  v_add_f32 v253, v253, v165
  v_add_f32 v253, v253, v166
  v_add_f32 v253, v253, v167
  s_barrier
  v_add_u32 v244, 57344, v246
  v_xor_b32 v245, 64, v244
  ds_read_b64_tr_b16 v[232:233], v244 offset:0
  ds_read_b64_tr_b16 v[234:235], v244 offset:512
  s_waitcnt lgkmcnt(6)
  v_mfma_f32_32x32x16_bf16 v[208:223], v[56:59], v[236:239], v[208:223]
  v_add_f32 v253, v253, v168
  v_add_f32 v253, v253, v169
  v_add_f32 v253, v253, v170
  ds_read_b64_tr_b16 v[236:237], v245 offset:0
  ds_read_b64_tr_b16 v[238:239], v245 offset:512
  v_mfma_f32_32x32x16_bf16 v[192:207], v[56:59], v[240:243], v[192:207]
  v_add_f32 v253, v253, v171
  v_add_f32 v253, v253, v172
  v_add_f32 v253, v253, v173
  ds_read_b64_tr_b16 v[240:241], v244 offset:2048
  ds_read_b64_tr_b16 v[242:243], v244 offset:2560
  s_waitcnt lgkmcnt(6)
  v_mfma_f32_32x32x16_bf16 v[208:223], v[60:63], v[224:227], v[208:223]
  v_add_f32 v253, v253, v174
  v_add_f32 v253, v253, v175
  v_mov_b32 v254, v253
  s_nop 1
  v_permlane32_swap_b32 v253, v254
  ds_read_b64_tr_b16 v[224:225], v245 offset:2048
  ds_read_b64_tr_b16 v[226:227], v245 offset:2560
  v_mfma_f32_32x32x16_bf16 v[192:207], v[60:63], v[228:231], v[192:207]
  s_lshl_b32 s80, s24, 8
  v_add_f32 v253, v253, v254
  v_bfe_u32 v254, v247, 4, 5
  ds_read_b64_tr_b16 v[228:229], v244 offset:4096
  ds_read_b64_tr_b16 v[230:231], v244 offset:4608
  s_waitcnt lgkmcnt(6)
  v_mfma_f32_32x32x16_bf16 v[208:223], v[64:67], v[232:235], v[208:223]
  v_lshlrev_b32 v254, 2, v254
  v_add_u32 v254, s80, v254
  ds_read_b64_tr_b16 v[232:233], v245 offset:4096
  ds_read_b64_tr_b16 v[234:235], v245 offset:4608
  v_mfma_f32_32x32x16_bf16 v[192:207], v[64:67], v[236:239], v[192:207]
  v_add_u32 v254, 162816, v254
  ds_write_b32 v254, v253
  ds_read_b64_tr_b16 v[236:237], v244 offset:6144
  ds_read_b64_tr_b16 v[238:239], v244 offset:6656
  s_waitcnt lgkmcnt(7)
  v_mfma_f32_32x32x16_bf16 v[208:223], v[68:71], v[240:243], v[208:223]
  v_cvt_pk_bf16_f32 v160, v160, v161
  v_cvt_pk_bf16_f32 v161, v162, v163
  ds_read_b64_tr_b16 v[240:241], v245 offset:6144
  ds_read_b64_tr_b16 v[242:243], v245 offset:6656
  v_mfma_f32_32x32x16_bf16 v[192:207], v[68:71], v[224:227], v[192:207]
  v_cvt_pk_bf16_f32 v162, v164, v165
  v_cvt_pk_bf16_f32 v163, v166, v167
  ds_write_b128 v252, v[160:163] offset:0
  ds_read_b64_tr_b16 v[224:225], v244 offset:8192
  ds_read_b64_tr_b16 v[226:227], v244 offset:8704
  s_waitcnt lgkmcnt(8)
  v_mfma_f32_32x32x16_bf16 v[208:223], v[72:75], v[228:231], v[208:223]
  v_cvt_pk_bf16_f32 v168, v168, v169
  v_cvt_pk_bf16_f32 v169, v170, v171
  ds_read_b64_tr_b16 v[228:229], v245 offset:8192
  ds_read_b64_tr_b16 v[230:231], v245 offset:8704
  v_mfma_f32_32x32x16_bf16 v[192:207], v[72:75], v[232:235], v[192:207]
  v_cvt_pk_bf16_f32 v170, v172, v173
  v_cvt_pk_bf16_f32 v171, v174, v175
  ds_write_b128 v252, v[168:171] offset:4096
  ds_read_b64_tr_b16 v[232:233], v244 offset:10240
  ds_read_b64_tr_b16 v[234:235], v244 offset:10752
  s_waitcnt lgkmcnt(8)
  v_mfma_f32_32x32x16_bf16 v[208:223], v[76:79], v[236:239], v[208:223]
  v_mul_f32 v248, s98, v176
  v_mul_f32 v249, s98, v177
  v_mul_f32 v250, s98, v178
  ds_read_b64_tr_b16 v[236:237], v245 offset:10240
  ds_read_b64_tr_b16 v[238:239], v245 offset:10752
  v_mfma_f32_32x32x16_bf16 v[192:207], v[76:79], v[240:243], v[192:207]
  v_mul_f32 v251, s98, v179
  v_exp_f32_e64 v248, v248 clamp
  ds_read_b64_tr_b16 v[240:241], v244 offset:12288
  ds_read_b64_tr_b16 v[242:243], v244 offset:12800
  s_waitcnt lgkmcnt(7)
  v_mfma_f32_32x32x16_bf16 v[208:223], v[80:83], v[224:227], v[208:223]
  v_exp_f32_e64 v249, v249 clamp
  v_exp_f32_e64 v250, v250 clamp
  v_exp_f32_e64 v251, v251 clamp
  ds_read_b64_tr_b16 v[224:225], v245 offset:12288
  ds_read_b64_tr_b16 v[226:227], v245 offset:12800
  v_mfma_f32_32x32x16_bf16 v[192:207], v[80:83], v[228:231], v[192:207]
  v_add_f32 v248, s99, v248
  v_add_f32 v249, s99, v249
  v_add_f32 v250, s99, v250
  ds_read_b64_tr_b16 v[228:229], v244 offset:14336
  ds_read_b64_tr_b16 v[230:231], v244 offset:14848
  s_waitcnt lgkmcnt(6)
  v_mfma_f32_32x32x16_bf16 v[208:223], v[84:87], v[232:235], v[208:223]
  v_add_f32 v251, s99, v251
  v_add_f32 v176, v176, v248
  v_add_f32 v177, v177, v249
  ds_read_b64_tr_b16 v[232:233], v245 offset:14336
  ds_read_b64_tr_b16 v[234:235], v245 offset:14848
  v_mfma_f32_32x32x16_bf16 v[192:207], v[84:87], v[236:239], v[192:207]
  v_add_f32 v178, v178, v250
  v_add_f32 v179, v179, v251
  v_max_f32 v176, v176, v248
  s_barrier
  v_add_u32 v244, 73728, v246
  v_xor_b32 v245, 64, v244
  ds_read_b64_tr_b16 v[236:237], v244 offset:0
  ds_read_b64_tr_b16 v[238:239], v244 offset:512
  s_waitcnt lgkmcnt(6)
  v_mfma_f32_32x32x16_bf16 v[208:223], v[88:91], v[240:243], v[208:223]
  v_max_f32 v177, v177, v249
  v_max_f32 v178, v178, v250
  v_max_f32 v179, v179, v251
  ds_read_b64_tr_b16 v[240:241], v245 offset:0
  ds_read_b64_tr_b16 v[242:243], v245 offset:512
  v_mfma_f32_32x32x16_bf16 v[192:207], v[88:91], v[224:227], v[192:207]
  v_mul_f32 v248, s98, v180
  v_mul_f32 v249, s98, v181
  v_mul_f32 v250, s98, v182
  ds_read_b64_tr_b16 v[224:225], v244 offset:2048
  ds_read_b64_tr_b16 v[226:227], v244 offset:2560
  s_waitcnt lgkmcnt(6)
  v_mfma_f32_32x32x16_bf16 v[208:223], v[92:95], v[228:231], v[208:223]
  v_mul_f32 v251, s98, v183
  v_exp_f32_e64 v248, v248 clamp
  v_exp_f32_e64 v249, v249 clamp
  ds_read_b64_tr_b16 v[228:229], v245 offset:2048
  ds_read_b64_tr_b16 v[230:231], v245 offset:2560
  v_mfma_f32_32x32x16_bf16 v[192:207], v[92:95], v[232:235], v[192:207]
  v_exp_f32_e64 v250, v250 clamp
  v_exp_f32_e64 v251, v251 clamp
  v_add_f32 v248, s99, v248
  ds_read_b64_tr_b16 v[232:233], v244 offset:4096
  ds_read_b64_tr_b16 v[234:235], v244 offset:4608
  s_waitcnt lgkmcnt(6)
  v_mfma_f32_32x32x16_bf16 v[208:223], v[96:99], v[236:239], v[208:223]
  v_add_f32 v249, s99, v249
  v_add_f32 v250, s99, v250
  v_add_f32 v251, s99, v251
  ds_read_b64_tr_b16 v[236:237], v245 offset:4096
  ds_read_b64_tr_b16 v[238:239], v245 offset:4608
  v_mfma_f32_32x32x16_bf16 v[192:207], v[96:99], v[240:243], v[192:207]
  v_add_f32 v180, v180, v248
  v_add_f32 v181, v181, v249
  v_add_f32 v182, v182, v250
  ds_read_b64_tr_b16 v[240:241], v244 offset:6144
  ds_read_b64_tr_b16 v[242:243], v244 offset:6656
  s_waitcnt lgkmcnt(6)
  v_mfma_f32_32x32x16_bf16 v[208:223], v[100:103], v[224:227], v[208:223]
  v_add_f32 v183, v183, v251
  v_max_f32 v180, v180, v248
  v_max_f32 v181, v181, v249
  ds_read_b64_tr_b16 v[224:225], v245 offset:6144
  ds_read_b64_tr_b16 v[226:227], v245 offset:6656
  v_mfma_f32_32x32x16_bf16 v[192:207], v[100:103], v[228:231], v[192:207]
  v_max_f32 v182, v182, v250
  v_max_f32 v183, v183, v251
  v_mul_f32 v248, s98, v184
  ds_read_b64_tr_b16 v[228:229], v244 offset:8192
  ds_read_b64_tr_b16 v[230:231], v244 offset:8704
  s_waitcnt lgkmcnt(6)
  v_mfma_f32_32x32x16_bf16 v[208:223], v[104:107], v[232:235], v[208:223]
  v_mul_f32 v249, s98, v185
  v_mul_f32 v250, s98, v186
  v_mul_f32 v251, s98, v187
  ds_read_b64_tr_b16 v[232:233], v245 offset:8192
  ds_read_b64_tr_b16 v[234:235], v245 offset:8704
  v_mfma_f32_32x32x16_bf16 v[192:207], v[104:107], v[236:239], v[192:207]
  v_exp_f32_e64 v248, v248 clamp
  v_exp_f32_e64 v249, v249 clamp
  v_exp_f32_e64 v250, v250 clamp
  ds_read_b64_tr_b16 v[236:237], v244 offset:10240
  ds_read_b64_tr_b16 v[238:239], v244 offset:10752
  s_waitcnt lgkmcnt(6)
  v_mfma_f32_32x32x16_bf16 v[208:223], v[108:111], v[240:243], v[208:223]
  v_exp_f32_e64 v251, v251 clamp
  v_add_f32 v248, s99, v248
  v_add_f32 v249, s99, v249
  ds_read_b64_tr_b16 v[240:241], v245 offset:10240
  ds_read_b64_tr_b16 v[242:243], v245 offset:10752
  v_mfma_f32_32x32x16_bf16 v[192:207], v[108:111], v[224:227], v[192:207]
  v_add_f32 v250, s99, v250
  v_add_f32 v251, s99, v251
  v_add_f32 v184, v184, v248
  ds_read_b64_tr_b16 v[224:225], v244 offset:12288
  ds_read_b64_tr_b16 v[226:227], v244 offset:12800
  s_waitcnt lgkmcnt(6)
  v_mfma_f32_32x32x16_bf16 v[208:223], v[112:115], v[228:231], v[208:223]
  v_add_f32 v185, v185, v249
  v_add_f32 v186, v186, v250
  v_add_f32 v187, v187, v251
  ds_read_b64_tr_b16 v[228:229], v245 offset:12288
  ds_read_b64_tr_b16 v[230:231], v245 offset:12800
  v_mfma_f32_32x32x16_bf16 v[192:207], v[112:115], v[232:235], v[192:207]
  v_max_f32 v184, v184, v248
  v_max_f32 v185, v185, v249
  v_max_f32 v186, v186, v250
  ds_read_b64_tr_b16 v[232:233], v244 offset:14336
  ds_read_b64_tr_b16 v[234:235], v244 offset:14848
  s_waitcnt lgkmcnt(6)
  v_mfma_f32_32x32x16_bf16 v[208:223], v[116:119], v[236:239], v[208:223]
  v_max_f32 v187, v187, v251
  v_mul_f32 v248, s98, v188
  v_mul_f32 v249, s98, v189
  ds_read_b64_tr_b16 v[236:237], v245 offset:14336
  ds_read_b64_tr_b16 v[238:239], v245 offset:14848
  v_mfma_f32_32x32x16_bf16 v[192:207], v[116:119], v[240:243], v[192:207]
  v_mul_f32 v250, s98, v190
  v_mul_f32 v251, s98, v191
  v_exp_f32_e64 v248, v248 clamp
  s_barrier
  v_add_u32 v244, 90112, v246
  v_xor_b32 v245, 64, v244
  ds_read_b64_tr_b16 v[240:241], v244 offset:0
  ds_read_b64_tr_b16 v[242:243], v244 offset:512
  s_waitcnt lgkmcnt(6)
  v_mfma_f32_32x32x16_bf16 v[208:223], v[120:123], v[224:227], v[208:223]
  v_exp_f32_e64 v249, v249 clamp
  v_exp_f32_e64 v250, v250 clamp
  v_exp_f32_e64 v251, v251 clamp
  ds_read_b64_tr_b16 v[224:225], v245 offset:0
  ds_read_b64_tr_b16 v[226:227], v245 offset:512
  v_mfma_f32_32x32x16_bf16 v[192:207], v[120:123], v[228:231], v[192:207]
  v_add_f32 v248, s99, v248
  v_add_f32 v249, s99, v249
  v_add_f32 v250, s99, v250
  ds_read_b64_tr_b16 v[228:229], v244 offset:2048
  ds_read_b64_tr_b16 v[230:231], v244 offset:2560
  s_waitcnt lgkmcnt(6)
  v_mfma_f32_32x32x16_bf16 v[208:223], v[124:127], v[232:235], v[208:223]
  v_add_f32 v251, s99, v251
  v_add_f32 v188, v188, v248
  v_add_f32 v189, v189, v249
  ds_read_b64_tr_b16 v[232:233], v245 offset:2048
  ds_read_b64_tr_b16 v[234:235], v245 offset:2560
  v_mfma_f32_32x32x16_bf16 v[192:207], v[124:127], v[236:239], v[192:207]
  v_add_f32 v190, v190, v250
  v_add_f32 v191, v191, v251
  v_max_f32 v188, v188, v248
  ds_read_b64_tr_b16 v[236:237], v244 offset:4096
  ds_read_b64_tr_b16 v[238:239], v244 offset:4608
  s_waitcnt lgkmcnt(6)
  v_mfma_f32_32x32x16_bf16 v[208:223], v[128:131], v[240:243], v[208:223]
  v_max_f32 v189, v189, v249
  v_max_f32 v190, v190, v250
  v_max_f32 v191, v191, v251
  ds_read_b64_tr_b16 v[240:241], v245 offset:4096
  ds_read_b64_tr_b16 v[242:243], v245 offset:4608
  v_mfma_f32_32x32x16_bf16 v[192:207], v[128:131], v[224:227], v[192:207]
  v_mov_b32 v253, v176
  v_add_f32 v253, v253, v177
  v_add_f32 v253, v253, v178
  ds_read_b64_tr_b16 v[224:225], v244 offset:6144
  ds_read_b64_tr_b16 v[226:227], v244 offset:6656
  s_waitcnt lgkmcnt(6)
  v_mfma_f32_32x32x16_bf16 v[208:223], v[132:135], v[228:231], v[208:223]
  v_add_f32 v253, v253, v179
  v_add_f32 v253, v253, v180
  v_add_f32 v253, v253, v181
  ds_read_b64_tr_b16 v[228:229], v245 offset:6144
  ds_read_b64_tr_b16 v[230:231], v245 offset:6656
  v_mfma_f32_32x32x16_bf16 v[192:207], v[132:135], v[232:235], v[192:207]
  v_add_f32 v253, v253, v182
  v_add_f32 v253, v253, v183
  v_add_f32 v253, v253, v184
  ds_read_b64_tr_b16 v[232:233], v244 offset:8192
  ds_read_b64_tr_b16 v[234:235], v244 offset:8704
  s_waitcnt lgkmcnt(6)
  v_mfma_f32_32x32x16_bf16 v[208:223], v[136:139], v[236:239], v[208:223]
  v_add_f32 v253, v253, v185
  v_add_f32 v253, v253, v186
  v_add_f32 v253, v253, v187
  ds_read_b64_tr_b16 v[236:237], v245 offset:8192
  ds_read_b64_tr_b16 v[238:239], v245 offset:8704
  v_mfma_f32_32x32x16_bf16 v[192:207], v[136:139], v[240:243], v[192:207]
  v_add_f32 v253, v253, v188
  v_add_f32 v253, v253, v189
  v_add_f32 v253, v253, v190
  ds_read_b64_tr_b16 v[240:241], v244 offset:10240
  ds_read_b64_tr_b16 v[242:243], v244 offset:10752
  s_waitcnt lgkmcnt(6)
  v_mfma_f32_32x32x16_bf16 v[208:223], v[140:143], v[224:227], v[208:223]
  v_add_f32 v253, v253, v191
  v_mov_b32 v254, v253
  s_nop 1
  v_permlane32_swap_b32 v253, v254
  ds_read_b64_tr_b16 v[224:225], v245 offset:10240
  ds_read_b64_tr_b16 v[226:227], v245 offset:10752
  v_mfma_f32_32x32x16_bf16 v[192:207], v[140:143], v[228:231], v[192:207]
  s_lshl_b32 s80, s24, 8
  v_add_f32 v253, v253, v254
  v_bfe_u32 v254, v247, 4, 5
  ds_read_b64_tr_b16 v[228:229], v244 offset:12288
  ds_read_b64_tr_b16 v[230:231], v244 offset:12800
  s_waitcnt lgkmcnt(6)
  v_mfma_f32_32x32x16_bf16 v[208:223], v[144:147], v[232:235], v[208:223]
  v_lshlrev_b32 v254, 2, v254
  v_add_u32 v254, s80, v254
  ds_read_b64_tr_b16 v[232:233], v245 offset:12288
  ds_read_b64_tr_b16 v[234:235], v245 offset:12800
  v_mfma_f32_32x32x16_bf16 v[192:207], v[144:147], v[236:239], v[192:207]
  v_add_u32 v254, 162944, v254
  ds_write_b32 v254, v253
  ds_read_b64_tr_b16 v[236:237], v244 offset:14336
  ds_read_b64_tr_b16 v[238:239], v244 offset:14848
  s_waitcnt lgkmcnt(7)
  v_mfma_f32_32x32x16_bf16 v[208:223], v[148:151], v[240:243], v[208:223]
  v_cvt_pk_bf16_f32 v176, v176, v177
  v_cvt_pk_bf16_f32 v177, v178, v179
  v_cvt_pk_bf16_f32 v178, v180, v181
  v_cvt_pk_bf16_f32 v179, v182, v183
  ds_read_b64_tr_b16 v[240:241], v245 offset:14336
  ds_read_b64_tr_b16 v[242:243], v245 offset:14848
  v_mfma_f32_32x32x16_bf16 v[192:207], v[148:151], v[224:227], v[192:207]
  ds_write_b128 v252, v[176:179] offset:8192
  s_barrier
  v_add_u32 v244, 0, v246
  v_xor_b32 v245, 64, v244
  ds_read_b64_tr_b16 v[224:225], v244 offset:0
  ds_read_b64_tr_b16 v[226:227], v244 offset:512
  s_waitcnt lgkmcnt(8)
  v_mfma_f32_32x32x16_bf16 v[208:223], v[152:155], v[228:231], v[208:223]
  v_cvt_pk_bf16_f32 v184, v184, v185
  v_cvt_pk_bf16_f32 v185, v186, v187
  v_cvt_pk_bf16_f32 v186, v188, v189
  v_cvt_pk_bf16_f32 v187, v190, v191
  ds_read_b64_tr_b16 v[228:229], v245 offset:0
  ds_read_b64_tr_b16 v[230:231], v245 offset:512
  v_mfma_f32_32x32x16_bf16 v[192:207], v[152:155], v[232:235], v[192:207]
  ds_write_b128 v252, v[184:187] offset:12288
  ds_read_b64_tr_b16 v[232:233], v244 offset:2048
  ds_read_b64_tr_b16 v[234:235], v244 offset:2560
  s_waitcnt lgkmcnt(8)
  v_mfma_f32_32x32x16_bf16 v[208:223], v[156:159], v[236:239], v[208:223]
  ds_read_b64_tr_b16 v[236:237], v245 offset:2048
  ds_read_b64_tr_b16 v[238:239], v245 offset:2560
  v_mfma_f32_32x32x16_bf16 v[192:207], v[156:159], v[240:243], v[192:207]
  s_nop 3
  s_nop 7
  v_cvt_pk_bf16_f32 v208, v208, v209
  v_cvt_pk_bf16_f32 v209, v210, v211
  v_cvt_pk_bf16_f32 v210, v212, v213
  v_cvt_pk_bf16_f32 v211, v214, v215
  ds_write_b128 v252, v[208:211] offset:24576
  v_cvt_pk_bf16_f32 v216, v216, v217
  v_cvt_pk_bf16_f32 v217, v218, v219
  v_cvt_pk_bf16_f32 v218, v220, v221
  v_cvt_pk_bf16_f32 v219, v222, v223
  ds_write_b128 v252, v[216:219] offset:28672
  v_cvt_pk_bf16_f32 v192, v192, v193
  v_cvt_pk_bf16_f32 v193, v194, v195
  v_cvt_pk_bf16_f32 v194, v196, v197
  v_cvt_pk_bf16_f32 v195, v198, v199
  ds_write_b128 v252, v[192:195] offset:32768
  v_cvt_pk_bf16_f32 v200, v200, v201
  v_cvt_pk_bf16_f32 v201, v202, v203
  v_cvt_pk_bf16_f32 v202, v204, v205
  v_cvt_pk_bf16_f32 v203, v206, v207
  ds_write_b128 v252, v[200:203] offset:36864
  s_waitcnt lgkmcnt(0)
  s_barrier
  ds_read_b64_tr_b16 v[240:241], v244 offset:4096
  ds_read_b64_tr_b16 v[242:243], v244 offset:4608
  s_waitcnt lgkmcnt(11)
  v_mfma_f32_32x32x16_bf16 v[160:175], v[224:227], v[0:3], 0
  ds_read_b64_tr_b16 v[224:225], v245 offset:4096
  ds_read_b64_tr_b16 v[226:227], v245 offset:4608
  v_mfma_f32_32x32x16_bf16 v[176:191], v[228:231], v[0:3], 0
  ds_read_b64_tr_b16 v[228:229], v244 offset:6144
  ds_read_b64_tr_b16 v[230:231], v244 offset:6656
  s_waitcnt lgkmcnt(10)
  v_mfma_f32_32x32x16_bf16 v[160:175], v[232:235], v[4:7], v[160:175]
  ds_read_b64_tr_b16 v[232:233], v245 offset:6144
  ds_read_b64_tr_b16 v[234:235], v245 offset:6656
  v_mfma_f32_32x32x16_bf16 v[176:191], v[236:239], v[4:7], v[176:191]
  ds_read_b64_tr_b16 v[236:237], v244 offset:8192
  ds_read_b64_tr_b16 v[238:239], v244 offset:8704
  s_waitcnt lgkmcnt(6)
  v_mfma_f32_32x32x16_bf16 v[160:175], v[240:243], v[8:11], v[160:175]
  ds_read_b64_tr_b16 v[240:241], v245 offset:8192
  ds_read_b64_tr_b16 v[242:243], v245 offset:8704
  v_mfma_f32_32x32x16_bf16 v[176:191], v[224:227], v[8:11], v[176:191]
  ds_read_b64_tr_b16 v[224:225], v244 offset:10240
  ds_read_b64_tr_b16 v[226:227], v244 offset:10752
  s_waitcnt lgkmcnt(6)
  v_mfma_f32_32x32x16_bf16 v[160:175], v[228:231], v[12:15], v[160:175]
  ds_read_b64_tr_b16 v[228:229], v245 offset:10240
  ds_read_b64_tr_b16 v[230:231], v245 offset:10752
  v_mfma_f32_32x32x16_bf16 v[176:191], v[232:235], v[12:15], v[176:191]
  ds_read_b64_tr_b16 v[232:233], v244 offset:12288
  ds_read_b64_tr_b16 v[234:235], v244 offset:12800
  s_waitcnt lgkmcnt(6)
  v_mfma_f32_32x32x16_bf16 v[160:175], v[236:239], v[16:19], v[160:175]
  ds_read_b64_tr_b16 v[236:237], v245 offset:12288
  ds_read_b64_tr_b16 v[238:239], v245 offset:12800
  v_mfma_f32_32x32x16_bf16 v[176:191], v[240:243], v[16:19], v[176:191]
  ds_read_b64_tr_b16 v[240:241], v244 offset:14336
  ds_read_b64_tr_b16 v[242:243], v244 offset:14848
  s_waitcnt lgkmcnt(6)
  v_mfma_f32_32x32x16_bf16 v[160:175], v[224:227], v[20:23], v[160:175]
  ds_read_b64_tr_b16 v[224:225], v245 offset:14336
  ds_read_b64_tr_b16 v[226:227], v245 offset:14848
  v_mfma_f32_32x32x16_bf16 v[176:191], v[228:231], v[20:23], v[176:191]
  s_barrier
  v_add_u32 v244, 16384, v246
  v_xor_b32 v245, 64, v244
  ds_read_b64_tr_b16 v[228:229], v244 offset:0
  ds_read_b64_tr_b16 v[230:231], v244 offset:512
  s_waitcnt lgkmcnt(6)
  v_mfma_f32_32x32x16_bf16 v[160:175], v[232:235], v[24:27], v[160:175]
  ds_read_b64_tr_b16 v[232:233], v245 offset:0
  ds_read_b64_tr_b16 v[234:235], v245 offset:512
  v_mfma_f32_32x32x16_bf16 v[176:191], v[236:239], v[24:27], v[176:191]
  ds_read_b64_tr_b16 v[236:237], v244 offset:2048
  ds_read_b64_tr_b16 v[238:239], v244 offset:2560
  s_waitcnt lgkmcnt(6)
  v_mfma_f32_32x32x16_bf16 v[160:175], v[240:243], v[28:31], v[160:175]
  ds_read_b64_tr_b16 v[240:241], v245 offset:2048
  ds_read_b64_tr_b16 v[242:243], v245 offset:2560
  v_mfma_f32_32x32x16_bf16 v[176:191], v[224:227], v[28:31], v[176:191]
  ds_read_b64_tr_b16 v[224:225], v244 offset:4096
  ds_read_b64_tr_b16 v[226:227], v244 offset:4608
  s_waitcnt lgkmcnt(6)
  v_mfma_f32_32x32x16_bf16 v[160:175], v[228:231], v[32:35], v[160:175]
  ds_read_b64_tr_b16 v[228:229], v245 offset:4096
  ds_read_b64_tr_b16 v[230:231], v245 offset:4608
  v_mfma_f32_32x32x16_bf16 v[176:191], v[232:235], v[32:35], v[176:191]
  ds_read_b64_tr_b16 v[232:233], v244 offset:6144
  ds_read_b64_tr_b16 v[234:235], v244 offset:6656
  s_waitcnt lgkmcnt(6)
  v_mfma_f32_32x32x16_bf16 v[160:175], v[236:239], v[36:39], v[160:175]
  ds_read_b64_tr_b16 v[236:237], v245 offset:6144
  ds_read_b64_tr_b16 v[238:239], v245 offset:6656
  v_mfma_f32_32x32x16_bf16 v[176:191], v[240:243], v[36:39], v[176:191]
  ds_read_b64_tr_b16 v[240:241], v244 offset:8192
  ds_read_b64_tr_b16 v[242:243], v244 offset:8704
  s_waitcnt lgkmcnt(6)
  v_mfma_f32_32x32x16_bf16 v[160:175], v[224:227], v[40:43], v[160:175]
  ds_read_b64_tr_b16 v[224:225], v245 offset:8192
  ds_read_b64_tr_b16 v[226:227], v245 offset:8704
  v_mfma_f32_32x32x16_bf16 v[176:191], v[228:231], v[40:43], v[176:191]
  ds_read_b64_tr_b16 v[228:229], v244 offset:10240
  ds_read_b64_tr_b16 v[230:231], v244 offset:10752
  s_waitcnt lgkmcnt(6)
  v_mfma_f32_32x32x16_bf16 v[160:175], v[232:235], v[44:47], v[160:175]
  ds_read_b64_tr_b16 v[232:233], v245 offset:10240
  ds_read_b64_tr_b16 v[234:235], v245 offset:10752
  v_mfma_f32_32x32x16_bf16 v[176:191], v[236:239], v[44:47], v[176:191]
  ds_read_b64_tr_b16 v[236:237], v244 offset:12288
  ds_read_b64_tr_b16 v[238:239], v244 offset:12800
  s_waitcnt lgkmcnt(6)
  v_mfma_f32_32x32x16_bf16 v[160:175], v[240:243], v[48:51], v[160:175]
  ds_read_b64_tr_b16 v[240:241], v245 offset:12288
  ds_read_b64_tr_b16 v[242:243], v245 offset:12800
  v_mfma_f32_32x32x16_bf16 v[176:191], v[224:227], v[48:51], v[176:191]
  ds_read_b64_tr_b16 v[224:225], v244 offset:14336
  ds_read_b64_tr_b16 v[226:227], v244 offset:14848
  s_waitcnt lgkmcnt(6)
  v_mfma_f32_32x32x16_bf16 v[160:175], v[228:231], v[52:55], v[160:175]
  ds_read_b64_tr_b16 v[228:229], v245 offset:14336
  ds_read_b64_tr_b16 v[230:231], v245 offset:14848
  v_mfma_f32_32x32x16_bf16 v[176:191], v[232:235], v[52:55], v[176:191]
  s_barrier
  v_add_u32 v244, 32768, v246
  v_xor_b32 v245, 64, v244
  ds_read_b64_tr_b16 v[232:233], v244 offset:0
  ds_read_b64_tr_b16 v[234:235], v244 offset:512
  s_waitcnt lgkmcnt(6)
  v_mfma_f32_32x32x16_bf16 v[160:175], v[236:239], v[56:59], v[160:175]
  ds_read_b64_tr_b16 v[236:237], v245 offset:0
  ds_read_b64_tr_b16 v[238:239], v245 offset:512
  v_mfma_f32_32x32x16_bf16 v[176:191], v[240:243], v[56:59], v[176:191]
  ds_read_b64_tr_b16 v[240:241], v244 offset:2048
  ds_read_b64_tr_b16 v[242:243], v244 offset:2560
  s_waitcnt lgkmcnt(6)
  v_mfma_f32_32x32x16_bf16 v[160:175], v[224:227], v[60:63], v[160:175]
  ds_read_b64_tr_b16 v[224:225], v245 offset:2048
  ds_read_b64_tr_b16 v[226:227], v245 offset:2560
  v_mfma_f32_32x32x16_bf16 v[176:191], v[228:231], v[60:63], v[176:191]
  ds_read_b64_tr_b16 v[228:229], v244 offset:4096
  ds_read_b64_tr_b16 v[230:231], v244 offset:4608
  s_waitcnt lgkmcnt(6)
  v_mfma_f32_32x32x16_bf16 v[160:175], v[232:235], v[64:67], v[160:175]
  ds_read_b64_tr_b16 v[232:233], v245 offset:4096
  ds_read_b64_tr_b16 v[234:235], v245 offset:4608
  v_mfma_f32_32x32x16_bf16 v[176:191], v[236:239], v[64:67], v[176:191]
  ds_read_b64_tr_b16 v[236:237], v244 offset:6144
  ds_read_b64_tr_b16 v[238:239], v244 offset:6656
  s_waitcnt lgkmcnt(6)
  v_mfma_f32_32x32x16_bf16 v[160:175], v[240:243], v[68:71], v[160:175]
  ds_read_b64_tr_b16 v[240:241], v245 offset:6144
  ds_read_b64_tr_b16 v[242:243], v245 offset:6656
  v_mfma_f32_32x32x16_bf16 v[176:191], v[224:227], v[68:71], v[176:191]
  ds_read_b64_tr_b16 v[224:225], v244 offset:8192
  ds_read_b64_tr_b16 v[226:227], v244 offset:8704
  s_waitcnt lgkmcnt(6)
  v_mfma_f32_32x32x16_bf16 v[160:175], v[228:231], v[72:75], v[160:175]
  ds_read_b64_tr_b16 v[228:229], v245 offset:8192
  ds_read_b64_tr_b16 v[230:231], v245 offset:8704
  v_mfma_f32_32x32x16_bf16 v[176:191], v[232:235], v[72:75], v[176:191]
  ds_read_b64_tr_b16 v[232:233], v244 offset:10240
  ds_read_b64_tr_b16 v[234:235], v244 offset:10752
  s_waitcnt lgkmcnt(6)
  v_mfma_f32_32x32x16_bf16 v[160:175], v[236:239], v[76:79], v[160:175]
  ds_read_b64_tr_b16 v[236:237], v245 offset:10240
  ds_read_b64_tr_b16 v[238:239], v245 offset:10752
  v_mfma_f32_32x32x16_bf16 v[176:191], v[240:243], v[76:79], v[176:191]
  ds_read_b64_tr_b16 v[240:241], v244 offset:12288
  ds_read_b64_tr_b16 v[242:243], v244 offset:12800
  s_waitcnt lgkmcnt(6)
  v_mfma_f32_32x32x16_bf16 v[160:175], v[224:227], v[80:83], v[160:175]
  ds_read_b64_tr_b16 v[224:225], v245 offset:12288
  ds_read_b64_tr_b16 v[226:227], v245 offset:12800
  v_mfma_f32_32x32x16_bf16 v[176:191], v[228:231], v[80:83], v[176:191]
  ds_read_b64_tr_b16 v[228:229], v244 offset:14336
  ds_read_b64_tr_b16 v[230:231], v244 offset:14848
  s_waitcnt lgkmcnt(6)
  v_mfma_f32_32x32x16_bf16 v[160:175], v[232:235], v[84:87], v[160:175]
  ds_read_b64_tr_b16 v[232:233], v245 offset:14336
  ds_read_b64_tr_b16 v[234:235], v245 offset:14848
  v_mfma_f32_32x32x16_bf16 v[176:191], v[236:239], v[84:87], v[176:191]
  s_barrier
  v_add_u32 v244, 49152, v246
  v_xor_b32 v245, 64, v244
  ds_read_b64_tr_b16 v[236:237], v244 offset:0
  ds_read_b64_tr_b16 v[238:239], v244 offset:512
  s_waitcnt lgkmcnt(6)
  v_mfma_f32_32x32x16_bf16 v[160:175], v[240:243], v[88:91], v[160:175]
  ds_read_b64_tr_b16 v[240:241], v245 offset:0
  ds_read_b64_tr_b16 v[242:243], v245 offset:512
  v_mfma_f32_32x32x16_bf16 v[176:191], v[224:227], v[88:91], v[176:191]
  ds_read_b64_tr_b16 v[224:225], v244 offset:2048
  ds_read_b64_tr_b16 v[226:227], v244 offset:2560
  s_waitcnt lgkmcnt(6)
  v_mfma_f32_32x32x16_bf16 v[160:175], v[228:231], v[92:95], v[160:175]
  ds_read_b64_tr_b16 v[228:229], v245 offset:2048
  ds_read_b64_tr_b16 v[230:231], v245 offset:2560
  v_mfma_f32_32x32x16_bf16 v[176:191], v[232:235], v[92:95], v[176:191]
  ds_read_b64_tr_b16 v[232:233], v244 offset:4096
  ds_read_b64_tr_b16 v[234:235], v244 offset:4608
  s_waitcnt lgkmcnt(6)
  v_mfma_f32_32x32x16_bf16 v[160:175], v[236:239], v[96:99], v[160:175]
  ds_read_b64_tr_b16 v[236:237], v245 offset:4096
  ds_read_b64_tr_b16 v[238:239], v245 offset:4608
  v_mfma_f32_32x32x16_bf16 v[176:191], v[240:243], v[96:99], v[176:191]
  ds_read_b64_tr_b16 v[240:241], v244 offset:6144
  ds_read_b64_tr_b16 v[242:243], v244 offset:6656
  s_waitcnt lgkmcnt(6)
  v_mfma_f32_32x32x16_bf16 v[160:175], v[224:227], v[100:103], v[160:175]
  ds_read_b64_tr_b16 v[224:225], v245 offset:6144
  ds_read_b64_tr_b16 v[226:227], v245 offset:6656
  v_mfma_f32_32x32x16_bf16 v[176:191], v[228:231], v[100:103], v[176:191]
  ds_read_b64_tr_b16 v[228:229], v244 offset:8192
  ds_read_b64_tr_b16 v[230:231], v244 offset:8704
  s_waitcnt lgkmcnt(6)
  v_mfma_f32_32x32x16_bf16 v[160:175], v[232:235], v[104:107], v[160:175]
  ds_read_b64_tr_b16 v[232:233], v245 offset:8192
  ds_read_b64_tr_b16 v[234:235], v245 offset:8704
  v_mfma_f32_32x32x16_bf16 v[176:191], v[236:239], v[104:107], v[176:191]
  ds_read_b64_tr_b16 v[236:237], v244 offset:10240
  ds_read_b64_tr_b16 v[238:239], v244 offset:10752
  s_waitcnt lgkmcnt(6)
  v_mfma_f32_32x32x16_bf16 v[160:175], v[240:243], v[108:111], v[160:175]
  ds_read_b64_tr_b16 v[240:241], v245 offset:10240
  ds_read_b64_tr_b16 v[242:243], v245 offset:10752
  v_mfma_f32_32x32x16_bf16 v[176:191], v[224:227], v[108:111], v[176:191]
  ds_read_b64_tr_b16 v[224:225], v244 offset:12288
  ds_read_b64_tr_b16 v[226:227], v244 offset:12800
  s_waitcnt lgkmcnt(6)
  v_mfma_f32_32x32x16_bf16 v[160:175], v[228:231], v[112:115], v[160:175]
  ds_read_b64_tr_b16 v[228:229], v245 offset:12288
  ds_read_b64_tr_b16 v[230:231], v245 offset:12800
  v_mfma_f32_32x32x16_bf16 v[176:191], v[232:235], v[112:115], v[176:191]
  ds_read_b64_tr_b16 v[232:233], v244 offset:14336
  ds_read_b64_tr_b16 v[234:235], v244 offset:14848
  s_waitcnt lgkmcnt(6)
  v_mfma_f32_32x32x16_bf16 v[160:175], v[236:239], v[116:119], v[160:175]
  ds_read_b64_tr_b16 v[236:237], v245 offset:14336
  ds_read_b64_tr_b16 v[238:239], v245 offset:14848
  v_mfma_f32_32x32x16_bf16 v[176:191], v[240:243], v[116:119], v[176:191]
  s_barrier
  v_add_u32 v244, 65536, v246
  v_xor_b32 v245, 64, v244
  ds_read_b64_tr_b16 v[240:241], v244 offset:0
  ds_read_b64_tr_b16 v[242:243], v244 offset:512
  s_waitcnt lgkmcnt(6)
  v_mfma_f32_32x32x16_bf16 v[160:175], v[224:227], v[120:123], v[160:175]
  ds_read_b64_tr_b16 v[224:225], v245 offset:0
  ds_read_b64_tr_b16 v[226:227], v245 offset:512
  v_mfma_f32_32x32x16_bf16 v[176:191], v[228:231], v[120:123], v[176:191]
  ds_read_b64_tr_b16 v[228:229], v244 offset:2048
  ds_read_b64_tr_b16 v[230:231], v244 offset:2560
  s_waitcnt lgkmcnt(6)
  v_mfma_f32_32x32x16_bf16 v[160:175], v[232:235], v[124:127], v[160:175]
  ds_read_b64_tr_b16 v[232:233], v245 offset:2048
  ds_read_b64_tr_b16 v[234:235], v245 offset:2560
  v_mfma_f32_32x32x16_bf16 v[176:191], v[236:239], v[124:127], v[176:191]
  ds_read_b64_tr_b16 v[236:237], v244 offset:4096
  ds_read_b64_tr_b16 v[238:239], v244 offset:4608
  s_waitcnt lgkmcnt(6)
  v_mfma_f32_32x32x16_bf16 v[160:175], v[240:243], v[128:131], v[160:175]
  ds_read_b64_tr_b16 v[240:241], v245 offset:4096
  ds_read_b64_tr_b16 v[242:243], v245 offset:4608
  v_mfma_f32_32x32x16_bf16 v[176:191], v[224:227], v[128:131], v[176:191]
  ds_read_b64_tr_b16 v[224:225], v244 offset:6144
  ds_read_b64_tr_b16 v[226:227], v244 offset:6656
  s_waitcnt lgkmcnt(6)
  v_mfma_f32_32x32x16_bf16 v[160:175], v[228:231], v[132:135], v[160:175]
  ds_read_b64_tr_b16 v[228:229], v245 offset:6144
  ds_read_b64_tr_b16 v[230:231], v245 offset:6656
  v_mfma_f32_32x32x16_bf16 v[176:191], v[232:235], v[132:135], v[176:191]
  ds_read_b64_tr_b16 v[232:233], v244 offset:8192
  ds_read_b64_tr_b16 v[234:235], v244 offset:8704
  s_waitcnt lgkmcnt(6)
  v_mfma_f32_32x32x16_bf16 v[160:175], v[236:239], v[136:139], v[160:175]
  ds_read_b64_tr_b16 v[236:237], v245 offset:8192
  ds_read_b64_tr_b16 v[238:239], v245 offset:8704
  v_mfma_f32_32x32x16_bf16 v[176:191], v[240:243], v[136:139], v[176:191]
  ds_read_b64_tr_b16 v[240:241], v244 offset:10240
  ds_read_b64_tr_b16 v[242:243], v244 offset:10752
  s_waitcnt lgkmcnt(6)
  v_mfma_f32_32x32x16_bf16 v[160:175], v[224:227], v[140:143], v[160:175]
  ds_read_b64_tr_b16 v[224:225], v245 offset:10240
  ds_read_b64_tr_b16 v[226:227], v245 offset:10752
  v_mfma_f32_32x32x16_bf16 v[176:191], v[228:231], v[140:143], v[176:191]
  ds_read_b64_tr_b16 v[228:229], v244 offset:12288
  ds_read_b64_tr_b16 v[230:231], v244 offset:12800
  s_waitcnt lgkmcnt(6)
  v_mfma_f32_32x32x16_bf16 v[160:175], v[232:235], v[144:147], v[160:175]
  ds_read_b64_tr_b16 v[232:233], v245 offset:12288
  ds_read_b64_tr_b16 v[234:235], v245 offset:12800
  v_mfma_f32_32x32x16_bf16 v[176:191], v[236:239], v[144:147], v[176:191]
  ds_read_b64_tr_b16 v[236:237], v244 offset:14336
  ds_read_b64_tr_b16 v[238:239], v244 offset:14848
  s_waitcnt lgkmcnt(6)
  v_mfma_f32_32x32x16_bf16 v[160:175], v[240:243], v[148:151], v[160:175]
  ds_read_b64_tr_b16 v[240:241], v245 offset:14336
  ds_read_b64_tr_b16 v[242:243], v245 offset:14848
  v_mfma_f32_32x32x16_bf16 v[176:191], v[224:227], v[148:151], v[176:191]
  s_barrier
  v_add_u32 v244, 81920, v246
  v_xor_b32 v245, 64, v244
  ds_read_b64_tr_b16 v[224:225], v244 offset:0
  ds_read_b64_tr_b16 v[226:227], v244 offset:512
  s_waitcnt lgkmcnt(6)
  v_mfma_f32_32x32x16_bf16 v[160:175], v[228:231], v[152:155], v[160:175]
  ds_read_b64_tr_b16 v[228:229], v245 offset:0
  ds_read_b64_tr_b16 v[230:231], v245 offset:512
  v_mfma_f32_32x32x16_bf16 v[176:191], v[232:235], v[152:155], v[176:191]
  ds_read_b64_tr_b16 v[232:233], v244 offset:2048
  ds_read_b64_tr_b16 v[234:235], v244 offset:2560
  s_waitcnt lgkmcnt(6)
  v_mfma_f32_32x32x16_bf16 v[160:175], v[236:239], v[156:159], v[160:175]
  ds_read_b64_tr_b16 v[236:237], v245 offset:2048
  ds_read_b64_tr_b16 v[238:239], v245 offset:2560
  v_mfma_f32_32x32x16_bf16 v[176:191], v[240:243], v[156:159], v[176:191]
  ds_read_b64_tr_b16 v[240:241], v244 offset:4096
  ds_read_b64_tr_b16 v[242:243], v244 offset:4608
  s_waitcnt lgkmcnt(6)
  v_mfma_f32_32x32x16_bf16 v[192:207], v[224:227], v[0:3], 0
  ds_read_b64_tr_b16 v[224:225], v245 offset:4096
  ds_read_b64_tr_b16 v[226:227], v245 offset:4608
  v_mfma_f32_32x32x16_bf16 v[208:223], v[228:231], v[0:3], 0
  ds_read_b64_tr_b16 v[228:229], v244 offset:6144
  ds_read_b64_tr_b16 v[230:231], v244 offset:6656
  s_waitcnt lgkmcnt(6)
  v_mfma_f32_32x32x16_bf16 v[192:207], v[232:235], v[4:7], v[192:207]
  ds_read_b64_tr_b16 v[232:233], v245 offset:6144
  ds_read_b64_tr_b16 v[234:235], v245 offset:6656
  v_mfma_f32_32x32x16_bf16 v[208:223], v[236:239], v[4:7], v[208:223]
  v_mul_f32 v160, s97, v160
  v_mul_f32 v161, s97, v161
  v_mul_f32 v162, s97, v162
  ds_read_b64_tr_b16 v[236:237], v244 offset:8192
  ds_read_b64_tr_b16 v[238:239], v244 offset:8704
  s_waitcnt lgkmcnt(6)
  v_mfma_f32_32x32x16_bf16 v[192:207], v[240:243], v[8:11], v[192:207]
  v_mul_f32 v163, s97, v163
  v_exp_f32 v160, v160
  ds_read_b64_tr_b16 v[240:241], v245 offset:8192
  ds_read_b64_tr_b16 v[242:243], v245 offset:8704
  v_mfma_f32_32x32x16_bf16 v[208:223], v[224:227], v[8:11], v[208:223]
  v_exp_f32 v161, v161
  ds_read_b64_tr_b16 v[224:225], v244 offset:10240
  ds_read_b64_tr_b16 v[226:227], v244 offset:10752
  s_waitcnt lgkmcnt(6)
  v_mfma_f32_32x32x16_bf16 v[192:207], v[228:231], v[12:15], v[192:207]
  v_exp_f32 v162, v162
  ds_read_b64_tr_b16 v[228:229], v245 offset:10240
  ds_read_b64_tr_b16 v[230:231], v245 offset:10752
  v_mfma_f32_32x32x16_bf16 v[208:223], v[232:235], v[12:15], v[208:223]
  v_exp_f32 v163, v163
  v_add_f32 v160, 1.0, v160
  ds_read_b64_tr_b16 v[232:233], v244 offset:12288
  ds_read_b64_tr_b16 v[234:235], v244 offset:12800
  s_waitcnt lgkmcnt(6)
  v_mfma_f32_32x32x16_bf16 v[192:207], v[236:239], v[16:19], v[192:207]
  v_add_f32 v161, 1.0, v161
  v_add_f32 v162, 1.0, v162
  v_add_f32 v163, 1.0, v163
  ds_read_b64_tr_b16 v[236:237], v245 offset:12288
  ds_read_b64_tr_b16 v[238:239], v245 offset:12800
  v_mfma_f32_32x32x16_bf16 v[208:223], v[240:243], v[16:19], v[208:223]
  v_rcp_f32 v160, v160
  ds_read_b64_tr_b16 v[240:241], v244 offset:14336
  ds_read_b64_tr_b16 v[242:243], v244 offset:14848
  s_waitcnt lgkmcnt(6)
  v_mfma_f32_32x32x16_bf16 v[192:207], v[224:227], v[20:23], v[192:207]
  v_rcp_f32 v161, v161
  ds_read_b64_tr_b16 v[224:225], v245 offset:14336
  ds_read_b64_tr_b16 v[226:227], v245 offset:14848
  v_mfma_f32_32x32x16_bf16 v[208:223], v[228:231], v[20:23], v[208:223]
  v_rcp_f32 v162, v162
  s_barrier
  v_add_u32 v244, 98304, v246
  v_xor_b32 v245, 64, v244
  ds_read_b64_tr_b16 v[228:229], v244 offset:0
  ds_read_b64_tr_b16 v[230:231], v244 offset:512
  s_waitcnt lgkmcnt(6)
  v_mfma_f32_32x32x16_bf16 v[192:207], v[232:235], v[24:27], v[192:207]
  v_rcp_f32 v163, v163
  v_mul_f32 v164, s97, v164
  ds_read_b64_tr_b16 v[232:233], v245 offset:0
  ds_read_b64_tr_b16 v[234:235], v245 offset:512
  v_mfma_f32_32x32x16_bf16 v[208:223], v[236:239], v[24:27], v[208:223]
  v_mul_f32 v165, s97, v165
  v_mul_f32 v166, s97, v166
  v_mul_f32 v167, s97, v167
  ds_read_b64_tr_b16 v[236:237], v244 offset:2048
  ds_read_b64_tr_b16 v[238:239], v244 offset:2560
  s_waitcnt lgkmcnt(6)
  v_mfma_f32_32x32x16_bf16 v[192:207], v[240:243], v[28:31], v[192:207]
  v_exp_f32 v164, v164
  ds_read_b64_tr_b16 v[240:241], v245 offset:2048
  ds_read_b64_tr_b16 v[242:243], v245 offset:2560
  v_mfma_f32_32x32x16_bf16 v[208:223], v[224:227], v[28:31], v[208:223]
  v_exp_f32 v165, v165
  ds_read_b64_tr_b16 v[224:225], v244 offset:4096
  ds_read_b64_tr_b16 v[226:227], v244 offset:4608
  s_waitcnt lgkmcnt(6)
  v_mfma_f32_32x32x16_bf16 v[192:207], v[228:231], v[32:35], v[192:207]
  v_exp_f32 v166, v166
  ds_read_b64_tr_b16 v[228:229], v245 offset:4096
  ds_read_b64_tr_b16 v[230:231], v245 offset:4608
  v_mfma_f32_32x32x16_bf16 v[208:223], v[232:235], v[32:35], v[208:223]
  v_exp_f32 v167, v167
  v_add_f32 v164, 1.0, v164
  ds_read_b64_tr_b16 v[232:233], v244 offset:6144
  ds_read_b64_tr_b16 v[234:235], v244 offset:6656
  s_waitcnt lgkmcnt(6)
  v_mfma_f32_32x32x16_bf16 v[192:207], v[236:239], v[36:39], v[192:207]
  v_add_f32 v165, 1.0, v165
  v_add_f32 v166, 1.0, v166
  v_add_f32 v167, 1.0, v167
  ds_read_b64_tr_b16 v[236:237], v245 offset:6144
  ds_read_b64_tr_b16 v[238:239], v245 offset:6656
  v_mfma_f32_32x32x16_bf16 v[208:223], v[240:243], v[36:39], v[208:223]
  v_rcp_f32 v164, v164
  ds_read_b64_tr_b16 v[240:241], v244 offset:8192
  ds_read_b64_tr_b16 v[242:243], v244 offset:8704
  s_waitcnt lgkmcnt(6)
  v_mfma_f32_32x32x16_bf16 v[192:207], v[224:227], v[40:43], v[192:207]
  v_rcp_f32 v165, v165
  ds_read_b64_tr_b16 v[224:225], v245 offset:8192
  ds_read_b64_tr_b16 v[226:227], v245 offset:8704
  v_mfma_f32_32x32x16_bf16 v[208:223], v[228:231], v[40:43], v[208:223]
  v_rcp_f32 v166, v166
  ds_read_b64_tr_b16 v[228:229], v244 offset:10240
  ds_read_b64_tr_b16 v[230:231], v244 offset:10752
  s_waitcnt lgkmcnt(6)
  v_mfma_f32_32x32x16_bf16 v[192:207], v[232:235], v[44:47], v[192:207]
  v_rcp_f32 v167, v167
  v_mul_f32 v168, s97, v168
  ds_read_b64_tr_b16 v[232:233], v245 offset:10240
  ds_read_b64_tr_b16 v[234:235], v245 offset:10752
  v_mfma_f32_32x32x16_bf16 v[208:223], v[236:239], v[44:47], v[208:223]
  v_mul_f32 v169, s97, v169
  v_mul_f32 v170, s97, v170
  v_mul_f32 v171, s97, v171
  ds_read_b64_tr_b16 v[236:237], v244 offset:12288
  ds_read_b64_tr_b16 v[238:239], v244 offset:12800
  s_waitcnt lgkmcnt(6)
  v_mfma_f32_32x32x16_bf16 v[192:207], v[240:243], v[48:51], v[192:207]
  v_exp_f32 v168, v168
  ds_read_b64_tr_b16 v[240:241], v245 offset:12288
  ds_read_b64_tr_b16 v[242:243], v245 offset:12800
  v_mfma_f32_32x32x16_bf16 v[208:223], v[224:227], v[48:51], v[208:223]
  v_exp_f32 v169, v169
  ds_read_b64_tr_b16 v[224:225], v244 offset:14336
  ds_read_b64_tr_b16 v[226:227], v244 offset:14848
  s_waitcnt lgkmcnt(6)
  v_mfma_f32_32x32x16_bf16 v[192:207], v[228:231], v[52:55], v[192:207]
  v_exp_f32 v170, v170
  ds_read_b64_tr_b16 v[228:229], v245 offset:14336
  ds_read_b64_tr_b16 v[230:231], v245 offset:14848
  v_mfma_f32_32x32x16_bf16 v[208:223], v[232:235], v[52:55], v[208:223]
  v_exp_f32 v171, v171
  v_add_f32 v168, 1.0, v168
  s_barrier
  v_add_u32 v244, 0, v246
  v_xor_b32 v245, 64, v244
  ds_read_b64_tr_b16 v[232:233], v244 offset:0
  ds_read_b64_tr_b16 v[234:235], v244 offset:512
  s_waitcnt lgkmcnt(6)
  v_mfma_f32_32x32x16_bf16 v[192:207], v[236:239], v[56:59], v[192:207]
  v_add_f32 v169, 1.0, v169
  v_add_f32 v170, 1.0, v170
  v_add_f32 v171, 1.0, v171
  ds_read_b64_tr_b16 v[236:237], v245 offset:0
  ds_read_b64_tr_b16 v[238:239], v245 offset:512
  v_mfma_f32_32x32x16_bf16 v[208:223], v[240:243], v[56:59], v[208:223]
  v_rcp_f32 v168, v168
  ds_read_b64_tr_b16 v[240:241], v244 offset:2048
  ds_read_b64_tr_b16 v[242:243], v244 offset:2560
  s_waitcnt lgkmcnt(6)
  v_mfma_f32_32x32x16_bf16 v[192:207], v[224:227], v[60:63], v[192:207]
  v_rcp_f32 v169, v169
  ds_read_b64_tr_b16 v[224:225], v245 offset:2048
  ds_read_b64_tr_b16 v[226:227], v245 offset:2560
  v_mfma_f32_32x32x16_bf16 v[208:223], v[228:231], v[60:63], v[208:223]
  v_rcp_f32 v170, v170
  ds_read_b64_tr_b16 v[228:229], v244 offset:4096
  ds_read_b64_tr_b16 v[230:231], v244 offset:4608
  s_waitcnt lgkmcnt(6)
  v_mfma_f32_32x32x16_bf16 v[192:207], v[232:235], v[64:67], v[192:207]
  v_rcp_f32 v171, v171
  v_mul_f32 v172, s97, v172
  ds_read_b64_tr_b16 v[232:233], v245 offset:4096
  ds_read_b64_tr_b16 v[234:235], v245 offset:4608
  v_mfma_f32_32x32x16_bf16 v[208:223], v[236:239], v[64:67], v[208:223]
  v_mul_f32 v173, s97, v173
  v_mul_f32 v174, s97, v174
  v_mul_f32 v175, s97, v175
  ds_read_b64_tr_b16 v[236:237], v244 offset:6144
  ds_read_b64_tr_b16 v[238:239], v244 offset:6656
  s_waitcnt lgkmcnt(6)
  v_mfma_f32_32x32x16_bf16 v[192:207], v[240:243], v[68:71], v[192:207]
  v_exp_f32 v172, v172
  ds_read_b64_tr_b16 v[240:241], v245 offset:6144
  ds_read_b64_tr_b16 v[242:243], v245 offset:6656
  v_mfma_f32_32x32x16_bf16 v[208:223], v[224:227], v[68:71], v[208:223]
  v_exp_f32 v173, v173
  ds_read_b64_tr_b16 v[224:225], v244 offset:8192
  ds_read_b64_tr_b16 v[226:227], v244 offset:8704
  s_waitcnt lgkmcnt(6)
  v_mfma_f32_32x32x16_bf16 v[192:207], v[228:231], v[72:75], v[192:207]
  v_exp_f32 v174, v174
  ds_read_b64_tr_b16 v[228:229], v245 offset:8192
  ds_read_b64_tr_b16 v[230:231], v245 offset:8704
  v_mfma_f32_32x32x16_bf16 v[208:223], v[232:235], v[72:75], v[208:223]
  v_exp_f32 v175, v175
  v_add_f32 v172, 1.0, v172
  ds_read_b64_tr_b16 v[232:233], v244 offset:10240
  ds_read_b64_tr_b16 v[234:235], v244 offset:10752
  s_waitcnt lgkmcnt(6)
  v_mfma_f32_32x32x16_bf16 v[192:207], v[236:239], v[76:79], v[192:207]
  v_add_f32 v173, 1.0, v173
  v_add_f32 v174, 1.0, v174
  v_add_f32 v175, 1.0, v175
  ds_read_b64_tr_b16 v[236:237], v245 offset:10240
  ds_read_b64_tr_b16 v[238:239], v245 offset:10752
  v_mfma_f32_32x32x16_bf16 v[208:223], v[240:243], v[76:79], v[208:223]
  v_rcp_f32 v172, v172
  ds_read_b64_tr_b16 v[240:241], v244 offset:12288
  ds_read_b64_tr_b16 v[242:243], v244 offset:12800
  s_waitcnt lgkmcnt(6)
  v_mfma_f32_32x32x16_bf16 v[192:207], v[224:227], v[80:83], v[192:207]
  v_rcp_f32 v173, v173
  ds_read_b64_tr_b16 v[224:225], v245 offset:12288
  ds_read_b64_tr_b16 v[226:227], v245 offset:12800
  v_mfma_f32_32x32x16_bf16 v[208:223], v[228:231], v[80:83], v[208:223]
  v_rcp_f32 v174, v174
  ds_read_b64_tr_b16 v[228:229], v244 offset:14336
  ds_read_b64_tr_b16 v[230:231], v244 offset:14848
  s_waitcnt lgkmcnt(6)
  v_mfma_f32_32x32x16_bf16 v[192:207], v[232:235], v[84:87], v[192:207]
  v_rcp_f32 v175, v175
  v_mul_f32 v176, s97, v176
  ds_read_b64_tr_b16 v[232:233], v245 offset:14336
  ds_read_b64_tr_b16 v[234:235], v245 offset:14848
  v_mfma_f32_32x32x16_bf16 v[208:223], v[236:239], v[84:87], v[208:223]
  v_mul_f32 v177, s97, v177
  v_mul_f32 v178, s97, v178
  v_mul_f32 v179, s97, v179
  s_barrier
  v_add_u32 v244, 16384, v246
  v_xor_b32 v245, 64, v244
  ds_read_b64_tr_b16 v[236:237], v244 offset:0
  ds_read_b64_tr_b16 v[238:239], v244 offset:512
  s_waitcnt lgkmcnt(6)
  v_mfma_f32_32x32x16_bf16 v[192:207], v[240:243], v[88:91], v[192:207]
  v_exp_f32 v176, v176
  ds_read_b64_tr_b16 v[240:241], v245 offset:0
  ds_read_b64_tr_b16 v[242:243], v245 offset:512
  v_mfma_f32_32x32x16_bf16 v[208:223], v[224:227], v[88:91], v[208:223]
  v_exp_f32 v177, v177
  ds_read_b64_tr_b16 v[224:225], v244 offset:2048
  ds_read_b64_tr_b16 v[226:227], v244 offset:2560
  s_waitcnt lgkmcnt(6)
  v_mfma_f32_32x32x16_bf16 v[192:207], v[228:231], v[92:95], v[192:207]
  v_exp_f32 v178, v178
  ds_read_b64_tr_b16 v[228:229], v245 offset:2048
  ds_read_b64_tr_b16 v[230:231], v245 offset:2560
  v_mfma_f32_32x32x16_bf16 v[208:223], v[232:235], v[92:95], v[208:223]
  v_exp_f32 v179, v179
  v_add_f32 v176, 1.0, v176
  ds_read_b64_tr_b16 v[232:233], v244 offset:4096
  ds_read_b64_tr_b16 v[234:235], v244 offset:4608
  s_waitcnt lgkmcnt(6)
  v_mfma_f32_32x32x16_bf16 v[192:207], v[236:239], v[96:99], v[192:207]
  v_add_f32 v177, 1.0, v177
  v_add_f32 v178, 1.0, v178
  v_add_f32 v179, 1.0, v179
  ds_read_b64_tr_b16 v[236:237], v245 offset:4096
  ds_read_b64_tr_b16 v[238:239], v245 offset:4608
  v_mfma_f32_32x32x16_bf16 v[208:223], v[240:243], v[96:99], v[208:223]
  v_rcp_f32 v176, v176
  ds_read_b64_tr_b16 v[240:241], v244 offset:6144
  ds_read_b64_tr_b16 v[242:243], v244 offset:6656
  s_waitcnt lgkmcnt(6)
  v_mfma_f32_32x32x16_bf16 v[192:207], v[224:227], v[100:103], v[192:207]
  v_rcp_f32 v177, v177
  ds_read_b64_tr_b16 v[224:225], v245 offset:6144
  ds_read_b64_tr_b16 v[226:227], v245 offset:6656
  v_mfma_f32_32x32x16_bf16 v[208:223], v[228:231], v[100:103], v[208:223]
  v_rcp_f32 v178, v178
  ds_read_b64_tr_b16 v[228:229], v244 offset:8192
  ds_read_b64_tr_b16 v[230:231], v244 offset:8704
  s_waitcnt lgkmcnt(6)
  v_mfma_f32_32x32x16_bf16 v[192:207], v[232:235], v[104:107], v[192:207]
  v_rcp_f32 v179, v179
  v_mul_f32 v180, s97, v180
  ds_read_b64_tr_b16 v[232:233], v245 offset:8192
  ds_read_b64_tr_b16 v[234:235], v245 offset:8704
  v_mfma_f32_32x32x16_bf16 v[208:223], v[236:239], v[104:107], v[208:223]
  v_mul_f32 v181, s97, v181
  v_mul_f32 v182, s97, v182
  v_mul_f32 v183, s97, v183
  ds_read_b64_tr_b16 v[236:237], v244 offset:10240
  ds_read_b64_tr_b16 v[238:239], v244 offset:10752
  s_waitcnt lgkmcnt(6)
  v_mfma_f32_32x32x16_bf16 v[192:207], v[240:243], v[108:111], v[192:207]
  v_exp_f32 v180, v180
  ds_read_b64_tr_b16 v[240:241], v245 offset:10240
  ds_read_b64_tr_b16 v[242:243], v245 offset:10752
  v_mfma_f32_32x32x16_bf16 v[208:223], v[224:227], v[108:111], v[208:223]
  v_exp_f32 v181, v181
  ds_read_b64_tr_b16 v[224:225], v244 offset:12288
  ds_read_b64_tr_b16 v[226:227], v244 offset:12800
  s_waitcnt lgkmcnt(6)
  v_mfma_f32_32x32x16_bf16 v[192:207], v[228:231], v[112:115], v[192:207]
  v_exp_f32 v182, v182
  ds_read_b64_tr_b16 v[228:229], v245 offset:12288
  ds_read_b64_tr_b16 v[230:231], v245 offset:12800
  v_mfma_f32_32x32x16_bf16 v[208:223], v[232:235], v[112:115], v[208:223]
  v_exp_f32 v183, v183
  v_add_f32 v180, 1.0, v180
  ds_read_b64_tr_b16 v[232:233], v244 offset:14336
  ds_read_b64_tr_b16 v[234:235], v244 offset:14848
  s_waitcnt lgkmcnt(6)
  v_mfma_f32_32x32x16_bf16 v[192:207], v[236:239], v[116:119], v[192:207]
  v_add_f32 v181, 1.0, v181
  v_add_f32 v182, 1.0, v182
  v_add_f32 v183, 1.0, v183
  ds_read_b64_tr_b16 v[236:237], v245 offset:14336
  ds_read_b64_tr_b16 v[238:239], v245 offset:14848
  v_mfma_f32_32x32x16_bf16 v[208:223], v[240:243], v[116:119], v[208:223]
  v_rcp_f32 v180, v180
  s_barrier
  v_add_u32 v244, 32768, v246
  v_xor_b32 v245, 64, v244
  ds_read_b64_tr_b16 v[240:241], v244 offset:0
  ds_read_b64_tr_b16 v[242:243], v244 offset:512
  s_waitcnt lgkmcnt(6)
  v_mfma_f32_32x32x16_bf16 v[192:207], v[224:227], v[120:123], v[192:207]
  v_rcp_f32 v181, v181
  ds_read_b64_tr_b16 v[224:225], v245 offset:0
  ds_read_b64_tr_b16 v[226:227], v245 offset:512
  v_mfma_f32_32x32x16_bf16 v[208:223], v[228:231], v[120:123], v[208:223]
  v_rcp_f32 v182, v182
  ds_read_b64_tr_b16 v[228:229], v244 offset:2048
  ds_read_b64_tr_b16 v[230:231], v244 offset:2560
  s_waitcnt lgkmcnt(6)
  v_mfma_f32_32x32x16_bf16 v[192:207], v[232:235], v[124:127], v[192:207]
  v_rcp_f32 v183, v183
  v_mul_f32 v184, s97, v184
  ds_read_b64_tr_b16 v[232:233], v245 offset:2048
  ds_read_b64_tr_b16 v[234:235], v245 offset:2560
  v_mfma_f32_32x32x16_bf16 v[208:223], v[236:239], v[124:127], v[208:223]
  v_mul_f32 v185, s97, v185
  v_mul_f32 v186, s97, v186
  v_mul_f32 v187, s97, v187
  ds_read_b64_tr_b16 v[236:237], v244 offset:4096
  ds_read_b64_tr_b16 v[238:239], v244 offset:4608
  s_waitcnt lgkmcnt(6)
  v_mfma_f32_32x32x16_bf16 v[192:207], v[240:243], v[128:131], v[192:207]
  v_exp_f32 v184, v184
  ds_read_b64_tr_b16 v[240:241], v245 offset:4096
  ds_read_b64_tr_b16 v[242:243], v245 offset:4608
  v_mfma_f32_32x32x16_bf16 v[208:223], v[224:227], v[128:131], v[208:223]
  v_exp_f32 v185, v185
  ds_read_b64_tr_b16 v[224:225], v244 offset:6144
  ds_read_b64_tr_b16 v[226:227], v244 offset:6656
  s_waitcnt lgkmcnt(6)
  v_mfma_f32_32x32x16_bf16 v[192:207], v[228:231], v[132:135], v[192:207]
  v_exp_f32 v186, v186
  ds_read_b64_tr_b16 v[228:229], v245 offset:6144
  ds_read_b64_tr_b16 v[230:231], v245 offset:6656
  v_mfma_f32_32x32x16_bf16 v[208:223], v[232:235], v[132:135], v[208:223]
  v_exp_f32 v187, v187
  v_add_f32 v184, 1.0, v184
  ds_read_b64_tr_b16 v[232:233], v244 offset:8192
  ds_read_b64_tr_b16 v[234:235], v244 offset:8704
  s_waitcnt lgkmcnt(6)
  v_mfma_f32_32x32x16_bf16 v[192:207], v[236:239], v[136:139], v[192:207]
  v_add_f32 v185, 1.0, v185
  v_add_f32 v186, 1.0, v186
  v_add_f32 v187, 1.0, v187
  ds_read_b64_tr_b16 v[236:237], v245 offset:8192
  ds_read_b64_tr_b16 v[238:239], v245 offset:8704
  v_mfma_f32_32x32x16_bf16 v[208:223], v[240:243], v[136:139], v[208:223]
  v_rcp_f32 v184, v184
  ds_read_b64_tr_b16 v[240:241], v244 offset:10240
  ds_read_b64_tr_b16 v[242:243], v244 offset:10752
  s_waitcnt lgkmcnt(6)
  v_mfma_f32_32x32x16_bf16 v[192:207], v[224:227], v[140:143], v[192:207]
  v_rcp_f32 v185, v185
  ds_read_b64_tr_b16 v[224:225], v245 offset:10240
  ds_read_b64_tr_b16 v[226:227], v245 offset:10752
  v_mfma_f32_32x32x16_bf16 v[208:223], v[228:231], v[140:143], v[208:223]
  v_rcp_f32 v186, v186
  ds_read_b64_tr_b16 v[228:229], v244 offset:12288
  ds_read_b64_tr_b16 v[230:231], v244 offset:12800
  s_waitcnt lgkmcnt(6)
  v_mfma_f32_32x32x16_bf16 v[192:207], v[232:235], v[144:147], v[192:207]
  v_rcp_f32 v187, v187
  v_mul_f32 v188, s97, v188
  ds_read_b64_tr_b16 v[232:233], v245 offset:12288
  ds_read_b64_tr_b16 v[234:235], v245 offset:12800
  v_mfma_f32_32x32x16_bf16 v[208:223], v[236:239], v[144:147], v[208:223]
  v_mul_f32 v189, s97, v189
  v_mul_f32 v190, s97, v190
  v_mul_f32 v191, s97, v191
  ds_read_b64_tr_b16 v[236:237], v244 offset:14336
  ds_read_b64_tr_b16 v[238:239], v244 offset:14848
  s_waitcnt lgkmcnt(6)
  v_mfma_f32_32x32x16_bf16 v[192:207], v[240:243], v[148:151], v[192:207]
  v_exp_f32 v188, v188
  ds_read_b64_tr_b16 v[240:241], v245 offset:14336
  ds_read_b64_tr_b16 v[242:243], v245 offset:14848
  v_mfma_f32_32x32x16_bf16 v[208:223], v[224:227], v[148:151], v[208:223]
  v_exp_f32 v189, v189
  v_exp_f32 v190, v190
  s_barrier
  v_add_u32 v244, 49152, v246
  v_xor_b32 v245, 64, v244
  ds_read_b64_tr_b16 v[224:225], v244 offset:0
  ds_read_b64_tr_b16 v[226:227], v244 offset:512
  s_waitcnt lgkmcnt(6)
  v_mfma_f32_32x32x16_bf16 v[192:207], v[228:231], v[152:155], v[192:207]
  v_exp_f32 v191, v191
  v_add_f32 v188, 1.0, v188
  v_add_f32 v189, 1.0, v189
  ds_read_b64_tr_b16 v[228:229], v245 offset:0
  ds_read_b64_tr_b16 v[230:231], v245 offset:512
  v_mfma_f32_32x32x16_bf16 v[208:223], v[232:235], v[152:155], v[208:223]
  v_add_f32 v190, 1.0, v190
  v_add_f32 v191, 1.0, v191
  v_rcp_f32 v188, v188
  ds_read_b64_tr_b16 v[232:233], v244 offset:2048
  ds_read_b64_tr_b16 v[234:235], v244 offset:2560
  s_waitcnt lgkmcnt(6)
  v_mfma_f32_32x32x16_bf16 v[192:207], v[236:239], v[156:159], v[192:207]
  v_rcp_f32 v189, v189
  v_rcp_f32 v190, v190
  v_rcp_f32 v191, v191
  ds_read_b64_tr_b16 v[236:237], v245 offset:2048
  ds_read_b64_tr_b16 v[238:239], v245 offset:2560
  v_mfma_f32_32x32x16_bf16 v[208:223], v[240:243], v[156:159], v[208:223]
  s_nop 3
  s_nop 7
  v_mul_f32 v192, v192, v160
  v_mul_f32 v193, v193, v161
  v_mul_f32 v194, v194, v162
  v_mul_f32 v195, v195, v163
  v_mul_f32 v196, v196, v164
  v_mul_f32 v197, v197, v165
  v_mul_f32 v198, v198, v166
  v_mul_f32 v199, v199, v167
  v_mul_f32 v200, v200, v168
  v_mul_f32 v201, v201, v169
  v_mul_f32 v202, v202, v170
  v_mul_f32 v203, v203, v171
  v_mul_f32 v204, v204, v172
  v_mul_f32 v205, v205, v173
  v_mul_f32 v206, v206, v174
  v_mul_f32 v207, v207, v175
  v_mul_f32 v208, v208, v176
  v_mul_f32 v209, v209, v177
  v_mul_f32 v210, v210, v178
  v_mul_f32 v211, v211, v179
  v_mul_f32 v212, v212, v180
  v_mul_f32 v213, v213, v181
  v_mul_f32 v214, v214, v182
  v_mul_f32 v215, v215, v183
  v_mul_f32 v216, v216, v184
  v_mul_f32 v217, v217, v185
  v_mul_f32 v218, v218, v186
  v_mul_f32 v219, v219, v187
  v_mul_f32 v220, v220, v188
  v_mul_f32 v221, v221, v189
  v_mul_f32 v222, v222, v190
  v_mul_f32 v223, v223, v191
  ds_read_b64_tr_b16 v[240:241], v244 offset:4096
  ds_read_b64_tr_b16 v[242:243], v244 offset:4608
  s_waitcnt lgkmcnt(6)
  v_mfma_f32_32x32x16_bf16 v[160:175], v[224:227], v[0:3], 0
  v_cvt_pk_bf16_f32 v192, v192, v193
  v_cvt_pk_bf16_f32 v193, v194, v195
  ds_read_b64_tr_b16 v[224:225], v245 offset:4096
  ds_read_b64_tr_b16 v[226:227], v245 offset:4608
  v_mfma_f32_32x32x16_bf16 v[176:191], v[228:231], v[0:3], 0
  v_cvt_pk_bf16_f32 v194, v196, v197
  v_cvt_pk_bf16_f32 v195, v198, v199
  ds_read_b64_tr_b16 v[228:229], v244 offset:6144
  ds_read_b64_tr_b16 v[230:231], v244 offset:6656
  s_waitcnt lgkmcnt(6)
  v_mfma_f32_32x32x16_bf16 v[160:175], v[232:235], v[4:7], v[160:175]
  ds_read_b64_tr_b16 v[232:233], v245 offset:6144
  ds_read_b64_tr_b16 v[234:235], v245 offset:6656
  v_mfma_f32_32x32x16_bf16 v[176:191], v[236:239], v[4:7], v[176:191]
  ds_read_b64_tr_b16 v[236:237], v244 offset:8192
  ds_read_b64_tr_b16 v[238:239], v244 offset:8704
  s_waitcnt lgkmcnt(6)
  v_mfma_f32_32x32x16_bf16 v[160:175], v[240:243], v[8:11], v[160:175]
  ds_read_b64_tr_b16 v[240:241], v245 offset:8192
  ds_read_b64_tr_b16 v[242:243], v245 offset:8704
  v_mfma_f32_32x32x16_bf16 v[176:191], v[224:227], v[8:11], v[176:191]
  ds_read_b64_tr_b16 v[224:225], v244 offset:10240
  ds_read_b64_tr_b16 v[226:227], v244 offset:10752
  s_waitcnt lgkmcnt(6)
  v_mfma_f32_32x32x16_bf16 v[160:175], v[228:231], v[12:15], v[160:175]
  ds_read_b64_tr_b16 v[228:229], v245 offset:10240
  ds_read_b64_tr_b16 v[230:231], v245 offset:10752
  v_mfma_f32_32x32x16_bf16 v[176:191], v[232:235], v[12:15], v[176:191]
  ds_read_b64_tr_b16 v[232:233], v244 offset:12288
  ds_read_b64_tr_b16 v[234:235], v244 offset:12800
  s_waitcnt lgkmcnt(6)
  v_mfma_f32_32x32x16_bf16 v[160:175], v[236:239], v[16:19], v[160:175]
  ds_read_b64_tr_b16 v[236:237], v245 offset:12288
  ds_read_b64_tr_b16 v[238:239], v245 offset:12800
  v_mfma_f32_32x32x16_bf16 v[176:191], v[240:243], v[16:19], v[176:191]
  ds_read_b64_tr_b16 v[240:241], v244 offset:14336
  ds_read_b64_tr_b16 v[242:243], v244 offset:14848
  s_waitcnt lgkmcnt(6)
  v_mfma_f32_32x32x16_bf16 v[160:175], v[224:227], v[20:23], v[160:175]
  ds_read_b64_tr_b16 v[224:225], v245 offset:14336
  ds_read_b64_tr_b16 v[226:227], v245 offset:14848
  v_mfma_f32_32x32x16_bf16 v[176:191], v[228:231], v[20:23], v[176:191]
  s_barrier
  v_add_u32 v244, 65536, v246
  v_xor_b32 v245, 64, v244
  ds_read_b64_tr_b16 v[228:229], v244 offset:0
  ds_read_b64_tr_b16 v[230:231], v244 offset:512
  s_waitcnt lgkmcnt(6)
  v_mfma_f32_32x32x16_bf16 v[160:175], v[232:235], v[24:27], v[160:175]
  ds_read_b64_tr_b16 v[232:233], v245 offset:0
  ds_read_b64_tr_b16 v[234:235], v245 offset:512
  v_mfma_f32_32x32x16_bf16 v[176:191], v[236:239], v[24:27], v[176:191]
  ds_read_b64_tr_b16 v[236:237], v244 offset:2048
  ds_read_b64_tr_b16 v[238:239], v244 offset:2560
  s_waitcnt lgkmcnt(6)
  v_mfma_f32_32x32x16_bf16 v[160:175], v[240:243], v[28:31], v[160:175]
  ds_read_b64_tr_b16 v[240:241], v245 offset:2048
  ds_read_b64_tr_b16 v[242:243], v245 offset:2560
  v_mfma_f32_32x32x16_bf16 v[176:191], v[224:227], v[28:31], v[176:191]
  ds_read_b64_tr_b16 v[224:225], v244 offset:4096
  ds_read_b64_tr_b16 v[226:227], v244 offset:4608
  s_waitcnt lgkmcnt(6)
  v_mfma_f32_32x32x16_bf16 v[160:175], v[228:231], v[32:35], v[160:175]
  ds_read_b64_tr_b16 v[228:229], v245 offset:4096
  ds_read_b64_tr_b16 v[230:231], v245 offset:4608
  v_mfma_f32_32x32x16_bf16 v[176:191], v[232:235], v[32:35], v[176:191]
  ds_read_b64_tr_b16 v[232:233], v244 offset:6144
  ds_read_b64_tr_b16 v[234:235], v244 offset:6656
  s_waitcnt lgkmcnt(6)
  v_mfma_f32_32x32x16_bf16 v[160:175], v[236:239], v[36:39], v[160:175]
  ds_read_b64_tr_b16 v[236:237], v245 offset:6144
  ds_read_b64_tr_b16 v[238:239], v245 offset:6656
  v_mfma_f32_32x32x16_bf16 v[176:191], v[240:243], v[36:39], v[176:191]
  ds_read_b64_tr_b16 v[240:241], v244 offset:8192
  ds_read_b64_tr_b16 v[242:243], v244 offset:8704
  s_waitcnt lgkmcnt(6)
  v_mfma_f32_32x32x16_bf16 v[160:175], v[224:227], v[40:43], v[160:175]
  ds_read_b64_tr_b16 v[224:225], v245 offset:8192
  ds_read_b64_tr_b16 v[226:227], v245 offset:8704
  v_mfma_f32_32x32x16_bf16 v[176:191], v[228:231], v[40:43], v[176:191]
  ds_read_b64_tr_b16 v[228:229], v244 offset:10240
  ds_read_b64_tr_b16 v[230:231], v244 offset:10752
  s_waitcnt lgkmcnt(6)
  v_mfma_f32_32x32x16_bf16 v[160:175], v[232:235], v[44:47], v[160:175]
  ds_read_b64_tr_b16 v[232:233], v245 offset:10240
  ds_read_b64_tr_b16 v[234:235], v245 offset:10752
  v_mfma_f32_32x32x16_bf16 v[176:191], v[236:239], v[44:47], v[176:191]
  ds_read_b64_tr_b16 v[236:237], v244 offset:12288
  ds_read_b64_tr_b16 v[238:239], v244 offset:12800
  s_waitcnt lgkmcnt(6)
  v_mfma_f32_32x32x16_bf16 v[160:175], v[240:243], v[48:51], v[160:175]
  ds_read_b64_tr_b16 v[240:241], v245 offset:12288
  ds_read_b64_tr_b16 v[242:243], v245 offset:12800
  v_mfma_f32_32x32x16_bf16 v[176:191], v[224:227], v[48:51], v[176:191]
  ds_read_b64_tr_b16 v[224:225], v244 offset:14336
  ds_read_b64_tr_b16 v[226:227], v244 offset:14848
  s_waitcnt lgkmcnt(6)
  v_mfma_f32_32x32x16_bf16 v[160:175], v[228:231], v[52:55], v[160:175]
  ds_read_b64_tr_b16 v[228:229], v245 offset:14336
  ds_read_b64_tr_b16 v[230:231], v245 offset:14848
  v_mfma_f32_32x32x16_bf16 v[176:191], v[232:235], v[52:55], v[176:191]
  s_barrier
  v_add_u32 v244, 81920, v246
  v_xor_b32 v245, 64, v244
  ds_read_b64_tr_b16 v[232:233], v244 offset:0
  ds_read_b64_tr_b16 v[234:235], v244 offset:512
  s_waitcnt lgkmcnt(6)
  v_mfma_f32_32x32x16_bf16 v[160:175], v[236:239], v[56:59], v[160:175]
  ds_read_b64_tr_b16 v[236:237], v245 offset:0
  ds_read_b64_tr_b16 v[238:239], v245 offset:512
  v_mfma_f32_32x32x16_bf16 v[176:191], v[240:243], v[56:59], v[176:191]
  ds_read_b64_tr_b16 v[240:241], v244 offset:2048
  ds_read_b64_tr_b16 v[242:243], v244 offset:2560
  s_waitcnt lgkmcnt(6)
  v_mfma_f32_32x32x16_bf16 v[160:175], v[224:227], v[60:63], v[160:175]
  ds_read_b64_tr_b16 v[224:225], v245 offset:2048
  ds_read_b64_tr_b16 v[226:227], v245 offset:2560
  v_mfma_f32_32x32x16_bf16 v[176:191], v[228:231], v[60:63], v[176:191]
  ds_read_b64_tr_b16 v[228:229], v244 offset:4096
  ds_read_b64_tr_b16 v[230:231], v244 offset:4608
  s_waitcnt lgkmcnt(6)
  v_mfma_f32_32x32x16_bf16 v[160:175], v[232:235], v[64:67], v[160:175]
  ds_read_b64_tr_b16 v[232:233], v245 offset:4096
  ds_read_b64_tr_b16 v[234:235], v245 offset:4608
  v_mfma_f32_32x32x16_bf16 v[176:191], v[236:239], v[64:67], v[176:191]
  ds_read_b64_tr_b16 v[236:237], v244 offset:6144
  ds_read_b64_tr_b16 v[238:239], v244 offset:6656
  s_waitcnt lgkmcnt(6)
  v_mfma_f32_32x32x16_bf16 v[160:175], v[240:243], v[68:71], v[160:175]
  ds_read_b64_tr_b16 v[240:241], v245 offset:6144
  ds_read_b64_tr_b16 v[242:243], v245 offset:6656
  v_mfma_f32_32x32x16_bf16 v[176:191], v[224:227], v[68:71], v[176:191]
  ds_read_b64_tr_b16 v[224:225], v244 offset:8192
  ds_read_b64_tr_b16 v[226:227], v244 offset:8704
  s_waitcnt lgkmcnt(6)
  v_mfma_f32_32x32x16_bf16 v[160:175], v[228:231], v[72:75], v[160:175]
  ds_read_b64_tr_b16 v[228:229], v245 offset:8192
  ds_read_b64_tr_b16 v[230:231], v245 offset:8704
  v_mfma_f32_32x32x16_bf16 v[176:191], v[232:235], v[72:75], v[176:191]
  ds_read_b64_tr_b16 v[232:233], v244 offset:10240
  ds_read_b64_tr_b16 v[234:235], v244 offset:10752
  s_waitcnt lgkmcnt(6)
  v_mfma_f32_32x32x16_bf16 v[160:175], v[236:239], v[76:79], v[160:175]
  ds_read_b64_tr_b16 v[236:237], v245 offset:10240
  ds_read_b64_tr_b16 v[238:239], v245 offset:10752
  v_mfma_f32_32x32x16_bf16 v[176:191], v[240:243], v[76:79], v[176:191]
  ds_read_b64_tr_b16 v[240:241], v244 offset:12288
  ds_read_b64_tr_b16 v[242:243], v244 offset:12800
  s_waitcnt lgkmcnt(6)
  v_mfma_f32_32x32x16_bf16 v[160:175], v[224:227], v[80:83], v[160:175]
  ds_read_b64_tr_b16 v[224:225], v245 offset:12288
  ds_read_b64_tr_b16 v[226:227], v245 offset:12800
  v_mfma_f32_32x32x16_bf16 v[176:191], v[228:231], v[80:83], v[176:191]
  ds_read_b64_tr_b16 v[228:229], v244 offset:14336
  ds_read_b64_tr_b16 v[230:231], v244 offset:14848
  s_waitcnt lgkmcnt(6)
  v_mfma_f32_32x32x16_bf16 v[160:175], v[232:235], v[84:87], v[160:175]
  ds_read_b64_tr_b16 v[232:233], v245 offset:14336
  ds_read_b64_tr_b16 v[234:235], v245 offset:14848
  v_mfma_f32_32x32x16_bf16 v[176:191], v[236:239], v[84:87], v[176:191]
  s_barrier
  v_add_u32 v244, 98304, v246
  v_xor_b32 v245, 64, v244
  ds_read_b64_tr_b16 v[236:237], v244 offset:0
  ds_read_b64_tr_b16 v[238:239], v244 offset:512
  s_waitcnt lgkmcnt(6)
  v_mfma_f32_32x32x16_bf16 v[160:175], v[240:243], v[88:91], v[160:175]
  ds_read_b64_tr_b16 v[240:241], v245 offset:0
  ds_read_b64_tr_b16 v[242:243], v245 offset:512
  v_mfma_f32_32x32x16_bf16 v[176:191], v[224:227], v[88:91], v[176:191]
  ds_read_b64_tr_b16 v[224:225], v244 offset:2048
  ds_read_b64_tr_b16 v[226:227], v244 offset:2560
  s_waitcnt lgkmcnt(6)
  v_mfma_f32_32x32x16_bf16 v[160:175], v[228:231], v[92:95], v[160:175]
  ds_read_b64_tr_b16 v[228:229], v245 offset:2048
  ds_read_b64_tr_b16 v[230:231], v245 offset:2560
  v_mfma_f32_32x32x16_bf16 v[176:191], v[232:235], v[92:95], v[176:191]
  ds_read_b64_tr_b16 v[232:233], v244 offset:4096
  ds_read_b64_tr_b16 v[234:235], v244 offset:4608
  s_waitcnt lgkmcnt(6)
  v_mfma_f32_32x32x16_bf16 v[160:175], v[236:239], v[96:99], v[160:175]
  ds_read_b64_tr_b16 v[236:237], v245 offset:4096
  ds_read_b64_tr_b16 v[238:239], v245 offset:4608
  v_mfma_f32_32x32x16_bf16 v[176:191], v[240:243], v[96:99], v[176:191]
  ds_read_b64_tr_b16 v[240:241], v244 offset:6144
  ds_read_b64_tr_b16 v[242:243], v244 offset:6656
  s_waitcnt lgkmcnt(6)
  v_mfma_f32_32x32x16_bf16 v[160:175], v[224:227], v[100:103], v[160:175]
  ds_read_b64_tr_b16 v[224:225], v245 offset:6144
  ds_read_b64_tr_b16 v[226:227], v245 offset:6656
  v_mfma_f32_32x32x16_bf16 v[176:191], v[228:231], v[100:103], v[176:191]
  ds_read_b64_tr_b16 v[228:229], v244 offset:8192
  ds_read_b64_tr_b16 v[230:231], v244 offset:8704
  s_waitcnt lgkmcnt(6)
  v_mfma_f32_32x32x16_bf16 v[160:175], v[232:235], v[104:107], v[160:175]
  ds_read_b64_tr_b16 v[232:233], v245 offset:8192
  ds_read_b64_tr_b16 v[234:235], v245 offset:8704
  v_mfma_f32_32x32x16_bf16 v[176:191], v[236:239], v[104:107], v[176:191]
  ds_read_b64_tr_b16 v[236:237], v244 offset:10240
  ds_read_b64_tr_b16 v[238:239], v244 offset:10752
  s_waitcnt lgkmcnt(6)
  v_mfma_f32_32x32x16_bf16 v[160:175], v[240:243], v[108:111], v[160:175]
  ds_read_b64_tr_b16 v[240:241], v245 offset:10240
  ds_read_b64_tr_b16 v[242:243], v245 offset:10752
  v_mfma_f32_32x32x16_bf16 v[176:191], v[224:227], v[108:111], v[176:191]
  ds_read_b64_tr_b16 v[224:225], v244 offset:12288
  ds_read_b64_tr_b16 v[226:227], v244 offset:12800
  s_waitcnt lgkmcnt(6)
  v_mfma_f32_32x32x16_bf16 v[160:175], v[228:231], v[112:115], v[160:175]
  ds_read_b64_tr_b16 v[228:229], v245 offset:12288
  ds_read_b64_tr_b16 v[230:231], v245 offset:12800
  v_mfma_f32_32x32x16_bf16 v[176:191], v[232:235], v[112:115], v[176:191]
  ds_read_b64_tr_b16 v[232:233], v244 offset:14336
  ds_read_b64_tr_b16 v[234:235], v244 offset:14848
  s_waitcnt lgkmcnt(6)
  v_mfma_f32_32x32x16_bf16 v[160:175], v[236:239], v[116:119], v[160:175]
  ds_read_b64_tr_b16 v[236:237], v245 offset:14336
  ds_read_b64_tr_b16 v[238:239], v245 offset:14848
  v_mfma_f32_32x32x16_bf16 v[176:191], v[240:243], v[116:119], v[176:191]
  s_barrier
  v_add_u32 v244, 0, v246
  v_xor_b32 v245, 64, v244
  ds_read_b64_tr_b16 v[240:241], v244 offset:0
  ds_read_b64_tr_b16 v[242:243], v244 offset:512
  s_waitcnt lgkmcnt(6)
  v_mfma_f32_32x32x16_bf16 v[160:175], v[224:227], v[120:123], v[160:175]
  ds_read_b64_tr_b16 v[224:225], v245 offset:0
  ds_read_b64_tr_b16 v[226:227], v245 offset:512
  v_mfma_f32_32x32x16_bf16 v[176:191], v[228:231], v[120:123], v[176:191]
  ds_read_b64_tr_b16 v[228:229], v244 offset:2048
  ds_read_b64_tr_b16 v[230:231], v244 offset:2560
  s_waitcnt lgkmcnt(6)
  v_mfma_f32_32x32x16_bf16 v[160:175], v[232:235], v[124:127], v[160:175]
  ds_read_b64_tr_b16 v[232:233], v245 offset:2048
  ds_read_b64_tr_b16 v[234:235], v245 offset:2560
  v_mfma_f32_32x32x16_bf16 v[176:191], v[236:239], v[124:127], v[176:191]
  s_lshl_b32 s82, s26, 2
  s_add_u32 s82, s82, 104
  s_lshl_b32 s81, s25, 2
  s_add_u32 s81, s81, s24
  s_mul_i32 s81, s81, 148
  s_add_u32 s81, s81, s82
  s_lshl_b32 s81, s81, 10
  buffer_store_dwordx4 v[192:195], v247, s[40:43], s81 offen offset:0 sc0 sc1
  ds_read_b64_tr_b16 v[236:237], v244 offset:4096
  ds_read_b64_tr_b16 v[238:239], v244 offset:4608
  s_waitcnt lgkmcnt(6)
  v_mfma_f32_32x32x16_bf16 v[160:175], v[240:243], v[128:131], v[160:175]
  v_cvt_pk_bf16_f32 v200, v200, v201
  v_cvt_pk_bf16_f32 v201, v202, v203
  ds_read_b64_tr_b16 v[240:241], v245 offset:4096
  ds_read_b64_tr_b16 v[242:243], v245 offset:4608
  v_mfma_f32_32x32x16_bf16 v[176:191], v[224:227], v[128:131], v[176:191]
  v_cvt_pk_bf16_f32 v202, v204, v205
  v_cvt_pk_bf16_f32 v203, v206, v207
  ds_read_b64_tr_b16 v[224:225], v244 offset:6144
  ds_read_b64_tr_b16 v[226:227], v244 offset:6656
  s_waitcnt lgkmcnt(6)
  v_mfma_f32_32x32x16_bf16 v[160:175], v[228:231], v[132:135], v[160:175]
  ds_read_b64_tr_b16 v[228:229], v245 offset:6144
  ds_read_b64_tr_b16 v[230:231], v245 offset:6656
  v_mfma_f32_32x32x16_bf16 v[176:191], v[232:235], v[132:135], v[176:191]
  s_lshl_b32 s82, s26, 2
  s_add_u32 s82, s82, 104
  s_lshl_b32 s81, s25, 2
  s_add_u32 s81, s81, s24
  s_mul_i32 s81, s81, 148
  s_add_u32 s81, s81, s82
  s_lshl_b32 s81, s81, 10
  buffer_store_dwordx4 v[200:203], v247, s[40:43], s81 offen offset:1024 sc0 sc1
  ds_read_b64_tr_b16 v[232:233], v244 offset:8192
  ds_read_b64_tr_b16 v[234:235], v244 offset:8704
  s_waitcnt lgkmcnt(6)
  v_mfma_f32_32x32x16_bf16 v[160:175], v[236:239], v[136:139], v[160:175]
  v_cvt_pk_bf16_f32 v208, v208, v209
  v_cvt_pk_bf16_f32 v209, v210, v211
  ds_read_b64_tr_b16 v[236:237], v245 offset:8192
  ds_read_b64_tr_b16 v[238:239], v245 offset:8704
  v_mfma_f32_32x32x16_bf16 v[176:191], v[240:243], v[136:139], v[176:191]
  v_cvt_pk_bf16_f32 v210, v212, v213
  v_cvt_pk_bf16_f32 v211, v214, v215
  ds_read_b64_tr_b16 v[240:241], v244 offset:10240
  ds_read_b64_tr_b16 v[242:243], v244 offset:10752
  s_waitcnt lgkmcnt(6)
  v_mfma_f32_32x32x16_bf16 v[160:175], v[224:227], v[140:143], v[160:175]
  ds_read_b64_tr_b16 v[224:225], v245 offset:10240
  ds_read_b64_tr_b16 v[226:227], v245 offset:10752
  v_mfma_f32_32x32x16_bf16 v[176:191], v[228:231], v[140:143], v[176:191]
  s_lshl_b32 s82, s26, 2
  s_add_u32 s82, s82, 104
  s_lshl_b32 s81, s25, 2
  s_add_u32 s81, s81, s24
  s_mul_i32 s81, s81, 148
  s_add_u32 s81, s81, s82
  s_lshl_b32 s81, s81, 10
  buffer_store_dwordx4 v[208:211], v247, s[40:43], s81 offen offset:2048 sc0 sc1
  ds_read_b64_tr_b16 v[228:229], v244 offset:12288
  ds_read_b64_tr_b16 v[230:231], v244 offset:12800
  s_waitcnt lgkmcnt(6)
  v_mfma_f32_32x32x16_bf16 v[160:175], v[232:235], v[144:147], v[160:175]
  v_cvt_pk_bf16_f32 v216, v216, v217
  v_cvt_pk_bf16_f32 v217, v218, v219
  ds_read_b64_tr_b16 v[232:233], v245 offset:12288
  ds_read_b64_tr_b16 v[234:235], v245 offset:12800
  v_mfma_f32_32x32x16_bf16 v[176:191], v[236:239], v[144:147], v[176:191]
  v_cvt_pk_bf16_f32 v218, v220, v221
  v_cvt_pk_bf16_f32 v219, v222, v223
  ds_read_b64_tr_b16 v[236:237], v244 offset:14336
  ds_read_b64_tr_b16 v[238:239], v244 offset:14848
  s_waitcnt lgkmcnt(6)
  v_mfma_f32_32x32x16_bf16 v[160:175], v[240:243], v[148:151], v[160:175]
  ds_read_b64_tr_b16 v[240:241], v245 offset:14336
  ds_read_b64_tr_b16 v[242:243], v245 offset:14848
  v_mfma_f32_32x32x16_bf16 v[176:191], v[224:227], v[148:151], v[176:191]
  s_lshl_b32 s82, s26, 2
  s_add_u32 s82, s82, 104
  s_lshl_b32 s81, s25, 2
  s_add_u32 s81, s81, s24
  s_mul_i32 s81, s81, 148
  s_add_u32 s81, s81, s82
  s_lshl_b32 s81, s81, 10
  buffer_store_dwordx4 v[216:219], v247, s[40:43], s81 offen offset:3072 sc0 sc1
  s_waitcnt lgkmcnt(4)
  v_mfma_f32_32x32x16_bf16 v[160:175], v[228:231], v[152:155], v[160:175]
  v_mfma_f32_32x32x16_bf16 v[176:191], v[232:235], v[152:155], v[176:191]
  s_waitcnt lgkmcnt(0)
  v_mfma_f32_32x32x16_bf16 v[160:175], v[236:239], v[156:159], v[160:175]
  v_mfma_f32_32x32x16_bf16 v[176:191], v[240:243], v[156:159], v[176:191]
  s_nop 7
  s_nop 3
  v_mul_f32 v160, s97, v160
  v_mul_f32 v161, s97, v161
  v_mul_f32 v162, s97, v162
  v_mul_f32 v163, s97, v163
  v_exp_f32 v160, v160
  v_exp_f32 v161, v161
  v_exp_f32 v162, v162
  v_exp_f32 v163, v163
  v_add_f32 v160, 1.0, v160
  v_add_f32 v161, 1.0, v161
  v_add_f32 v162, 1.0, v162
  v_add_f32 v163, 1.0, v163
  v_rcp_f32 v160, v160
  v_rcp_f32 v161, v161
  v_rcp_f32 v162, v162
  v_rcp_f32 v163, v163
  v_mul_f32 v164, s97, v164
  v_mul_f32 v165, s97, v165
  v_mul_f32 v166, s97, v166
  v_mul_f32 v167, s97, v167
  v_exp_f32 v164, v164
  v_exp_f32 v165, v165
  v_exp_f32 v166, v166
  v_exp_f32 v167, v167
  v_add_f32 v164, 1.0, v164
  v_add_f32 v165, 1.0, v165
  v_add_f32 v166, 1.0, v166
  v_add_f32 v167, 1.0, v167
  v_rcp_f32 v164, v164
  v_rcp_f32 v165, v165
  v_rcp_f32 v166, v166
  v_rcp_f32 v167, v167
  v_mul_f32 v168, s97, v168
  v_mul_f32 v169, s97, v169
  v_mul_f32 v170, s97, v170
  v_mul_f32 v171, s97, v171
  v_exp_f32 v168, v168
  v_exp_f32 v169, v169
  v_exp_f32 v170, v170
  v_exp_f32 v171, v171
  v_add_f32 v168, 1.0, v168
  v_add_f32 v169, 1.0, v169
  v_add_f32 v170, 1.0, v170
  v_add_f32 v171, 1.0, v171
  v_rcp_f32 v168, v168
  v_rcp_f32 v169, v169
  v_rcp_f32 v170, v170
  v_rcp_f32 v171, v171
  v_mul_f32 v172, s97, v172
  v_mul_f32 v173, s97, v173
  v_mul_f32 v174, s97, v174
  v_mul_f32 v175, s97, v175
  v_exp_f32 v172, v172
  v_exp_f32 v173, v173
  v_exp_f32 v174, v174
  v_exp_f32 v175, v175
  v_add_f32 v172, 1.0, v172
  v_add_f32 v173, 1.0, v173
  v_add_f32 v174, 1.0, v174
  v_add_f32 v175, 1.0, v175
  v_rcp_f32 v172, v172
  v_rcp_f32 v173, v173
  v_rcp_f32 v174, v174
  v_rcp_f32 v175, v175
  v_mul_f32 v176, v176, v160
  v_mul_f32 v177, v177, v161
  v_mul_f32 v178, v178, v162
  v_mul_f32 v179, v179, v163
  v_mul_f32 v180, v180, v164
  v_mul_f32 v181, v181, v165
  v_mul_f32 v182, v182, v166
  v_mul_f32 v183, v183, v167
  v_mul_f32 v184, v184, v168
  v_mul_f32 v185, v185, v169
  v_mul_f32 v186, v186, v170
  v_mul_f32 v187, v187, v171
  v_mul_f32 v188, v188, v172
  v_mul_f32 v189, v189, v173
  v_mul_f32 v190, v190, v174
  v_mul_f32 v191, v191, v175
  v_cvt_pk_bf16_f32 v176, v176, v177
  v_cvt_pk_bf16_f32 v177, v178, v179
  v_cvt_pk_bf16_f32 v178, v180, v181
  v_cvt_pk_bf16_f32 v179, v182, v183
  s_lshl_b32 s82, s26, 1
  s_add_u32 s82, s82, 136
  s_cmp_ge_u32 s26, 6
  s_cselect_b32 s82, 0x100000, s82
  s_lshl_b32 s81, s25, 2
  s_add_u32 s81, s81, s24
  s_mul_i32 s81, s81, 148
  s_add_u32 s81, s81, s82
  s_lshl_b32 s81, s81, 10
  buffer_store_dwordx4 v[176:179], v247, s[40:43], s81 offen offset:0 sc0 sc1
  v_cvt_pk_bf16_f32 v184, v184, v185
  v_cvt_pk_bf16_f32 v185, v186, v187
  v_cvt_pk_bf16_f32 v186, v188, v189
  v_cvt_pk_bf16_f32 v187, v190, v191
  s_lshl_b32 s82, s26, 1
  s_add_u32 s82, s82, 136
  s_cmp_ge_u32 s26, 6
  s_cselect_b32 s82, 0x100000, s82
  s_lshl_b32 s81, s25, 2
  s_add_u32 s81, s81, s24
  s_mul_i32 s81, s81, 148
  s_add_u32 s81, s81, s82
  s_lshl_b32 s81, s81, 10
  buffer_store_dwordx4 v[184:187], v247, s[40:43], s81 offen offset:1024 sc0 sc1
  s_endpgm
front_kernel_aux:
  s_waitcnt lgkmcnt(0)
  s_add_u32 s28, s22, 25165824
  s_addc_u32 s29, s23, 0
  s_mov_b32 s30, 2621440
  s_mov_b32 s31, 0x00020000
  s_cmp_eq_u32 s27, 1
  s_cbranch_scc1 front_kernel_akv
  v_and_b32 v15, 63, v0
  v_lshlrev_b32 v14, 4, v15
  s_mul_i32 s68, s26, 122880
  s_mov_b32 s64, s28
  s_mov_b32 s65, s29
  s_mov_b32 s66, s30
  s_mov_b32 s67, s31
  s_mul_i32 s71, s24, 6144
  s_add_u32 s71, s71, s68
  s_mul_i32 s69, s24, 6144
  s_add_u32 s55, s69, 0
  s_add_u32 s68, s68, 24576
  s_mov_b32 m0, s55
  s_add_u32 s55, s55, 1024
  buffer_load_dwordx4 v14, s[64:67], s71 offen lds
  s_add_u32 s71, s71, 1024
  s_mov_b32 m0, s55
  s_add_u32 s55, s55, 1024
  buffer_load_dwordx4 v14, s[64:67], s71 offen lds
  s_add_u32 s71, s71, 1024
  s_mov_b32 m0, s55
  s_add_u32 s55, s55, 1024
  buffer_load_dwordx4 v14, s[64:67], s71 offen lds
  s_add_u32 s71, s71, 1024
  s_mov_b32 m0, s55
  s_add_u32 s55, s55, 1024
  buffer_load_dwordx4 v14, s[64:67], s71 offen lds
  s_add_u32 s71, s71, 1024
  s_mov_b32 m0, s55
  s_add_u32 s55, s55, 1024
  buffer_load_dwordx4 v14, s[64:67], s71 offen lds
  s_add_u32 s71, s71, 1024
  s_mov_b32 m0, s55
  s_add_u32 s55, s55, 1024
  buffer_load_dwordx4 v14, s[64:67], s71 offen lds
  s_mul_i32 s71, s24, 6144
  s_add_u32 s71, s71, s68
  s_mul_i32 s69, s24, 6144
  s_add_u32 s55, s69, 24576
  s_add_u32 s68, s68, 24576
  s_mov_b32 m0, s55
  s_add_u32 s55, s55, 1024
  buffer_load_dwordx4 v14, s[64:67], s71 offen lds
  s_add_u32 s71, s71, 1024
  s_mov_b32 m0, s55
  s_add_u32 s55, s55, 1024
  buffer_load_dwordx4 v14, s[64:67], s71 offen lds
  s_add_u32 s71, s71, 1024
  s_mov_b32 m0, s55
  s_add_u32 s55, s55, 1024
  buffer_load_dwordx4 v14, s[64:67], s71 offen lds
  s_add_u32 s71, s71, 1024
  s_mov_b32 m0, s55
  s_add_u32 s55, s55, 1024
  buffer_load_dwordx4 v14, s[64:67], s71 offen lds
  s_add_u32 s71, s71, 1024
  s_mov_b32 m0, s55
  s_add_u32 s55, s55, 1024
  buffer_load_dwordx4 v14, s[64:67], s71 offen lds
  s_add_u32 s71, s71, 1024
  s_mov_b32 m0, s55
  s_add_u32 s55, s55, 1024
  buffer_load_dwordx4 v14, s[64:67], s71 offen lds
  s_mov_b32 s32, s12
  s_mov_b32 s33, s13
  s_mov_b32 s34, 2211840
  s_mov_b32 s35, 0x00020000
  s_mov_b32 s36, s14
  s_mov_b32 s37, s15
  s_mov_b32 s38, 2211840
  s_mov_b32 s39, 0x00020000
  s_mov_b32 s40, s22
  s_mov_b32 s41, s23
  s_mov_b32 s42, 9699328
  s_mov_b32 s43, 0x00020000
  s_add_u32 s44, s22, 20971520
  s_addc_u32 s45, s23, 0
  s_mov_b32 s46, 2621440
  s_mov_b32 s47, 0x00020000
  s_lshl_b32 s69, s26, 15
  s_add_u32 s69, s69, 14680064
  s_add_u32 s48, s22, s69
  s_addc_u32 s49, s23, 0
  s_mov_b32 s50, 32768
  s_mov_b32 s51, 0x00020000
  v_lshlrev_b32 v14, 4, v15
  v_lshrrev_b32 v1, 3, v15
  v_bfe_u32 v2, v15, 2, 1
  v_bfe_u32 v3, v15, 4, 1
  v_xor_b32 v2, v2, v3
  v_and_b32 v3, 3, v15
  v_lshlrev_b32 v3, 4, v3
  v_lshlrev_b32 v4, 6, v2
  v_add_u32 v4, v4, v3
  v_mul_u32_u24 v5, 3456, v1
  v_add_u32 v8, v5, v4
  v_add_u32 v10, v5, v3
  v_lshlrev_b32 v5, 7, v1
  v_add_u32 v9, v5, v4
  v_cmp_eq_u32 s[76:77], 0, v2
  v_cmp_eq_u32 s[78:79], 1, v2
  v_lshrrev_b32 v23, 5, v15
  v_and_b32 v24, 31, v15
  s_lshl_b32 s69, s24, 12
  v_add_u32 v20, s69, v14
  v_lshlrev_b32 v1, 2, v15
  v_add_u32 v21, s69, v1
  s_add_u32 s92, s22, 15466496
  s_addc_u32 s93, s23, 0
  s_mov_b32 s94, 16384
  s_mov_b32 s95, 0x00020000
  s_mov_b32 s99, 0x358637bd
  s_waitcnt vmcnt(6)
  s_barrier
  s_mul_i32 s71, s24, 6144
  s_add_u32 s71, s71, s68
  s_mul_i32 s69, s24, 6144
  s_add_u32 s55, s69, 49152
  s_add_u32 s68, s68, 24576
  s_mov_b32 m0, s55
  s_add_u32 s55, s55, 1024
  buffer_load_dwordx4 v14, s[64:67], s71 offen lds
  s_add_u32 s71, s71, 1024
  s_mov_b32 m0, s55
  s_add_u32 s55, s55, 1024
  buffer_load_dwordx4 v14, s[64:67], s71 offen lds
  s_add_u32 s71, s71, 1024
  s_mov_b32 m0, s55
  s_add_u32 s55, s55, 1024
  buffer_load_dwordx4 v14, s[64:67], s71 offen lds
  s_add_u32 s71, s71, 1024
  s_mov_b32 m0, s55
  s_add_u32 s55, s55, 1024
  buffer_load_dwordx4 v14, s[64:67], s71 offen lds
  s_add_u32 s71, s71, 1024
  s_mov_b32 m0, s55
  s_add_u32 s55, s55, 1024
  buffer_load_dwordx4 v14, s[64:67], s71 offen lds
  s_add_u32 s71, s71, 1024
  s_mov_b32 m0, s55
  s_add_u32 s55, s55, 1024
  buffer_load_dwordx4 v14, s[64:67], s71 offen lds
  s_mul_i32 s71, s24, 6144
  s_add_u32 s71, s71, s68
  s_mul_i32 s69, s24, 6144
  s_add_u32 s55, s69, 73728
  s_add_u32 s68, s68, 24576
  s_mov_b32 m0, s55
  s_add_u32 s55, s55, 1024
  buffer_load_dwordx4 v14, s[64:67], s71 offen lds
  s_add_u32 s71, s71, 1024
  s_mov_b32 m0, s55
  s_add_u32 s55, s55, 1024
  buffer_load_dwordx4 v14, s[64:67], s71 offen lds
  s_add_u32 s71, s71, 1024
  s_mov_b32 m0, s55
  s_add_u32 s55, s55, 1024
  buffer_load_dwordx4 v14, s[64:67], s71 offen lds
  s_add_u32 s71, s71, 1024
  s_mov_b32 m0, s55
  s_add_u32 s55, s55, 1024
  buffer_load_dwordx4 v14, s[64:67], s71 offen lds
  s_add_u32 s71, s71, 1024
  s_mov_b32 m0, s55
  s_add_u32 s55, s55, 1024
  buffer_load_dwordx4 v14, s[64:67], s71 offen lds
  s_add_u32 s71, s71, 1024
  s_mov_b32 m0, s55
  s_add_u32 s55, s55, 1024
  buffer_load_dwordx4 v14, s[64:67], s71 offen lds
  s_waitcnt vmcnt(12)
  s_barrier
  s_waitcnt vmcnt(6)
  s_barrier
  s_mul_i32 s71, s24, 6144
  s_add_u32 s71, s71, s68
  s_mul_i32 s69, s24, 6144
  s_add_u32 s55, s69, 0
  s_add_u32 s68, s68, 24576
  s_mov_b32 m0, s55
  s_add_u32 s55, s55, 1024
  buffer_load_dwordx4 v14, s[64:67], s71 offen lds
  s_add_u32 s71, s71, 1024
  s_mov_b32 m0, s55
  s_add_u32 s55, s55, 1024
  buffer_load_dwordx4 v14, s[64:67], s71 offen lds
  s_add_u32 s71, s71, 1024
  s_mov_b32 m0, s55
  s_add_u32 s55, s55, 1024
  buffer_load_dwordx4 v14, s[64:67], s71 offen lds
  s_add_u32 s71, s71, 1024
  s_mov_b32 m0, s55
  s_add_u32 s55, s55, 1024
  buffer_load_dwordx4 v14, s[64:67], s71 offen lds
  s_add_u32 s71, s71, 1024
  s_mov_b32 m0, s55
  s_add_u32 s55, s55, 1024
  buffer_load_dwordx4 v14, s[64:67], s71 offen lds
  s_add_u32 s71, s71, 1024
  s_mov_b32 m0, s55
  s_add_u32 s55, s55, 1024
  buffer_load_dwordx4 v14, s[64:67], s71 offen lds
  s_waitcnt vmcnt(6)
  s_barrier
  s_lshl_b32 s68, s26, 8
  s_mov_b32 s64, s32
  s_mov_b32 s65, s33
  s_mov_b32 s66, s34
  s_mov_b32 s67, s35
  s_mul_i32 s71, s24, 110592
  s_add_u32 s71, s71, s68
  s_mul_i32 s69, s24, 4096
  s_add_u32 s55, s69, 24576
  s_add_u32 s68, s68, 442368
  s_mov_b32 m0, s55
  s_add_u32 s55, s55, 1024
  buffer_load_dwordx4 v8, s[64:67], s71 offen lds
  s_add_u32 s71, s71, 27648
  s_mov_b32 m0, s55
  s_add_u32 s55, s55, 1024
  buffer_load_dwordx4 v8, s[64:67], s71 offen lds
  s_add_u32 s71, s71, 27648
  s_mov_b32 m0, s55
  s_add_u32 s55, s55, 1024
  buffer_load_dwordx4 v8, s[64:67], s71 offen lds
  s_add_u32 s71, s71, 27648
  s_mov_b32 m0, s55
  s_add_u32 s55, s55, 1024
  buffer_load_dwordx4 v8, s[64:67], s71 offen lds
  s_waitcnt vmcnt(4)
  s_barrier
  s_mul_i32 s71, s24, 110592
  s_add_u32 s71, s71, s68
  s_mul_i32 s69, s24, 4096
  s_add_u32 s55, s69, 40960
  s_add_u32 s68, s68, 442368
  s_mov_b32 m0, s55
  s_add_u32 s55, s55, 1024
  buffer_load_dwordx4 v8, s[64:67], s71 offen lds
  s_add_u32 s71, s71, 27648
  s_mov_b32 m0, s55
  s_add_u32 s55, s55, 1024
  buffer_load_dwordx4 v8, s[64:67], s71 offen lds
  s_add_u32 s71, s71, 27648
  s_mov_b32 m0, s55
  s_add_u32 s55, s55, 1024
  buffer_load_dwordx4 v8, s[64:67], s71 offen lds
  s_add_u32 s71, s71, 27648
  s_mov_b32 m0, s55
  s_add_u32 s55, s55, 1024
  buffer_load_dwordx4 v8, s[64:67], s71 offen lds
  s_mul_i32 s71, s24, 110592
  s_add_u32 s71, s71, s68
  s_mul_i32 s69, s24, 4096
  s_add_u32 s55, s69, 57344
  s_add_u32 s68, s68, 442368
  s_mov_b32 m0, s55
  s_add_u32 s55, s55, 1024
  buffer_load_dwordx4 v8, s[64:67], s71 offen lds
  s_add_u32 s71, s71, 27648
  s_mov_b32 m0, s55
  s_add_u32 s55, s55, 1024
  buffer_load_dwordx4 v8, s[64:67], s71 offen lds
  s_add_u32 s71, s71, 27648
  s_mov_b32 m0, s55
  s_add_u32 s55, s55, 1024
  buffer_load_dwordx4 v8, s[64:67], s71 offen lds
  s_add_u32 s71, s71, 27648
  s_mov_b32 m0, s55
  s_add_u32 s55, s55, 1024
  buffer_load_dwordx4 v8, s[64:67], s71 offen lds
  s_waitcnt vmcnt(8)
  s_barrier
  s_mul_i32 s71, s24, 110592
  s_add_u32 s71, s71, s68
  s_mul_i32 s69, s24, 4096
  s_add_u32 s55, s69, 73728
  s_add_u32 s68, s68, 442368
  s_mov_b32 m0, s55
  s_add_u32 s55, s55, 1024
  buffer_load_dwordx4 v8, s[64:67], s71 offen lds
  s_add_u32 s71, s71, 27648
  s_mov_b32 m0, s55
  s_add_u32 s55, s55, 1024
  buffer_load_dwordx4 v8, s[64:67], s71 offen lds
  s_add_u32 s71, s71, 27648
  s_mov_b32 m0, s55
  s_add_u32 s55, s55, 1024
  buffer_load_dwordx4 v8, s[64:67], s71 offen lds
  s_add_u32 s71, s71, 27648
  s_mov_b32 m0, s55
  s_add_u32 s55, s55, 1024
  buffer_load_dwordx4 v8, s[64:67], s71 offen lds
  s_mul_i32 s71, s24, 110592
  s_add_u32 s71, s71, s68
  s_mul_i32 s69, s24, 4096
  s_add_u32 s55, s69, 90112
  s_add_u32 s68, s68, 442368
  s_mov_b32 m0, s55
  s_add_u32 s55, s55, 1024
  buffer_load_dwordx4 v8, s[64:67], s71 offen lds
  s_add_u32 s71, s71, 27648
  s_mov_b32 m0, s55
  s_add_u32 s55, s55, 1024
  buffer_load_dwordx4 v8, s[64:67], s71 offen lds
  s_add_u32 s71, s71, 27648
  s_mov_b32 m0, s55
  s_add_u32 s55, s55, 1024
  buffer_load_dwordx4 v8, s[64:67], s71 offen lds
  s_add_u32 s71, s71, 27648
  s_mov_b32 m0, s55
  s_add_u32 s55, s55, 1024
  buffer_load_dwordx4 v8, s[64:67], s71 offen lds
  s_waitcnt vmcnt(12)
  s_barrier
  s_lshl_b32 s68, s26, 8
  s_mov_b32 s64, s36
  s_mov_b32 s65, s37
  s_mov_b32 s66, s38
  s_mov_b32 s67, s39
  s_mul_i32 s71, s24, 110592
  s_add_u32 s71, s71, s68
  s_mul_i32 s69, s24, 4096
  s_add_u32 s55, s69, 0
  s_add_u32 s68, s68, 442368
  s_mov_b32 m0, s55
  s_add_u32 s55, s55, 1024
  buffer_load_dwordx4 v8, s[64:67], s71 offen lds
  s_add_u32 s71, s71, 27648
  s_mov_b32 m0, s55
  s_add_u32 s55, s55, 1024
  buffer_load_dwordx4 v8, s[64:67], s71 offen lds
  s_add_u32 s71, s71, 27648
  s_mov_b32 m0, s55
  s_add_u32 s55, s55, 1024
  buffer_load_dwordx4 v8, s[64:67], s71 offen lds
  s_add_u32 s71, s71, 27648
  s_mov_b32 m0, s55
  s_add_u32 s55, s55, 1024
  buffer_load_dwordx4 v8, s[64:67], s71 offen lds
  s_waitcnt vmcnt(12)
  s_barrier
  s_mul_i32 s71, s24, 110592
  s_add_u32 s71, s71, s68
  s_mul_i32 s69, s24, 4096
  s_add_u32 s55, s69, 16384
  s_add_u32 s68, s68, 442368
  s_mov_b32 m0, s55
  s_add_u32 s55, s55, 1024
  buffer_load_dwordx4 v8, s[64:67], s71 offen lds
  s_add_u32 s71, s71, 27648
  s_mov_b32 m0, s55
  s_add_u32 s55, s55, 1024
  buffer_load_dwordx4 v8, s[64:67], s71 offen lds
  s_add_u32 s71, s71, 27648
  s_mov_b32 m0, s55
  s_add_u32 s55, s55, 1024
  buffer_load_dwordx4 v8, s[64:67], s71 offen lds
  s_add_u32 s71, s71, 27648
  s_mov_b32 m0, s55
  s_add_u32 s55, s55, 1024
  buffer_load_dwordx4 v8, s[64:67], s71 offen lds
  s_waitcnt vmcnt(12)
  s_barrier
  s_mul_i32 s71, s24, 110592
  s_add_u32 s71, s71, s68
  s_mul_i32 s69, s24, 4096
  s_add_u32 s55, s69, 32768
  s_add_u32 s68, s68, 442368
  s_mov_b32 m0, s55
  s_add_u32 s55, s55, 1024
  buffer_load_dwordx4 v8, s[64:67], s71 offen lds
  s_add_u32 s71, s71, 27648
  s_mov_b32 m0, s55
  s_add_u32 s55, s55, 1024
  buffer_load_dwordx4 v8, s[64:67], s71 offen lds
  s_add_u32 s71, s71, 27648
  s_mov_b32 m0, s55
  s_add_u32 s55, s55, 1024
  buffer_load_dwordx4 v8, s[64:67], s71 offen lds
  s_add_u32 s71, s71, 27648
  s_mov_b32 m0, s55
  s_add_u32 s55, s55, 1024
  buffer_load_dwordx4 v8, s[64:67], s71 offen lds
  s_waitcnt vmcnt(12)
  s_barrier
  s_mul_i32 s71, s24, 110592
  s_add_u32 s71, s71, s68
  s_mul_i32 s69, s24, 4096
  s_add_u32 s55, s69, 49152
  s_add_u32 s68, s68, 442368
  s_mov_b32 m0, s55
  s_add_u32 s55, s55, 1024
  buffer_load_dwordx4 v8, s[64:67], s71 offen lds
  s_add_u32 s71, s71, 27648
  s_mov_b32 m0, s55
  s_add_u32 s55, s55, 1024
  buffer_load_dwordx4 v8, s[64:67], s71 offen lds
  s_add_u32 s71, s71, 27648
  s_mov_b32 m0, s55
  s_add_u32 s55, s55, 1024
  buffer_load_dwordx4 v8, s[64:67], s71 offen lds
  s_add_u32 s71, s71, 27648
  s_mov_b32 m0, s55
  s_add_u32 s55, s55, 1024
  buffer_load_dwordx4 v8, s[64:67], s71 offen lds
  s_waitcnt vmcnt(12)
  s_barrier
  s_mul_i32 s71, s24, 110592
  s_add_u32 s71, s71, s68
  s_mul_i32 s69, s24, 4096
  s_add_u32 s55, s69, 65536
  s_add_u32 s68, s68, 442368
  s_mov_b32 m0, s55
  s_add_u32 s55, s55, 1024
  buffer_load_dwordx4 v8, s[64:67], s71 offen lds
  s_add_u32 s71, s71, 27648
  s_mov_b32 m0, s55
  s_add_u32 s55, s55, 1024
  buffer_load_dwordx4 v8, s[64:67], s71 offen lds
  s_add_u32 s71, s71, 27648
  s_mov_b32 m0, s55
  s_add_u32 s55, s55, 1024
  buffer_load_dwordx4 v8, s[64:67], s71 offen lds
  s_add_u32 s71, s71, 27648
  s_mov_b32 m0, s55
  s_add_u32 s55, s55, 1024
  buffer_load_dwordx4 v8, s[64:67], s71 offen lds
  s_waitcnt vmcnt(12)
  s_barrier
  s_lshl_b32 s68, s26, 8
  s_add_u32 s68, s68, 128
  s_mov_b32 s64, s32
  s_mov_b32 s65, s33
  s_mov_b32 s66, s34
  s_mov_b32 s67, s35
  s_mul_i32 s71, s24, 110592
  s_add_u32 s71, s71, s68
  s_mul_i32 s69, s24, 4096
  s_add_u32 s55, s69, 81920
  s_add_u32 s68, s68, 442368
  s_mov_b32 m0, s55
  s_add_u32 s55, s55, 1024
  buffer_load_dwordx4 v8, s[64:67], s71 offen lds
  s_add_u32 s71, s71, 27648
  s_mov_b32 m0, s55
  s_add_u32 s55, s55, 1024
  buffer_load_dwordx4 v8, s[64:67], s71 offen lds
  s_add_u32 s71, s71, 27648
  s_mov_b32 m0, s55
  s_add_u32 s55, s55, 1024
  buffer_load_dwordx4 v8, s[64:67], s71 offen lds
  s_add_u32 s71, s71, 27648
  s_mov_b32 m0, s55
  s_add_u32 s55, s55, 1024
  buffer_load_dwordx4 v8, s[64:67], s71 offen lds
  s_mul_i32 s71, s24, 110592
  s_add_u32 s71, s71, s68
  s_mul_i32 s69, s24, 4096
  s_add_u32 s55, s69, 98304
  s_add_u32 s68, s68, 442368
  s_mov_b32 m0, s55
  s_add_u32 s55, s55, 1024
  buffer_load_dwordx4 v8, s[64:67], s71 offen lds
  s_add_u32 s71, s71, 27648
  s_mov_b32 m0, s55
  s_add_u32 s55, s55, 1024
  buffer_load_dwordx4 v8, s[64:67], s71 offen lds
  s_add_u32 s71, s71, 27648
  s_mov_b32 m0, s55
  s_add_u32 s55, s55, 1024
  buffer_load_dwordx4 v8, s[64:67], s71 offen lds
  s_add_u32 s71, s71, 27648
  s_mov_b32 m0, s55
  s_add_u32 s55, s55, 1024
  buffer_load_dwordx4 v8, s[64:67], s71 offen lds
  s_waitcnt vmcnt(16)
  s_barrier
  s_lshl_b32 s81, s25, 2
  s_add_u32 s81, s81, s24
  s_lshl_b32 s81, s81, 3
  s_add_u32 s81, s81, s26
  s_mul_i32 s81, s81, 5120
  buffer_load_dwordx4 v[128:131], v14, s[44:47], s81 offen offset:0
  buffer_load_dwordx4 v[132:135], v14, s[44:47], s81 offen offset:1024
  buffer_load_dwordx4 v[136:139], v14, s[44:47], s81 offen offset:2048
  buffer_load_dwordx4 v[140:143], v14, s[44:47], s81 offen offset:3072
  s_add_u32 s81, s81, 4096
  buffer_load_dwordx4 v[144:147], v14, s[44:47], s81 offen
  s_mul_i32 s71, s24, 110592
  s_add_u32 s71, s71, s68
  s_mul_i32 s69, s24, 4096
  s_add_u32 s55, s69, 0
  s_add_u32 s68, s68, 442368
  s_mov_b32 m0, s55
  s_add_u32 s55, s55, 1024
  buffer_load_dwordx4 v8, s[64:67], s71 offen lds
  s_add_u32 s71, s71, 27648
  s_mov_b32 m0, s55
  s_add_u32 s55, s55, 1024
  buffer_load_dwordx4 v8, s[64:67], s71 offen lds
  s_add_u32 s71, s71, 27648
  s_mov_b32 m0, s55
  s_add_u32 s55, s55, 1024
  buffer_load_dwordx4 v8, s[64:67], s71 offen lds
  s_add_u32 s71, s71, 27648
  s_mov_b32 m0, s55
  s_add_u32 s55, s55, 1024
  buffer_load_dwordx4 v8, s[64:67], s71 offen lds
  s_waitcnt vmcnt(21)
  s_barrier
  s_mul_i32 s71, s24, 110592
  s_add_u32 s71, s71, s68
  s_mul_i32 s69, s24, 4096
  s_add_u32 s55, s69, 16384
  s_add_u32 s68, s68, 442368
  s_mov_b32 m0, s55
  s_add_u32 s55, s55, 1024
  buffer_load_dwordx4 v8, s[64:67], s71 offen lds
  s_add_u32 s71, s71, 27648
  s_mov_b32 m0, s55
  s_add_u32 s55, s55, 1024
  buffer_load_dwordx4 v8, s[64:67], s71 offen lds
  s_add_u32 s71, s71, 27648
  s_mov_b32 m0, s55
  s_add_u32 s55, s55, 1024
  buffer_load_dwordx4 v8, s[64:67], s71 offen lds
  s_add_u32 s71, s71, 27648
  s_mov_b32 m0, s55
  s_add_u32 s55, s55, 1024
  buffer_load_dwordx4 v8, s[64:67], s71 offen lds
  s_waitcnt vmcnt(21)
  s_barrier
  s_mul_i32 s71, s24, 110592
  s_add_u32 s71, s71, s68
  s_mul_i32 s69, s24, 4096
  s_add_u32 s55, s69, 32768
  s_add_u32 s68, s68, 442368
  s_mov_b32 m0, s55
  s_add_u32 s55, s55, 1024
  buffer_load_dwordx4 v8, s[64:67], s71 offen lds
  s_add_u32 s71, s71, 27648
  s_mov_b32 m0, s55
  s_add_u32 s55, s55, 1024
  buffer_load_dwordx4 v8, s[64:67], s71 offen lds
  s_add_u32 s71, s71, 27648
  s_mov_b32 m0, s55
  s_add_u32 s55, s55, 1024
  buffer_load_dwordx4 v8, s[64:67], s71 offen lds
  s_add_u32 s71, s71, 27648
  s_mov_b32 m0, s55
  s_add_u32 s55, s55, 1024
  buffer_load_dwordx4 v8, s[64:67], s71 offen lds
  s_waitcnt vmcnt(21)
  s_barrier
  s_lshl_b32 s68, s26, 8
  s_add_u32 s68, s68, 128
  s_mov_b32 s64, s36
  s_mov_b32 s65, s37
  s_mov_b32 s66, s38
  s_mov_b32 s67, s39
  s_mul_i32 s71, s24, 110592
  s_add_u32 s71, s71, s68
  s_mul_i32 s69, s24, 4096
  s_add_u32 s55, s69, 49152
  s_add_u32 s68, s68, 442368
  s_mov_b32 m0, s55
  s_add_u32 s55, s55, 1024
  buffer_load_dwordx4 v8, s[64:67], s71 offen lds
  s_add_u32 s71, s71, 27648
  s_mov_b32 m0, s55
  s_add_u32 s55, s55, 1024
  buffer_load_dwordx4 v8, s[64:67], s71 offen lds
  s_add_u32 s71, s71, 27648
  s_mov_b32 m0, s55
  s_add_u32 s55, s55, 1024
  buffer_load_dwordx4 v8, s[64:67], s71 offen lds
  s_add_u32 s71, s71, 27648
  s_mov_b32 m0, s55
  s_add_u32 s55, s55, 1024
  buffer_load_dwordx4 v8, s[64:67], s71 offen lds
  s_waitcnt vmcnt(21)
  s_barrier
  s_mul_i32 s71, s24, 110592
  s_add_u32 s71, s71, s68
  s_mul_i32 s69, s24, 4096
  s_add_u32 s55, s69, 65536
  s_add_u32 s68, s68, 442368
  s_mov_b32 m0, s55
  s_add_u32 s55, s55, 1024
  buffer_load_dwordx4 v8, s[64:67], s71 offen lds
  s_add_u32 s71, s71, 27648
  s_mov_b32 m0, s55
  s_add_u32 s55, s55, 1024
  buffer_load_dwordx4 v8, s[64:67], s71 offen lds
  s_add_u32 s71, s71, 27648
  s_mov_b32 m0, s55
  s_add_u32 s55, s55, 1024
  buffer_load_dwordx4 v8, s[64:67], s71 offen lds
  s_add_u32 s71, s71, 27648
  s_mov_b32 m0, s55
  s_add_u32 s55, s55, 1024
  buffer_load_dwordx4 v8, s[64:67], s71 offen lds
  s_waitcnt vmcnt(16)
  s_barrier
  s_mul_i32 s71, s24, 110592
  s_add_u32 s71, s71, s68
  s_mul_i32 s69, s24, 4096
  s_add_u32 s55, s69, 81920
  s_add_u32 s68, s68, 442368
  s_mov_b32 m0, s55
  s_add_u32 s55, s55, 1024
  buffer_load_dwordx4 v8, s[64:67], s71 offen lds
  s_add_u32 s71, s71, 27648
  s_mov_b32 m0, s55
  s_add_u32 s55, s55, 1024
  buffer_load_dwordx4 v8, s[64:67], s71 offen lds
  s_add_u32 s71, s71, 27648
  s_mov_b32 m0, s55
  s_add_u32 s55, s55, 1024
  buffer_load_dwordx4 v8, s[64:67], s71 offen lds
  s_add_u32 s71, s71, 27648
  s_mov_b32 m0, s55
  s_add_u32 s55, s55, 1024
  buffer_load_dwordx4 v8, s[64:67], s71 offen lds
  s_waitcnt vmcnt(16)
  s_barrier
  s_mul_i32 s71, s24, 110592
  s_add_u32 s71, s71, s68
  s_mul_i32 s69, s24, 4096
  s_add_u32 s55, s69, 98304
  s_add_u32 s68, s68, 442368
  s_mov_b32 m0, s55
  s_add_u32 s55, s55, 1024
  buffer_load_dwordx4 v8, s[64:67], s71 offen lds
  s_add_u32 s71, s71, 27648
  s_mov_b32 m0, s55
  s_add_u32 s55, s55, 1024
  buffer_load_dwordx4 v8, s[64:67], s71 offen lds
  s_add_u32 s71, s71, 27648
  s_mov_b32 m0, s55
  s_add_u32 s55, s55, 1024
  buffer_load_dwordx4 v8, s[64:67], s71 offen lds
  s_add_u32 s71, s71, 27648
  s_mov_b32 m0, s55
  s_add_u32 s55, s55, 1024
  buffer_load_dwordx4 v8, s[64:67], s71 offen lds
  s_waitcnt vmcnt(16)
  s_barrier
  s_cmp_lg_u32 s24, 0
  s_cbranch_scc1 Lfd_1
  s_lshl_b32 s80, s26, 11
  v_lshlrev_b32 v176, 7, v15
  v_add_u32 v176, s80, v176
  s_mov_b64 exec, 0xffff
  s_mov_b32 s70, 20000
Lfr_2:
  buffer_load_dword v178, v176, s[92:95], 0 offen sc1
  s_waitcnt vmcnt(0)
  v_cmp_ne_u32 vcc, 0, v178
  s_cmp_eq_u64 vcc, exec
  s_cbranch_scc1 Lfe_3
  s_sleep 1
  s_sub_u32 s70, s70, 1
  s_cmp_lg_u32 s70, 0
  s_cbranch_scc1 Lfr_2
Lfe_3:
  s_mov_b64 exec, -1
Lfd_1:
  s_mul_i32 s71, s24, 110592
  s_add_u32 s71, s71, s68
  s_mul_i32 s69, s24, 4096
  s_add_u32 s55, s69, 0
  s_add_u32 s68, s68, 442368
  s_mov_b32 m0, s55
  s_add_u32 s55, s55, 1024
  buffer_load_dwordx4 v8, s[64:67], s71 offen lds
  s_add_u32 s71, s71, 27648
  s_mov_b32 m0, s55
  s_add_u32 s55, s55, 1024
  buffer_load_dwordx4 v8, s[64:67], s71 offen lds
  s_add_u32 s71, s71, 27648
  s_mov_b32 m0, s55
  s_add_u32 s55, s55, 1024
  buffer_load_dwordx4 v8, s[64:67], s71 offen lds
  s_add_u32 s71, s71, 27648
  s_mov_b32 m0, s55
  s_add_u32 s55, s55, 1024
  buffer_load_dwordx4 v8, s[64:67], s71 offen lds
  s_waitcnt vmcnt(16)
  s_barrier
  s_mul_i32 s80, s24, 1792
  v_add_u32 v176, s80, v14
  s_mov_b32 s81, 0
  buffer_load_dwordx4 v[180:183], v176, s[48:51], s81 offen sc1
  buffer_load_dwordx4 v[184:187], v176, s[48:51], s81 offen offset:1024 sc1
  s_mov_b32 s81, 8192
  buffer_load_dwordx4 v[188:191], v176, s[48:51], s81 offen sc1
  buffer_load_dwordx4 v[192:195], v176, s[48:51], s81 offen offset:1024 sc1
  s_mov_b32 s81, 16384
  buffer_load_dwordx4 v[196:199], v176, s[48:51], s81 offen sc1
  buffer_load_dwordx4 v[200:203], v176, s[48:51], s81 offen offset:1024 sc1
  s_mov_b32 s81, 24576
  buffer_load_dwordx4 v[204:207], v176, s[48:51], s81 offen sc1
  buffer_load_dwordx4 v[208:211], v176, s[48:51], s81 offen offset:1024 sc1
  s_waitcnt vmcnt(20)
  s_barrier
  s_waitcnt vmcnt(0)
  v_add_f32 v180, v180, v188
  v_add_f32 v196, v196, v204
  v_add_f32 v181, v181, v189
  v_add_f32 v197, v197, v205
  v_add_f32 v182, v182, v190
  v_add_f32 v198, v198, v206
  v_add_f32 v183, v183, v191
  v_add_f32 v199, v199, v207
  v_add_f32 v184, v184, v192
  v_add_f32 v200, v200, v208
  v_add_f32 v185, v185, v193
  v_add_f32 v201, v201, v209
  v_add_f32 v186, v186, v194
  v_add_f32 v202, v202, v210
  v_add_f32 v187, v187, v195
  v_add_f32 v203, v203, v211
  v_add_f32 v180, v180, v196
  v_add_f32 v181, v181, v197
  v_add_f32 v182, v182, v198
  v_add_f32 v183, v183, v199
  v_add_f32 v184, v184, v200
  v_add_f32 v185, v185, v201
  v_add_f32 v186, v186, v202
  v_add_f32 v187, v187, v203
  v_add_u32 v176, 114688, v176
  ds_write_b128 v176, v[180:183]
  s_mov_b32 s80, -1
  s_mov_b32 s81, 0xffff
  s_mov_b64 exec, s[80:81]
  ds_write_b128 v176, v[184:187] offset:1024
  s_mov_b64 exec, -1
  s_waitcnt lgkmcnt(0)
  s_waitcnt vmcnt(16)
  s_barrier
  s_cmp_lg_u32 s24, 0
  s_cbranch_scc1 Lob_5
  s_mov_b32 s80, 0
  s_mov_b32 s81, 0
  s_mov_b32 s82, 122880
  s_mov_b32 s83, 32
  s_branch Lobe_4
Lob_5:
  s_cmp_lg_u32 s24, 1
  s_cbranch_scc1 Lob_6
  s_mov_b32 s80, 0
  s_mov_b32 s81, 16
  s_mov_b32 s82, 123904
  s_mov_b32 s83, 32
  s_branch Lobe_4
Lob_6:
  s_cmp_lg_u32 s24, 2
  s_cbranch_scc1 Lob_7
  s_mov_b32 s80, 0
  s_mov_b32 s81, 32
  s_mov_b32 s82, 124928
  s_mov_b32 s83, 32
  s_branch Lobe_4
Lob_7:
  s_mov_b32 s80, 32
  s_mov_b32 s81, 16
  s_mov_b32 s82, 125952
  s_mov_b32 s83, 32
Lobe_4:
  v_add_u32 v192, s80, v24
  v_mul_u32_u24 v193, 205, v192
  v_lshrrev_b32 v193, 12, v193
  v_subrev_u32 v196, 80, v192
  v_cmp_le_u32 vcc, 80, v192
  v_lshlrev_b32 v194, 2, v23
  v_add_u32 v194, s81, v194
  v_cndmask_b32 v193, v193, v196, vcc
  v_mul_u32_u24 v196, 20, v193
  v_sub_u32 v194, v194, v196
  v_cmp_gt_u32 vcc, s83, v24
  v_mov_b32 v196, 0x1000
  v_mul_u32_u24 v195, 80, v192
  v_cndmask_b32 v194, v196, v194, vcc
  v_add_u32 v197, 8, v194
  v_cmp_gt_u32 s[72:73], 20, v194
  v_cmp_gt_u32 s[74:75], 20, v197
  v_add_u32 v195, 114688, v195
  s_nop 0
  v_cndmask_b32 v194, 0, v194, s[72:73]
  v_cndmask_b32 v197, 0, v197, s[74:75]
  v_lshl_add_u32 v194, v194, 2, v195
  v_lshl_add_u32 v197, v197, 2, v195
  ds_read_b128 v[176:179], v194
  ds_read_b128 v[180:183], v197
  v_add_u32 v196, s82, v14
  s_waitcnt lgkmcnt(0)
  v_cvt_pk_bf16_f32 v184, v176, v177
  v_cvt_pk_bf16_f32 v185, v178, v179
  v_cvt_pk_bf16_f32 v186, v180, v181
  v_cvt_pk_bf16_f32 v187, v182, v183
  v_cndmask_b32 v184, 0, v184, s[72:73]
  v_cndmask_b32 v185, 0, v185, s[72:73]
  v_cndmask_b32 v186, 0, v186, s[74:75]
  v_cndmask_b32 v187, 0, v187, s[74:75]
  ds_write_b128 v196, v[184:187]
  s_cmp_lg_u32 s24, 0
  s_cbranch_scc1 Lob_10
  s_mov_b32 s80, 32
  s_mov_b32 s81, 32
  s_mov_b32 s82, 126976
  s_mov_b32 s83, 32
  s_branch Lobe_9
Lob_10:
  s_cmp_lg_u32 s24, 1
  s_cbranch_scc1 Lob_11
  s_mov_b32 s80, 32
  s_mov_b32 s81, 48
  s_mov_b32 s82, 128000
  s_mov_b32 s83, 32
  s_branch Lobe_9
Lob_11:
  s_cmp_lg_u32 s24, 2
  s_cbranch_scc1 Lob_12
  s_mov_b32 s80, 32
  s_mov_b32 s81, 64
  s_mov_b32 s82, 129024
  s_mov_b32 s83, 32
  s_branch Lobe_9
Lob_12:
  s_mov_b32 s80, 64
  s_mov_b32 s81, 0
  s_mov_b32 s82, 130048
  s_mov_b32 s83, 20
Lobe_9:
  v_add_u32 v192, s80, v24
  v_mul_u32_u24 v193, 205, v192
  v_lshrrev_b32 v193, 12, v193
  v_subrev_u32 v196, 80, v192
  v_cmp_le_u32 vcc, 80, v192
  v_lshlrev_b32 v194, 2, v23
  v_add_u32 v194, s81, v194
  v_cndmask_b32 v193, v193, v196, vcc
  v_mul_u32_u24 v196, 20, v193
  v_sub_u32 v194, v194, v196
  v_cmp_gt_u32 vcc, s83, v24
  v_mov_b32 v196, 0x1000
  v_mul_u32_u24 v195, 80, v192
  v_cndmask_b32 v194, v196, v194, vcc
  v_add_u32 v197, 8, v194
  v_cmp_gt_u32 s[72:73], 20, v194
  v_cmp_gt_u32 s[74:75], 20, v197
  v_add_u32 v195, 114688, v195
  s_nop 0
  v_cndmask_b32 v194, 0, v194, s[72:73]
  v_cndmask_b32 v197, 0, v197, s[74:75]
  v_lshl_add_u32 v194, v194, 2, v195
  v_lshl_add_u32 v197, v197, 2, v195
  ds_read_b128 v[176:179], v194
  ds_read_b128 v[180:183], v197
  v_add_u32 v196, s82, v14
  s_waitcnt lgkmcnt(0)
  v_cvt_pk_bf16_f32 v184, v176, v177
  v_cvt_pk_bf16_f32 v185, v178, v179
  v_cvt_pk_bf16_f32 v186, v180, v181
  v_cvt_pk_bf16_f32 v187, v182, v183
  v_cndmask_b32 v184, 0, v184, s[72:73]
  v_cndmask_b32 v185, 0, v185, s[72:73]
  v_cndmask_b32 v186, 0, v186, s[74:75]
  v_cndmask_b32 v187, 0, v187, s[74:75]
  ds_write_b128 v196, v[184:187]
  s_waitcnt vmcnt(12)
  s_barrier
  s_cmp_lg_u32 s24, 0
  s_cbranch_scc1 Lob_15
  s_mov_b32 s80, 64
  s_mov_b32 s81, 16
  s_mov_b32 s82, 131072
  s_mov_b32 s83, 20
  s_branch Lobe_14
Lob_15:
  s_cmp_lg_u32 s24, 1
  s_cbranch_scc1 Lob_16
  s_mov_b32 s80, 64
  s_mov_b32 s81, 32
  s_mov_b32 s82, 132096
  s_mov_b32 s83, 20
  s_branch Lobe_14
Lob_16:
  s_cmp_lg_u32 s24, 2
  s_cbranch_scc1 Lob_17
  s_mov_b32 s80, 64
  s_mov_b32 s81, 48
  s_mov_b32 s82, 133120
  s_mov_b32 s83, 20
  s_branch Lobe_14
Lob_17:
  s_mov_b32 s80, 64
  s_mov_b32 s81, 64
  s_mov_b32 s82, 134144
  s_mov_b32 s83, 20
Lobe_14:
  v_add_u32 v192, s80, v24
  v_mul_u32_u24 v193, 205, v192
  v_lshrrev_b32 v193, 12, v193
  v_subrev_u32 v196, 80, v192
  v_cmp_le_u32 vcc, 80, v192
  v_lshlrev_b32 v194, 2, v23
  v_add_u32 v194, s81, v194
  v_cndmask_b32 v193, v193, v196, vcc
  v_mul_u32_u24 v196, 20, v193
  v_sub_u32 v194, v194, v196
  v_cmp_gt_u32 vcc, s83, v24
  v_mov_b32 v196, 0x1000
  v_mul_u32_u24 v195, 80, v192
  v_cndmask_b32 v194, v196, v194, vcc
  v_add_u32 v197, 8, v194
  v_cmp_gt_u32 s[72:73], 20, v194
  v_cmp_gt_u32 s[74:75], 20, v197
  v_add_u32 v195, 114688, v195
  s_nop 0
  v_cndmask_b32 v194, 0, v194, s[72:73]
  v_cndmask_b32 v197, 0, v197, s[74:75]
  v_lshl_add_u32 v194, v194, 2, v195
  v_lshl_add_u32 v197, v197, 2, v195
  ds_read_b128 v[176:179], v194
  ds_read_b128 v[180:183], v197
  v_add_u32 v196, s82, v14
  s_waitcnt lgkmcnt(0)
  v_cvt_pk_bf16_f32 v184, v176, v177
  v_cvt_pk_bf16_f32 v185, v178, v179
  v_cvt_pk_bf16_f32 v186, v180, v181
  v_cvt_pk_bf16_f32 v187, v182, v183
  v_cndmask_b32 v184, 0, v184, s[72:73]
  v_cndmask_b32 v185, 0, v185, s[72:73]
  v_cndmask_b32 v186, 0, v186, s[74:75]
  v_cndmask_b32 v187, 0, v187, s[74:75]
  ds_write_b128 v196, v[184:187]
  s_waitcnt lgkmcnt(0)
  s_waitcnt vmcnt(8)
  s_barrier
  s_waitcnt vmcnt(40)
  v_add_u32 v25, 122880, v14
  ds_read_b128 v[208:211], v25 offset:7168
  ds_read_b128 v[212:215], v25 offset:8192
  ds_read_b128 v[216:219], v25 offset:9216
  ds_read_b128 v[220:223], v25 offset:10240
  ds_read_b128 v[224:227], v25 offset:11264
  s_waitcnt lgkmcnt(4)
  v_mfma_f32_32x32x16_bf16 v[176:191], v[208:211], v[128:131], 0
  s_waitcnt lgkmcnt(3)
  v_mfma_f32_32x32x16_bf16 v[176:191], v[212:215], v[132:135], v[176:191]
  s_waitcnt lgkmcnt(2)
  v_mfma_f32_32x32x16_bf16 v[176:191], v[216:219], v[136:139], v[176:191]
  s_waitcnt lgkmcnt(1)
  v_mfma_f32_32x32x16_bf16 v[176:191], v[220:223], v[140:143], v[176:191]
  s_waitcnt lgkmcnt(0)
  v_mfma_f32_32x32x16_bf16 v[176:191], v[224:227], v[144:147], v[176:191]
  s_nop 7
  s_nop 7
  v_mov_b32 v248, v184
  v_mov_b32 v249, v185
  v_mov_b32 v250, v186
  v_mov_b32 v251, v187
  v_mov_b32 v192, v184
  v_mov_b32 v193, v185
  v_mov_b32 v194, v186
  v_mov_b32 v195, v187
  s_nop 1
  v_permlane32_swap_b32 v248, v192
  v_permlane32_swap_b32 v249, v193
  v_permlane32_swap_b32 v250, v194
  v_permlane32_swap_b32 v251, v195
  s_nop 1
  v_add_f32 v248, s99, v248
  v_add_f32 v249, s99, v249
  v_add_f32 v250, s99, v250
  v_add_f32 v251, s99, v251
  v_rcp_f32 v248, v248
  v_rcp_f32 v249, v249
  v_rcp_f32 v250, v250
  v_rcp_f32 v251, v251
  v_cmp_eq_u32 vcc, 1, v23
  s_nop 1
  v_cndmask_b32 v252, v248, v249, vcc
  v_cndmask_b32 v253, v250, v251, vcc
  v_mul_f32 v176, v176, v251
  v_mul_f32 v177, v177, v251
  v_mul_f32 v178, v178, v251
  v_mul_f32 v179, v179, v251
  v_mul_f32 v180, v180, v251
  v_mul_f32 v181, v181, v251
  v_mul_f32 v182, v182, v251
  v_mul_f32 v183, v183, v251
  v_cvt_pk_bf16_f32 v200, v176, v177
  v_cvt_pk_bf16_f32 v201, v178, v179
  v_cvt_pk_bf16_f32 v202, v180, v181
  v_cvt_pk_bf16_f32 v203, v182, v183
  s_mul_i32 s82, s26, 5
  s_lshl_b32 s81, s25, 2
  s_add_u32 s81, s81, s24
  s_mul_i32 s81, s81, 148
  s_add_u32 s81, s81, s82
  s_lshl_b32 s81, s81, 10
  s_add_u32 s81, s81, 4096
  buffer_store_dwordx4 v[200:203], v14, s[40:43], s81 offen offset:0 sc0 sc1
  s_nop 1
  v_add_u32 v25, 122880, v14
  ds_read_b128 v[208:211], v25 offset:0
  ds_read_b128 v[212:215], v25 offset:1024
  ds_read_b128 v[216:219], v25 offset:2048
  s_waitcnt lgkmcnt(2)
  v_mfma_f32_32x32x16_bf16 v[176:191], v[208:211], v[128:131], 0
  s_waitcnt lgkmcnt(1)
  v_mfma_f32_32x32x16_bf16 v[176:191], v[212:215], v[132:135], v[176:191]
  s_waitcnt lgkmcnt(0)
  v_mfma_f32_32x32x16_bf16 v[176:191], v[216:219], v[136:139], v[176:191]
  s_nop 7
  s_nop 7
  v_mul_f32 v176, v176, v248
  v_mul_f32 v177, v177, v248
  v_mul_f32 v178, v178, v248
  v_mul_f32 v179, v179, v248
  v_mul_f32 v180, v180, v248
  v_mul_f32 v181, v181, v248
  v_mul_f32 v182, v182, v248
  v_mul_f32 v183, v183, v248
  v_mul_f32 v184, v184, v252
  v_mul_f32 v185, v185, v252
  v_mul_f32 v186, v186, v252
  v_mul_f32 v187, v187, v252
  v_mul_f32 v188, v188, v249
  v_mul_f32 v189, v189, v249
  v_mul_f32 v190, v190, v249
  v_mul_f32 v191, v191, v249
  v_cvt_pk_bf16_f32 v200, v176, v177
  v_cvt_pk_bf16_f32 v201, v178, v179
  v_cvt_pk_bf16_f32 v202, v180, v181
  v_cvt_pk_bf16_f32 v203, v182, v183
  v_cvt_pk_bf16_f32 v204, v184, v185
  v_cvt_pk_bf16_f32 v205, v186, v187
  v_cvt_pk_bf16_f32 v206, v188, v189
  v_cvt_pk_bf16_f32 v207, v190, v191
  s_mul_i32 s82, s26, 5
  s_lshl_b32 s81, s25, 2
  s_add_u32 s81, s81, s24
  s_mul_i32 s81, s81, 148
  s_add_u32 s81, s81, s82
  s_lshl_b32 s81, s81, 10
  buffer_store_dwordx4 v[200:203], v14, s[40:43], s81 offen offset:0 sc0 sc1
  buffer_store_dwordx4 v[204:207], v14, s[40:43], s81 offen offset:1024 sc0 sc1
  s_nop 1
  v_add_u32 v25, 122880, v14
  ds_read_b128 v[208:211], v25 offset:3072
  ds_read_b128 v[212:215], v25 offset:4096
  ds_read_b128 v[216:219], v25 offset:5120
  ds_read_b128 v[220:223], v25 offset:6144
  s_waitcnt lgkmcnt(3)
  v_mfma_f32_32x32x16_bf16 v[176:191], v[208:211], v[132:135], 0
  s_waitcnt lgkmcnt(2)
  v_mfma_f32_32x32x16_bf16 v[176:191], v[212:215], v[136:139], v[176:191]
  s_waitcnt lgkmcnt(1)
  v_mfma_f32_32x32x16_bf16 v[176:191], v[216:219], v[140:143], v[176:191]
  s_waitcnt lgkmcnt(0)
  v_mfma_f32_32x32x16_bf16 v[176:191], v[220:223], v[144:147], v[176:191]
  s_nop 7
  s_nop 7
  v_mul_f32 v176, v176, v249
  v_mul_f32 v177, v177, v249
  v_mul_f32 v178, v178, v249
  v_mul_f32 v179, v179, v249
  v_mul_f32 v180, v180, v250
  v_mul_f32 v181, v181, v250
  v_mul_f32 v182, v182, v250
  v_mul_f32 v183, v183, v250
  v_mul_f32 v184, v184, v250
  v_mul_f32 v185, v185, v250
  v_mul_f32 v186, v186, v250
  v_mul_f32 v187, v187, v250
  v_mul_f32 v188, v188, v253
  v_mul_f32 v189, v189, v253
  v_mul_f32 v190, v190, v253
  v_mul_f32 v191, v191, v253
  v_cvt_pk_bf16_f32 v200, v176, v177
  v_cvt_pk_bf16_f32 v201, v178, v179
  v_cvt_pk_bf16_f32 v202, v180, v181
  v_cvt_pk_bf16_f32 v203, v182, v183
  v_cvt_pk_bf16_f32 v204, v184, v185
  v_cvt_pk_bf16_f32 v205, v186, v187
  v_cvt_pk_bf16_f32 v206, v188, v189
  v_cvt_pk_bf16_f32 v207, v190, v191
  s_mul_i32 s82, s26, 5
  s_lshl_b32 s81, s25, 2
  s_add_u32 s81, s81, s24
  s_mul_i32 s81, s81, 148
  s_add_u32 s81, s81, s82
  s_lshl_b32 s81, s81, 10
  buffer_store_dwordx4 v[200:203], v14, s[40:43], s81 offen offset:2048 sc0 sc1
  buffer_store_dwordx4 v[204:207], v14, s[40:43], s81 offen offset:3072 sc0 sc1
  s_nop 1
  s_endpgm
front_kernel_akv:
  v_and_b32 v15, 63, v0
  v_lshlrev_b32 v14, 4, v15
  s_mul_i32 s68, s26, 122880
  s_add_u32 s68, s68, 983040
  s_mov_b32 s64, s28
  s_mov_b32 s65, s29
  s_mov_b32 s66, s30
  s_mov_b32 s67, s31
  s_mul_i32 s71, s24, 6144
  s_add_u32 s71, s71, s68
  s_mul_i32 s69, s24, 6144
  s_add_u32 s55, s69, 0
  s_add_u32 s68, s68, 24576
  s_mov_b32 m0, s55
  s_add_u32 s55, s55, 1024
  buffer_load_dwordx4 v14, s[64:67], s71 offen lds
  s_add_u32 s71, s71, 1024
  s_mov_b32 m0, s55
  s_add_u32 s55, s55, 1024
  buffer_load_dwordx4 v14, s[64:67], s71 offen lds
  s_add_u32 s71, s71, 1024
  s_mov_b32 m0, s55
  s_add_u32 s55, s55, 1024
  buffer_load_dwordx4 v14, s[64:67], s71 offen lds
  s_add_u32 s71, s71, 1024
  s_mov_b32 m0, s55
  s_add_u32 s55, s55, 1024
  buffer_load_dwordx4 v14, s[64:67], s71 offen lds
  s_add_u32 s71, s71, 1024
  s_mov_b32 m0, s55
  s_add_u32 s55, s55, 1024
  buffer_load_dwordx4 v14, s[64:67], s71 offen lds
  s_add_u32 s71, s71, 1024
  s_mov_b32 m0, s55
  s_add_u32 s55, s55, 1024
  buffer_load_dwordx4 v14, s[64:67], s71 offen lds
  s_mul_i32 s71, s24, 6144
  s_add_u32 s71, s71, s68
  s_mul_i32 s69, s24, 6144
  s_add_u32 s55, s69, 24576
  s_add_u32 s68, s68, 24576
  s_mov_b32 m0, s55
  s_add_u32 s55, s55, 1024
  buffer_load_dwordx4 v14, s[64:67], s71 offen lds
  s_add_u32 s71, s71, 1024
  s_mov_b32 m0, s55
  s_add_u32 s55, s55, 1024
  buffer_load_dwordx4 v14, s[64:67], s71 offen lds
  s_add_u32 s71, s71, 1024
  s_mov_b32 m0, s55
  s_add_u32 s55, s55, 1024
  buffer_load_dwordx4 v14, s[64:67], s71 offen lds
  s_add_u32 s71, s71, 1024
  s_mov_b32 m0, s55
  s_add_u32 s55, s55, 1024
  buffer_load_dwordx4 v14, s[64:67], s71 offen lds
  s_add_u32 s71, s71, 1024
  s_mov_b32 m0, s55
  s_add_u32 s55, s55, 1024
  buffer_load_dwordx4 v14, s[64:67], s71 offen lds
  s_add_u32 s71, s71, 1024
  s_mov_b32 m0, s55
  s_add_u32 s55, s55, 1024
  buffer_load_dwordx4 v14, s[64:67], s71 offen lds
  s_mov_b32 s32, s12
  s_mov_b32 s33, s13
  s_mov_b32 s34, 2211840
  s_mov_b32 s35, 0x00020000
  s_mov_b32 s36, s14
  s_mov_b32 s37, s15
  s_mov_b32 s38, 2211840
  s_mov_b32 s39, 0x00020000
  s_mov_b32 s40, s22
  s_mov_b32 s41, s23
  s_mov_b32 s42, 9699328
  s_mov_b32 s43, 0x00020000
  s_add_u32 s44, s22, 20971520
  s_addc_u32 s45, s23, 0
  s_mov_b32 s46, 2621440
  s_mov_b32 s47, 0x00020000
  s_lshl_b32 s69, s26, 15
  s_add_u32 s69, s69, 14680064
  s_add_u32 s48, s22, s69
  s_addc_u32 s49, s23, 0
  s_mov_b32 s50, 32768
  s_mov_b32 s51, 0x00020000
  v_lshlrev_b32 v14, 4, v15
  v_lshrrev_b32 v1, 3, v15
  v_bfe_u32 v2, v15, 2, 1
  v_bfe_u32 v3, v15, 4, 1
  v_xor_b32 v2, v2, v3
  v_and_b32 v3, 3, v15
  v_lshlrev_b32 v3, 4, v3
  v_lshlrev_b32 v4, 6, v2
  v_add_u32 v4, v4, v3
  v_mul_u32_u24 v5, 3456, v1
  v_add_u32 v8, v5, v4
  v_add_u32 v10, v5, v3
  v_lshlrev_b32 v5, 7, v1
  v_add_u32 v9, v5, v4
  v_cmp_eq_u32 s[76:77], 0, v2
  v_cmp_eq_u32 s[78:79], 1, v2
  v_lshrrev_b32 v23, 5, v15
  v_and_b32 v24, 31, v15
  s_lshl_b32 s69, s24, 12
  v_add_u32 v20, s69, v14
  v_lshlrev_b32 v1, 2, v15
  v_add_u32 v21, s69, v1
  s_add_u32 s92, s22, 15466496
  s_addc_u32 s93, s23, 0
  s_mov_b32 s94, 16384
  s_mov_b32 s95, 0x00020000
  s_mov_b32 s99, 0x358637bd
  s_waitcnt vmcnt(6)
  s_barrier
  s_mul_i32 s71, s24, 6144
  s_add_u32 s71, s71, s68
  s_mul_i32 s69, s24, 6144
  s_add_u32 s55, s69, 49152
  s_add_u32 s68, s68, 24576
  s_mov_b32 m0, s55
  s_add_u32 s55, s55, 1024
  buffer_load_dwordx4 v14, s[64:67], s71 offen lds
  s_add_u32 s71, s71, 1024
  s_mov_b32 m0, s55
  s_add_u32 s55, s55, 1024
  buffer_load_dwordx4 v14, s[64:67], s71 offen lds
  s_add_u32 s71, s71, 1024
  s_mov_b32 m0, s55
  s_add_u32 s55, s55, 1024
  buffer_load_dwordx4 v14, s[64:67], s71 offen lds
  s_add_u32 s71, s71, 1024
  s_mov_b32 m0, s55
  s_add_u32 s55, s55, 1024
  buffer_load_dwordx4 v14, s[64:67], s71 offen lds
  s_add_u32 s71, s71, 1024
  s_mov_b32 m0, s55
  s_add_u32 s55, s55, 1024
  buffer_load_dwordx4 v14, s[64:67], s71 offen lds
  s_add_u32 s71, s71, 1024
  s_mov_b32 m0, s55
  s_add_u32 s55, s55, 1024
  buffer_load_dwordx4 v14, s[64:67], s71 offen lds
  s_mul_i32 s71, s24, 6144
  s_add_u32 s71, s71, s68
  s_mul_i32 s69, s24, 6144
  s_add_u32 s55, s69, 73728
  s_add_u32 s68, s68, 24576
  s_mov_b32 m0, s55
  s_add_u32 s55, s55, 1024
  buffer_load_dwordx4 v14, s[64:67], s71 offen lds
  s_add_u32 s71, s71, 1024
  s_mov_b32 m0, s55
  s_add_u32 s55, s55, 1024
  buffer_load_dwordx4 v14, s[64:67], s71 offen lds
  s_add_u32 s71, s71, 1024
  s_mov_b32 m0, s55
  s_add_u32 s55, s55, 1024
  buffer_load_dwordx4 v14, s[64:67], s71 offen lds
  s_add_u32 s71, s71, 1024
  s_mov_b32 m0, s55
  s_add_u32 s55, s55, 1024
  buffer_load_dwordx4 v14, s[64:67], s71 offen lds
  s_add_u32 s71, s71, 1024
  s_mov_b32 m0, s55
  s_add_u32 s55, s55, 1024
  buffer_load_dwordx4 v14, s[64:67], s71 offen lds
  s_add_u32 s71, s71, 1024
  s_mov_b32 m0, s55
  s_add_u32 s55, s55, 1024
  buffer_load_dwordx4 v14, s[64:67], s71 offen lds
  s_waitcnt vmcnt(12)
  s_barrier
  s_waitcnt vmcnt(6)
  s_barrier
  s_mul_i32 s71, s24, 6144
  s_add_u32 s71, s71, s68
  s_mul_i32 s69, s24, 6144
  s_add_u32 s55, s69, 0
  s_add_u32 s68, s68, 24576
  s_mov_b32 m0, s55
  s_add_u32 s55, s55, 1024
  buffer_load_dwordx4 v14, s[64:67], s71 offen lds
  s_add_u32 s71, s71, 1024
  s_mov_b32 m0, s55
  s_add_u32 s55, s55, 1024
  buffer_load_dwordx4 v14, s[64:67], s71 offen lds
  s_add_u32 s71, s71, 1024
  s_mov_b32 m0, s55
  s_add_u32 s55, s55, 1024
  buffer_load_dwordx4 v14, s[64:67], s71 offen lds
  s_add_u32 s71, s71, 1024
  s_mov_b32 m0, s55
  s_add_u32 s55, s55, 1024
  buffer_load_dwordx4 v14, s[64:67], s71 offen lds
  s_add_u32 s71, s71, 1024
  s_mov_b32 m0, s55
  s_add_u32 s55, s55, 1024
  buffer_load_dwordx4 v14, s[64:67], s71 offen lds
  s_add_u32 s71, s71, 1024
  s_mov_b32 m0, s55
  s_add_u32 s55, s55, 1024
  buffer_load_dwordx4 v14, s[64:67], s71 offen lds
  s_waitcnt vmcnt(6)
  s_barrier
  s_mul_i32 s68, s26, 81920
  s_add_u32 s68, s68, 1966080
  s_mov_b32 s64, s28
  s_mov_b32 s65, s29
  s_mov_b32 s66, s30
  s_mov_b32 s67, s31
  s_mul_i32 s71, s24, 4096
  s_add_u32 s71, s71, s68
  s_mul_i32 s69, s24, 4096
  s_add_u32 s55, s69, 24576
  s_add_u32 s68, s68, 16384
  s_mov_b32 m0, s55
  s_add_u32 s55, s55, 1024
  buffer_load_dwordx4 v9, s[64:67], s71 offen lds
  s_add_u32 s71, s71, 1024
  s_mov_b32 m0, s55
  s_add_u32 s55, s55, 1024
  buffer_load_dwordx4 v9, s[64:67], s71 offen lds
  s_add_u32 s71, s71, 1024
  s_mov_b32 m0, s55
  s_add_u32 s55, s55, 1024
  buffer_load_dwordx4 v9, s[64:67], s71 offen lds
  s_add_u32 s71, s71, 1024
  s_mov_b32 m0, s55
  s_add_u32 s55, s55, 1024
  buffer_load_dwordx4 v9, s[64:67], s71 offen lds
  s_waitcnt vmcnt(4)
  s_barrier
  s_mul_i32 s71, s24, 4096
  s_add_u32 s71, s71, s68
  s_mul_i32 s69, s24, 4096
  s_add_u32 s55, s69, 40960
  s_add_u32 s68, s68, 16384
  s_mov_b32 m0, s55
  s_add_u32 s55, s55, 1024
  buffer_load_dwordx4 v9, s[64:67], s71 offen lds
  s_add_u32 s71, s71, 1024
  s_mov_b32 m0, s55
  s_add_u32 s55, s55, 1024
  buffer_load_dwordx4 v9, s[64:67], s71 offen lds
  s_add_u32 s71, s71, 1024
  s_mov_b32 m0, s55
  s_add_u32 s55, s55, 1024
  buffer_load_dwordx4 v9, s[64:67], s71 offen lds
  s_add_u32 s71, s71, 1024
  s_mov_b32 m0, s55
  s_add_u32 s55, s55, 1024
  buffer_load_dwordx4 v9, s[64:67], s71 offen lds
  s_mul_i32 s71, s24, 4096
  s_add_u32 s71, s71, s68
  s_mul_i32 s69, s24, 4096
  s_add_u32 s55, s69, 57344
  s_add_u32 s68, s68, 16384
  s_mov_b32 m0, s55
  s_add_u32 s55, s55, 1024
  buffer_load_dwordx4 v9, s[64:67], s71 offen lds
  s_add_u32 s71, s71, 1024
  s_mov_b32 m0, s55
  s_add_u32 s55, s55, 1024
  buffer_load_dwordx4 v9, s[64:67], s71 offen lds
  s_add_u32 s71, s71, 1024
  s_mov_b32 m0, s55
  s_add_u32 s55, s55, 1024
  buffer_load_dwordx4 v9, s[64:67], s71 offen lds
  s_add_u32 s71, s71, 1024
  s_mov_b32 m0, s55
  s_add_u32 s55, s55, 1024
  buffer_load_dwordx4 v9, s[64:67], s71 offen lds
  s_waitcnt vmcnt(8)
  s_barrier
  s_mul_i32 s71, s24, 4096
  s_add_u32 s71, s71, s68
  s_mul_i32 s69, s24, 4096
  s_add_u32 s55, s69, 73728
  s_add_u32 s68, s68, 16384
  s_mov_b32 m0, s55
  s_add_u32 s55, s55, 1024
  buffer_load_dwordx4 v9, s[64:67], s71 offen lds
  s_add_u32 s71, s71, 1024
  s_mov_b32 m0, s55
  s_add_u32 s55, s55, 1024
  buffer_load_dwordx4 v9, s[64:67], s71 offen lds
  s_add_u32 s71, s71, 1024
  s_mov_b32 m0, s55
  s_add_u32 s55, s55, 1024
  buffer_load_dwordx4 v9, s[64:67], s71 offen lds
  s_add_u32 s71, s71, 1024
  s_mov_b32 m0, s55
  s_add_u32 s55, s55, 1024
  buffer_load_dwordx4 v9, s[64:67], s71 offen lds
  s_mul_i32 s71, s24, 4096
  s_add_u32 s71, s71, s68
  s_mul_i32 s69, s24, 4096
  s_add_u32 s55, s69, 90112
  s_add_u32 s68, s68, 16384
  s_mov_b32 m0, s55
  s_add_u32 s55, s55, 1024
  buffer_load_dwordx4 v9, s[64:67], s71 offen lds
  s_add_u32 s71, s71, 1024
  s_mov_b32 m0, s55
  s_add_u32 s55, s55, 1024
  buffer_load_dwordx4 v9, s[64:67], s71 offen lds
  s_add_u32 s71, s71, 1024
  s_mov_b32 m0, s55
  s_add_u32 s55, s55, 1024
  buffer_load_dwordx4 v9, s[64:67], s71 offen lds
  s_add_u32 s71, s71, 1024
  s_mov_b32 m0, s55
  s_add_u32 s55, s55, 1024
  buffer_load_dwordx4 v9, s[64:67], s71 offen lds
  s_waitcnt vmcnt(12)
  s_barrier
  s_lshl_b32 s68, s26, 7
  s_add_u32 s68, s68, 2048
  s_mov_b32 s64, s32
  s_mov_b32 s65, s33
  s_mov_b32 s66, s34
  s_mov_b32 s67, s35
  s_mul_i32 s71, s24, 110592
  s_add_u32 s71, s71, s68
  s_mul_i32 s69, s24, 4096
  s_add_u32 s55, s69, 0
  s_add_u32 s68, s68, 442368
  s_mov_b32 m0, s55
  s_add_u32 s55, s55, 1024
  buffer_load_dwordx4 v8, s[64:67], s71 offen lds
  s_add_u32 s71, s71, 27648
  s_mov_b32 m0, s55
  s_add_u32 s55, s55, 1024
  buffer_load_dwordx4 v8, s[64:67], s71 offen lds
  s_add_u32 s71, s71, 27648
  s_mov_b32 m0, s55
  s_add_u32 s55, s55, 1024
  buffer_load_dwordx4 v8, s[64:67], s71 offen lds
  s_add_u32 s71, s71, 27648
  s_mov_b32 m0, s55
  s_add_u32 s55, s55, 1024
  buffer_load_dwordx4 v8, s[64:67], s71 offen lds
  s_waitcnt vmcnt(12)
  s_barrier
  s_mul_i32 s71, s24, 110592
  s_add_u32 s71, s71, s68
  s_mul_i32 s69, s24, 4096
  s_add_u32 s55, s69, 16384
  s_add_u32 s68, s68, 442368
  s_mov_b32 m0, s55
  s_add_u32 s55, s55, 1024
  buffer_load_dwordx4 v8, s[64:67], s71 offen lds
  s_add_u32 s71, s71, 27648
  s_mov_b32 m0, s55
  s_add_u32 s55, s55, 1024
  buffer_load_dwordx4 v8, s[64:67], s71 offen lds
  s_add_u32 s71, s71, 27648
  s_mov_b32 m0, s55
  s_add_u32 s55, s55, 1024
  buffer_load_dwordx4 v8, s[64:67], s71 offen lds
  s_add_u32 s71, s71, 27648
  s_mov_b32 m0, s55
  s_add_u32 s55, s55, 1024
  buffer_load_dwordx4 v8, s[64:67], s71 offen lds
  s_waitcnt vmcnt(12)
  s_barrier
  s_mul_i32 s71, s24, 110592
  s_add_u32 s71, s71, s68
  s_mul_i32 s69, s24, 4096
  s_add_u32 s55, s69, 32768
  s_add_u32 s68, s68, 442368
  s_mov_b32 m0, s55
  s_add_u32 s55, s55, 1024
  buffer_load_dwordx4 v8, s[64:67], s71 offen lds
  s_add_u32 s71, s71, 27648
  s_mov_b32 m0, s55
  s_add_u32 s55, s55, 1024
  buffer_load_dwordx4 v8, s[64:67], s71 offen lds
  s_add_u32 s71, s71, 27648
  s_mov_b32 m0, s55
  s_add_u32 s55, s55, 1024
  buffer_load_dwordx4 v8, s[64:67], s71 offen lds
  s_add_u32 s71, s71, 27648
  s_mov_b32 m0, s55
  s_add_u32 s55, s55, 1024
  buffer_load_dwordx4 v8, s[64:67], s71 offen lds
  s_waitcnt vmcnt(12)
  s_barrier
  s_mul_i32 s71, s24, 110592
  s_add_u32 s71, s71, s68
  s_mul_i32 s69, s24, 4096
  s_add_u32 s55, s69, 49152
  s_add_u32 s68, s68, 442368
  s_mov_b32 m0, s55
  s_add_u32 s55, s55, 1024
  buffer_load_dwordx4 v8, s[64:67], s71 offen lds
  s_add_u32 s71, s71, 27648
  s_mov_b32 m0, s55
  s_add_u32 s55, s55, 1024
  buffer_load_dwordx4 v8, s[64:67], s71 offen lds
  s_add_u32 s71, s71, 27648
  s_mov_b32 m0, s55
  s_add_u32 s55, s55, 1024
  buffer_load_dwordx4 v8, s[64:67], s71 offen lds
  s_add_u32 s71, s71, 27648
  s_mov_b32 m0, s55
  s_add_u32 s55, s55, 1024
  buffer_load_dwordx4 v8, s[64:67], s71 offen lds
  s_waitcnt vmcnt(12)
  s_barrier
  s_cmp_lg_u32 s24, 0
  s_cbranch_scc1 Lka_20
  s_mov_b32 s4, 0
  s_mov_b32 s5, 3
  s_mov_b32 s6, 1
  s_mov_b32 s7, 2
  s_mov_b32 s8, 20
  s_branch Lkae_19
Lka_20:
  s_cmp_lg_u32 s24, 1
  s_cbranch_scc1 Lka_21
  s_mov_b32 s4, 0
  s_mov_b32 s5, 4
  s_mov_b32 s6, 2
  s_mov_b32 s7, 4
  s_mov_b32 s8, 20
  s_branch Lkae_19
Lka_21:
  s_cmp_lg_u32 s24, 2
  s_cbranch_scc1 Lka_22
  s_mov_b32 s4, 1
  s_mov_b32 s5, 3
  s_mov_b32 s6, 2
  s_mov_b32 s7, 2
  s_mov_b32 s8, 20
  s_branch Lkae_19
Lka_22:
  s_mov_b32 s4, 1
  s_mov_b32 s5, 4
  s_mov_b32 s6, 1
  s_mov_b32 s7, 4
  s_mov_b32 s8, 0
Lkae_19:
  s_sub_u32 s80, s5, 3
  s_lshl_b32 s80, s80, 5
  s_cmp_eq_u32 s5, 2
  s_cselect_b32 s80, 48, s80
  v_add_u32 v192, s80, v24
  v_mul_u32_u24 v193, 205, v192
  v_lshrrev_b32 v193, 12, v193
  v_mul_u32_u24 v196, 20, v193
  s_lshl_b32 s81, s4, 5
  v_lshlrev_b32 v194, 2, v23
  v_add_u32 v194, s81, v194
  v_sub_u32 v194, v194, v196
  v_mul_u32_u24 v195, 80, v192
  v_lshlrev_b32 v196, 2, v194
  v_add_u32 v195, v195, v196
  v_add_u32 v195, 155648, v195
  s_cmp_eq_u32 s5, 2
  s_cselect_b32 s82, 16, 0
  v_cmp_gt_u32 vcc, s82, v24
  v_mov_b32 v196, 0x1000
  s_lshl_b32 s81, s4, 13
  s_add_u32 s81, s81, 114688
  v_cndmask_b32 v194, v194, v196, vcc
  v_add_u32 v197, s81, v14
  s_lshl_b32 s81, s5, 13
  s_add_u32 s81, s81, 114688
  v_add_u32 v198, s81, v14
  v_add_u32 v196, 0, v194
  v_cmp_gt_u32 s[84:85], 20, v196
  v_add_u32 v196, 8, v194
  v_cmp_gt_u32 s[86:87], 20, v196
  v_add_u32 v196, 16, v194
  v_cmp_gt_u32 s[88:89], 20, v196
  v_add_u32 v196, 24, v194
  v_cmp_gt_u32 s[90:91], 20, v196
  s_sub_u32 s80, s7, 3
  s_lshl_b32 s80, s80, 5
  s_cmp_eq_u32 s7, 2
  s_cselect_b32 s80, 48, s80
  v_add_u32 v200, s80, v24
  v_mul_u32_u24 v201, 205, v200
  v_lshrrev_b32 v201, 12, v201
  v_mul_u32_u24 v204, 20, v201
  s_lshl_b32 s81, s6, 5
  v_lshlrev_b32 v202, 2, v23
  v_add_u32 v202, s81, v202
  v_sub_u32 v202, v202, v204
  v_mul_u32_u24 v203, 80, v200
  v_lshlrev_b32 v204, 2, v202
  v_add_u32 v203, v203, v204
  v_add_u32 v203, 155648, v203
  s_cmp_eq_u32 s7, 2
  s_cselect_b32 s82, 16, 0
  v_cmp_gt_u32 vcc, s82, v24
  v_mov_b32 v204, 0x1000
  s_lshl_b32 s81, s6, 13
  s_add_u32 s81, s81, 114688
  v_cndmask_b32 v202, v202, v204, vcc
  v_add_u32 v205, s81, v14
  s_lshl_b32 s81, s7, 13
  s_add_u32 s81, s81, 114688
  v_add_u32 v206, s81, v14
  v_add_u32 v204, 0, v202
  v_cmp_gt_u32 s[56:57], s8, v204
  v_add_u32 v204, 8, v202
  v_cmp_gt_u32 s[58:59], s8, v204
  v_add_u32 v204, 16, v202
  v_cmp_gt_u32 s[60:61], s8, v204
  v_add_u32 v204, 24, v202
  v_cmp_gt_u32 s[62:63], s8, v204
  s_mul_i32 s71, s24, 110592
  s_add_u32 s71, s71, s68
  s_mul_i32 s69, s24, 4096
  s_add_u32 s55, s69, 65536
  s_add_u32 s68, s68, 442368
  s_mov_b32 m0, s55
  s_add_u32 s55, s55, 1024
  buffer_load_dwordx4 v8, s[64:67], s71 offen lds
  s_add_u32 s71, s71, 27648
  s_barrier
  ds_read_b128 v[64:67], v197 offset:0
  ds_read_b128 v[68:71], v198 offset:0
  ds_read_b128 v[72:75], v197 offset:4096
  ds_read_b128 v[76:79], v198 offset:4096
  ds_read_b128 v[80:83], v197 offset:1024
  ds_read_b128 v[84:87], v198 offset:1024
  ds_read_b128 v[88:91], v197 offset:5120
  ds_read_b128 v[92:95], v198 offset:5120
  ds_read_b128 v[96:99], v197 offset:2048
  ds_read_b128 v[100:103], v198 offset:2048
  ds_read_b128 v[104:107], v197 offset:6144
  ds_read_b128 v[108:111], v198 offset:6144
  ds_read_b128 v[112:115], v197 offset:3072
  ds_read_b128 v[116:119], v198 offset:3072
  ds_read_b128 v[120:123], v197 offset:7168
  ds_read_b128 v[124:127], v198 offset:7168
  s_waitcnt lgkmcnt(14)
  v_mfma_f32_32x32x16_bf16 v[208:223], v[64:67], v[68:71], 0
  s_waitcnt lgkmcnt(12)
  v_mfma_f32_32x32x16_bf16 v[208:223], v[72:75], v[76:79], v[208:223]
  s_waitcnt lgkmcnt(10)
  v_mfma_f32_32x32x16_bf16 v[208:223], v[80:83], v[84:87], v[208:223]
  s_waitcnt lgkmcnt(8)
  v_mfma_f32_32x32x16_bf16 v[208:223], v[88:91], v[92:95], v[208:223]
  s_waitcnt lgkmcnt(6)
  v_mfma_f32_32x32x16_bf16 v[208:223], v[96:99], v[100:103], v[208:223]
  s_waitcnt lgkmcnt(4)
  v_mfma_f32_32x32x16_bf16 v[208:223], v[104:107], v[108:111], v[208:223]
  s_waitcnt lgkmcnt(2)
  v_mfma_f32_32x32x16_bf16 v[208:223], v[112:115], v[116:119], v[208:223]
  s_waitcnt lgkmcnt(0)
  v_mfma_f32_32x32x16_bf16 v[208:223], v[120:123], v[124:127], v[208:223]
  s_mov_b32 m0, s55
  s_add_u32 s55, s55, 1024
  buffer_load_dwordx4 v8, s[64:67], s71 offen lds
  s_add_u32 s71, s71, 27648
  s_mov_b32 m0, s55
  s_add_u32 s55, s55, 1024
  buffer_load_dwordx4 v8, s[64:67], s71 offen lds
  s_add_u32 s71, s71, 27648
  s_mov_b32 m0, s55
  s_add_u32 s55, s55, 1024
  buffer_load_dwordx4 v8, s[64:67], s71 offen lds
  s_waitcnt vmcnt(12)
  s_barrier
  ds_read_b128 v[64:67], v205 offset:0
  ds_read_b128 v[68:71], v206 offset:0
  ds_read_b128 v[72:75], v205 offset:4096
  ds_read_b128 v[76:79], v206 offset:4096
  ds_read_b128 v[80:83], v205 offset:1024
  ds_read_b128 v[84:87], v206 offset:1024
  ds_read_b128 v[88:91], v205 offset:5120
  ds_read_b128 v[92:95], v206 offset:5120
  ds_read_b128 v[96:99], v205 offset:2048
  ds_read_b128 v[100:103], v206 offset:2048
  ds_read_b128 v[104:107], v205 offset:6144
  ds_read_b128 v[108:111], v206 offset:6144
  ds_read_b128 v[112:115], v205 offset:3072
  ds_read_b128 v[116:119], v206 offset:3072
  ds_read_b128 v[120:123], v205 offset:7168
  ds_read_b128 v[124:127], v206 offset:7168
  s_waitcnt lgkmcnt(14)
  v_mfma_f32_32x32x16_bf16 v[224:239], v[64:67], v[68:71], 0
  s_waitcnt lgkmcnt(12)
  v_mfma_f32_32x32x16_bf16 v[224:239], v[72:75], v[76:79], v[224:239]
  s_waitcnt lgkmcnt(10)
  v_mfma_f32_32x32x16_bf16 v[224:239], v[80:83], v[84:87], v[224:239]
  s_waitcnt lgkmcnt(8)
  v_mfma_f32_32x32x16_bf16 v[224:239], v[88:91], v[92:95], v[224:239]
  s_waitcnt lgkmcnt(6)
  v_mfma_f32_32x32x16_bf16 v[224:239], v[96:99], v[100:103], v[224:239]
  s_waitcnt lgkmcnt(4)
  v_mfma_f32_32x32x16_bf16 v[224:239], v[104:107], v[108:111], v[224:239]
  s_waitcnt lgkmcnt(2)
  v_mfma_f32_32x32x16_bf16 v[224:239], v[112:115], v[116:119], v[224:239]
  s_waitcnt lgkmcnt(0)
  v_mfma_f32_32x32x16_bf16 v[224:239], v[120:123], v[124:127], v[224:239]
  s_lshl_b32 s68, s26, 7
  s_add_u32 s68, s68, 2048
  s_mov_b32 s64, s36
  s_mov_b32 s65, s37
  s_mov_b32 s66, s38
  s_mov_b32 s67, s39
  s_mul_i32 s71, s24, 110592
  s_add_u32 s71, s71, s68
  s_mul_i32 s69, s24, 4096
  s_add_u32 s55, s69, 81920
  s_add_u32 s68, s68, 442368
  s_mov_b32 m0, s55
  s_add_u32 s55, s55, 1024
  buffer_load_dwordx4 v8, s[64:67], s71 offen lds
  s_add_u32 s71, s71, 27648
  s_cmp_lg_u32 s24, 3
  s_cbranch_scc1 Lkz_24
  v_lshlrev_b32 v184, 2, v15
  v_add_u32 v185, 162816, v184
  v_add_u32 v186, 162368, v184
  ds_read_b32 v187, v185 offset:0
  ds_read_b32 v188, v185 offset:256
  ds_read_b32 v189, v185 offset:512
  ds_read_b32 v190, v185 offset:768
  ds_read_b32 v176, v186 offset:0
  ds_read_b32 v177, v186 offset:64
  ds_read_b32 v178, v186 offset:128
  ds_read_b32 v179, v186 offset:192
  s_waitcnt lgkmcnt(0)
  v_add_f32 v187, v187, v188
  v_add_f32 v189, v189, v190
  v_add_f32 v187, v187, v189
  v_add_f32 v176, v176, v177
  v_add_f32 v178, v178, v179
  v_add_f32 v176, v176, v178
  v_add_u32 v185, 162048, v184
  ds_write_b32 v185, v187
  s_mov_b64 exec, 0xffff
  ds_write_b32 v185, v176 offset:256
  s_mov_b64 exec, -1
Lkz_24:
  s_nop 7
  s_nop 7
  s_mov_b64 exec, s[84:85]
  ds_write_b128 v195, v[208:211] offset:0
  s_mov_b64 exec, s[86:87]
  ds_write_b128 v195, v[212:215] offset:32
  s_mov_b64 exec, s[88:89]
  ds_write_b128 v195, v[216:219] offset:64
  s_mov_b64 exec, s[90:91]
  ds_write_b128 v195, v[220:223] offset:96
  s_mov_b64 exec, -1
  s_mov_b64 exec, s[56:57]
  ds_write_b128 v203, v[224:227] offset:0
  s_mov_b64 exec, s[58:59]
  ds_write_b128 v203, v[228:231] offset:32
  s_mov_b64 exec, s[60:61]
  ds_write_b128 v203, v[232:235] offset:64
  s_mov_b64 exec, s[62:63]
  ds_write_b128 v203, v[236:239] offset:96
  s_mov_b64 exec, -1
  s_waitcnt lgkmcnt(0)
  s_mov_b32 m0, s55
  s_add_u32 s55, s55, 1024
  buffer_load_dwordx4 v8, s[64:67], s71 offen lds
  s_add_u32 s71, s71, 27648
  s_mov_b32 m0, s55
  s_add_u32 s55, s55, 1024
  buffer_load_dwordx4 v8, s[64:67], s71 offen lds
  s_add_u32 s71, s71, 27648
  s_mov_b32 m0, s55
  s_add_u32 s55, s55, 1024
  buffer_load_dwordx4 v8, s[64:67], s71 offen lds
  s_mul_i32 s71, s24, 110592
  s_add_u32 s71, s71, s68
  s_mul_i32 s69, s24, 4096
  s_add_u32 s55, s69, 98304
  s_add_u32 s68, s68, 442368
  s_mov_b32 m0, s55
  s_add_u32 s55, s55, 1024
  buffer_load_dwordx4 v8, s[64:67], s71 offen lds
  s_add_u32 s71, s71, 27648
  s_mov_b32 m0, s55
  s_add_u32 s55, s55, 1024
  buffer_load_dwordx4 v8, s[64:67], s71 offen lds
  s_add_u32 s71, s71, 27648
  s_mov_b32 m0, s55
  s_add_u32 s55, s55, 1024
  buffer_load_dwordx4 v8, s[64:67], s71 offen lds
  s_add_u32 s71, s71, 27648
  s_mov_b32 m0, s55
  s_add_u32 s55, s55, 1024
  buffer_load_dwordx4 v8, s[64:67], s71 offen lds
  s_waitcnt vmcnt(16)
  s_barrier
  s_lshl_b32 s80, s24, 8
  v_lshlrev_b32 v25, 2, v15
  v_add_u32 v25, s80, v25
  v_add_u32 v26, 155648, v25
  ds_read_b32 v128, v26 offset:0
  ds_read_b32 v129, v26 offset:1024
  ds_read_b32 v130, v26 offset:2048
  ds_read_b32 v131, v26 offset:3072
  ds_read_b32 v132, v26 offset:4096
  ds_read_b32 v133, v26 offset:5120
  ds_read_b32 v134, v26 offset:6144
  s_waitcnt lgkmcnt(0)
  s_and_b32 s80, s25, 3
  s_lshl_b32 s80, s80, 13
  buffer_atomic_add_f32 v128, v25, s[48:51], s80 offen
  s_add_u32 s80, s80, 1024
  buffer_atomic_add_f32 v129, v25, s[48:51], s80 offen
  s_add_u32 s80, s80, 1024
  buffer_atomic_add_f32 v130, v25, s[48:51], s80 offen
  s_add_u32 s80, s80, 1024
  buffer_atomic_add_f32 v131, v25, s[48:51], s80 offen
  s_add_u32 s80, s80, 1024
  buffer_atomic_add_f32 v132, v25, s[48:51], s80 offen
  s_add_u32 s80, s80, 1024
  buffer_atomic_add_f32 v133, v25, s[48:51], s80 offen
  s_add_u32 s80, s80, 1024
  buffer_atomic_add_f32 v134, v25, s[48:51], s80 offen
  s_mul_i32 s71, s24, 110592
  s_add_u32 s71, s71, s68
  s_mul_i32 s69, s24, 4096
  s_add_u32 s55, s69, 0
  s_add_u32 s68, s68, 442368
  s_mov_b32 m0, s55
  s_add_u32 s55, s55, 1024
  buffer_load_dwordx4 v8, s[64:67], s71 offen lds
  s_add_u32 s71, s71, 27648
  s_mov_b32 m0, s55
  s_add_u32 s55, s55, 1024
  buffer_load_dwordx4 v8, s[64:67], s71 offen lds
  s_add_u32 s71, s71, 27648
  s_mov_b32 m0, s55
  s_add_u32 s55, s55, 1024
  buffer_load_dwordx4 v8, s[64:67], s71 offen lds
  s_add_u32 s71, s71, 27648
  s_mov_b32 m0, s55
  s_add_u32 s55, s55, 1024
  buffer_load_dwordx4 v8, s[64:67], s71 offen lds
  s_waitcnt vmcnt(23)
  s_barrier
  s_waitcnt vmcnt(4)
  s_mul_i32 s71, s24, 110592
  s_add_u32 s71, s71, s68
  s_mul_i32 s69, s24, 4096
  s_add_u32 s55, s69, 16384
  s_add_u32 s68, s68, 442368
  s_mov_b32 m0, s55
  s_add_u32 s55, s55, 1024
  buffer_load_dwordx4 v8, s[64:67], s71 offen lds
  s_add_u32 s71, s71, 27648
  s_mov_b32 m0, s55
  s_add_u32 s55, s55, 1024
  buffer_load_dwordx4 v8, s[64:67], s71 offen lds
  s_add_u32 s71, s71, 27648
  s_mov_b32 m0, s55
  s_add_u32 s55, s55, 1024
  buffer_load_dwordx4 v8, s[64:67], s71 offen lds
  s_add_u32 s71, s71, 27648
  s_mov_b32 m0, s55
  s_add_u32 s55, s55, 1024
  buffer_load_dwordx4 v8, s[64:67], s71 offen lds
  s_waitcnt vmcnt(23)
  s_barrier
  s_cmp_lg_u32 s24, 0
  s_cbranch_scc1 Lkd_25
  s_lshl_b32 s80, s26, 11
  s_lshl_b32 s81, s25, 7
  s_add_u32 s80, s80, s81
  v_mov_b32 v25, s80
  v_mov_b32 v26, 1
  s_mov_b64 exec, 1
  buffer_store_dword v26, v25, s[92:95], 0 offen sc1
  s_mov_b64 exec, -1
Lkd_25:
  s_mul_i32 s71, s24, 110592
  s_add_u32 s71, s71, s68
  s_mul_i32 s69, s24, 4096
  s_add_u32 s55, s69, 32768
  s_add_u32 s68, s68, 442368
  s_mov_b32 m0, s55
  s_add_u32 s55, s55, 1024
  buffer_load_dwordx4 v8, s[64:67], s71 offen lds
  s_add_u32 s71, s71, 27648
  s_mov_b32 m0, s55
  s_add_u32 s55, s55, 1024
  buffer_load_dwordx4 v8, s[64:67], s71 offen lds
  s_add_u32 s71, s71, 27648
  s_mov_b32 m0, s55
  s_add_u32 s55, s55, 1024
  buffer_load_dwordx4 v8, s[64:67], s71 offen lds
  s_add_u32 s71, s71, 27648
  s_mov_b32 m0, s55
  s_add_u32 s55, s55, 1024
  buffer_load_dwordx4 v8, s[64:67], s71 offen lds
  s_waitcnt vmcnt(23)
  s_barrier
  s_lshl_b32 s68, s26, 6
  s_add_u32 s68, s68, 3072
  s_mov_b32 s64, s32
  s_mov_b32 s65, s33
  s_mov_b32 s66, s34
  s_mov_b32 s67, s35
  s_mul_i32 s71, s24, 110592
  s_add_u32 s71, s71, s68
  s_mul_i32 s69, s24, 4096
  s_add_u32 s55, s69, 49152
  s_add_u32 s68, s68, 442368
  s_mov_b32 m0, s55
  s_add_u32 s55, s55, 1024
  s_mov_b64 exec, s[76:77]
  buffer_load_dwordx4 v10, s[32:35], s71 offen lds
  s_mov_b64 exec, s[78:79]
  buffer_load_dwordx4 v10, s[36:39], s71 offen lds
  s_mov_b64 exec, -1
  s_add_u32 s71, s71, 27648
  s_mov_b32 m0, s55
  s_add_u32 s55, s55, 1024
  s_mov_b64 exec, s[76:77]
  buffer_load_dwordx4 v10, s[32:35], s71 offen lds
  s_mov_b64 exec, s[78:79]
  buffer_load_dwordx4 v10, s[36:39], s71 offen lds
  s_mov_b64 exec, -1
  s_add_u32 s71, s71, 27648
  s_mov_b32 m0, s55
  s_add_u32 s55, s55, 1024
  s_mov_b64 exec, s[76:77]
  buffer_load_dwordx4 v10, s[32:35], s71 offen lds
  s_mov_b64 exec, s[78:79]
  buffer_load_dwordx4 v10, s[36:39], s71 offen lds
  s_mov_b64 exec, -1
  s_add_u32 s71, s71, 27648
  s_mov_b32 m0, s55
  s_add_u32 s55, s55, 1024
  s_mov_b64 exec, s[76:77]
  buffer_load_dwordx4 v10, s[32:35], s71 offen lds
  s_mov_b64 exec, s[78:79]
  buffer_load_dwordx4 v10, s[36:39], s71 offen lds
  s_mov_b64 exec, -1
  s_waitcnt vmcnt(27)
  s_barrier
  s_mul_i32 s71, s24, 110592
  s_add_u32 s71, s71, s68
  s_mul_i32 s69, s24, 4096
  s_add_u32 s55, s69, 65536
  s_add_u32 s68, s68, 442368
  s_mov_b32 m0, s55
  s_add_u32 s55, s55, 1024
  s_mov_b64 exec, s[76:77]
  buffer_load_dwordx4 v10, s[32:35], s71 offen lds
  s_mov_b64 exec, s[78:79]
  buffer_load_dwordx4 v10, s[36:39], s71 offen lds
  s_mov_b64 exec, -1
  s_add_u32 s71, s71, 27648
  s_mov_b32 m0, s55
  s_add_u32 s55, s55, 1024
  s_mov_b64 exec, s[76:77]
  buffer_load_dwordx4 v10, s[32:35], s71 offen lds
  s_mov_b64 exec, s[78:79]
  buffer_load_dwordx4 v10, s[36:39], s71 offen lds
  s_mov_b64 exec, -1
  s_add_u32 s71, s71, 27648
  s_mov_b32 m0, s55
  s_add_u32 s55, s55, 1024
  s_mov_b64 exec, s[76:77]
  buffer_load_dwordx4 v10, s[32:35], s71 offen lds
  s_mov_b64 exec, s[78:79]
  buffer_load_dwordx4 v10, s[36:39], s71 offen lds
  s_mov_b64 exec, -1
  s_add_u32 s71, s71, 27648
  s_mov_b32 m0, s55
  s_add_u32 s55, s55, 1024
  s_mov_b64 exec, s[76:77]
  buffer_load_dwordx4 v10, s[32:35], s71 offen lds
  s_mov_b64 exec, s[78:79]
  buffer_load_dwordx4 v10, s[36:39], s71 offen lds
  s_mov_b64 exec, -1
  s_waitcnt vmcnt(24)
  s_barrier
  s_mul_i32 s71, s24, 110592
  s_add_u32 s71, s71, s68
  s_mul_i32 s69, s24, 4096
  s_add_u32 s55, s69, 81920
  s_add_u32 s68, s68, 442368
  s_mov_b32 m0, s55
  s_add_u32 s55, s55, 1024
  s_mov_b64 exec, s[76:77]
  buffer_load_dwordx4 v10, s[32:35], s71 offen lds
  s_mov_b64 exec, s[78:79]
  buffer_load_dwordx4 v10, s[36:39], s71 offen lds
  s_mov_b64 exec, -1
  s_add_u32 s71, s71, 27648
  s_mov_b32 m0, s55
  s_add_u32 s55, s55, 1024
  s_mov_b64 exec, s[76:77]
  buffer_load_dwordx4 v10, s[32:35], s71 offen lds
  s_mov_b64 exec, s[78:79]
  buffer_load_dwordx4 v10, s[36:39], s71 offen lds
  s_mov_b64 exec, -1
  s_add_u32 s71, s71, 27648
  s_mov_b32 m0, s55
  s_add_u32 s55, s55, 1024
  s_mov_b64 exec, s[76:77]
  buffer_load_dwordx4 v10, s[32:35], s71 offen lds
  s_mov_b64 exec, s[78:79]
  buffer_load_dwordx4 v10, s[36:39], s71 offen lds
  s_mov_b64 exec, -1
  s_add_u32 s71, s71, 27648
  s_mov_b32 m0, s55
  s_add_u32 s55, s55, 1024
  s_mov_b64 exec, s[76:77]
  buffer_load_dwordx4 v10, s[32:35], s71 offen lds
  s_mov_b64 exec, s[78:79]
  buffer_load_dwordx4 v10, s[36:39], s71 offen lds
  s_mov_b64 exec, -1
  s_waitcnt vmcnt(28)
  s_barrier
  s_mul_i32 s71, s24, 110592
  s_add_u32 s71, s71, s68
  s_mul_i32 s69, s24, 4096
  s_add_u32 s55, s69, 98304
  s_add_u32 s68, s68, 442368
  s_mov_b32 m0, s55
  s_add_u32 s55, s55, 1024
  s_mov_b64 exec, s[76:77]
  buffer_load_dwordx4 v10, s[32:35], s71 offen lds
  s_mov_b64 exec, s[78:79]
  buffer_load_dwordx4 v10, s[36:39], s71 offen lds
  s_mov_b64 exec, -1
  s_add_u32 s71, s71, 27648
  s_mov_b32 m0, s55
  s_add_u32 s55, s55, 1024
  s_mov_b64 exec, s[76:77]
  buffer_load_dwordx4 v10, s[32:35], s71 offen lds
  s_mov_b64 exec, s[78:79]
  buffer_load_dwordx4 v10, s[36:39], s71 offen lds
  s_mov_b64 exec, -1
  s_add_u32 s71, s71, 27648
  s_mov_b32 m0, s55
  s_add_u32 s55, s55, 1024
  s_mov_b64 exec, s[76:77]
  buffer_load_dwordx4 v10, s[32:35], s71 offen lds
  s_mov_b64 exec, s[78:79]
  buffer_load_dwordx4 v10, s[36:39], s71 offen lds
  s_mov_b64 exec, -1
  s_add_u32 s71, s71, 27648
  s_mov_b32 m0, s55
  s_add_u32 s55, s55, 1024
  s_mov_b64 exec, s[76:77]
  buffer_load_dwordx4 v10, s[32:35], s71 offen lds
  s_mov_b64 exec, s[78:79]
  buffer_load_dwordx4 v10, s[36:39], s71 offen lds
  s_mov_b64 exec, -1
  s_waitcnt vmcnt(32)
  s_barrier
  s_mul_i32 s71, s24, 110592
  s_add_u32 s71, s71, s68
  s_mul_i32 s69, s24, 4096
  s_add_u32 s55, s69, 0
  s_add_u32 s68, s68, 442368
  s_mov_b32 m0, s55
  s_add_u32 s55, s55, 1024
  s_mov_b64 exec, s[76:77]
  buffer_load_dwordx4 v10, s[32:35], s71 offen lds
  s_mov_b64 exec, s[78:79]
  buffer_load_dwordx4 v10, s[36:39], s71 offen lds
  s_mov_b64 exec, -1
  s_add_u32 s71, s71, 27648
  s_mov_b32 m0, s55
  s_add_u32 s55, s55, 1024
  s_mov_b64 exec, s[76:77]
  buffer_load_dwordx4 v10, s[32:35], s71 offen lds
  s_mov_b64 exec, s[78:79]
  buffer_load_dwordx4 v10, s[36:39], s71 offen lds
  s_mov_b64 exec, -1
  s_add_u32 s71, s71, 27648
  s_mov_b32 m0, s55
  s_add_u32 s55, s55, 1024
  s_mov_b64 exec, s[76:77]
  buffer_load_dwordx4 v10, s[32:35], s71 offen lds
  s_mov_b64 exec, s[78:79]
  buffer_load_dwordx4 v10, s[36:39], s71 offen lds
  s_mov_b64 exec, -1
  s_add_u32 s71, s71, 27648
  s_mov_b32 m0, s55
  s_add_u32 s55, s55, 1024
  s_mov_b64 exec, s[76:77]
  buffer_load_dwordx4 v10, s[32:35], s71 offen lds
  s_mov_b64 exec, s[78:79]
  buffer_load_dwordx4 v10, s[36:39], s71 offen lds
  s_mov_b64 exec, -1
  s_waitcnt vmcnt(32)
  s_barrier
  s_waitcnt vmcnt(24)
  s_barrier
  s_waitcnt vmcnt(16)
  s_barrier
  s_waitcnt vmcnt(8)
  s_barrier
  s_waitcnt vmcnt(0)
  s_barrier
  s_endpgm
front_kernel_end:
  s_endpgm
.section .rodata,"a"
.p2align 6
.amdhsa_kernel front_kernel
  .amdhsa_next_free_vgpr 256
  .amdhsa_next_free_sgpr 102
  .amdhsa_accum_offset 256
  .amdhsa_group_segment_fixed_size 0
  .amdhsa_kernarg_size 80
  .amdhsa_user_sgpr_count 2
  .amdhsa_user_sgpr_kernarg_segment_ptr 1
  .amdhsa_system_sgpr_workgroup_id_x 1
.end_amdhsa_kernel
.text
.globl final_kernel
.p2align 8
.type final_kernel,@function
final_kernel:

  s_cmp_ge_u32 s2, 256
  s_cbranch_scc1 final_kernel_end
  s_load_dwordx2 s[4:5], s[0:1], 0
  s_load_dwordx2 s[6:7], s[0:1], 56
  s_load_dwordx2 s[8:9], s[0:1], 72
  v_and_b32 v1, 63, v0
  v_lshrrev_b32 v2, 6, v0
  v_and_b32 v3, 15, v1
  v_readfirstlane_b32 s20, v2
  v_lshrrev_b32 v4, 4, v1
  s_and_b32 s21, s2, 7
  s_lshr_b32 s22, s2, 3
  s_lshr_b32 s23, s21, 1
  s_lshl_b32 s23, s23, 3
  s_lshr_b32 s24, s22, 2
  s_add_u32 s23, s23, s24
  s_and_b32 s24, s21, 1
  s_lshl_b32 s24, s24, 2
  s_and_b32 s25, s22, 3
  s_add_u32 s24, s24, s25
  v_lshrrev_b32 v5, 1, v4
  v_lshlrev_b32 v5, 10, v5
  v_and_b32 v6, 1, v4
  v_lshlrev_b32 v6, 9, v6
  v_add_u32 v5, v5, v6
  v_lshlrev_b32 v6, 4, v3
  v_add_u32 v5, v5, v6
  v_lshlrev_b32 v6, 4, v1
  v_add_u32 v7, 0x1000, v6
  s_mul_i32 s26, s23, 303104
  s_lshl_b32 s29, s20, 11
  s_add_u32 s26, s26, s29
  s_add_u32 s27, s26, 151552
  s_mul_i32 s28, s24, 5120
  s_mul_i32 s29, s20, 40960
  s_add_u32 s28, s28, s29
  v_add_u32 v14, 0, v0
  v_mul_u32_u24 v15, 205, v14
  v_lshrrev_b32 v15, 11, v15
  v_mul_u32_u24 v16, 10, v15
  v_sub_u32 v16, v14, v16
  v_mul_u32_u24 v17, 336, v15
  v_lshlrev_b32 v18, 5, v16
  v_add_u32 v11, v17, v18
  v_mul_u32_u24 v17, 1280, v15
  v_lshlrev_b32 v18, 4, v16
  v_add_u32 v8, v17, v18
  v_add_u32 v14, 256, v0
  v_mul_u32_u24 v15, 205, v14
  v_lshrrev_b32 v15, 11, v15
  v_mul_u32_u24 v16, 10, v15
  v_sub_u32 v16, v14, v16
  v_mul_u32_u24 v17, 336, v15
  v_lshlrev_b32 v18, 5, v16
  v_add_u32 v12, v17, v18
  v_mul_u32_u24 v17, 1280, v15
  v_lshlrev_b32 v18, 4, v16
  v_add_u32 v9, v17, v18
  v_add_u32 v14, 512, v0
  v_mul_u32_u24 v15, 205, v14
  v_lshrrev_b32 v15, 11, v15
  v_mul_u32_u24 v16, 10, v15
  v_sub_u32 v16, v14, v16
  v_mul_u32_u24 v17, 336, v15
  v_lshlrev_b32 v18, 5, v16
  v_add_u32 v13, v17, v18
  v_mul_u32_u24 v17, 1280, v15
  v_lshlrev_b32 v18, 4, v16
  v_add_u32 v10, v17, v18
  s_mul_i32 s30, s23, 81920
  s_mul_i32 s31, s24, 160
  s_add_u32 s30, s30, s31
  s_waitcnt lgkmcnt(0)
  s_mov_b32 s32, s8
  s_mov_b32 s33, s9
  s_mov_b32 s34, 9699328
  s_mov_b32 s35, 0x00020000
  s_add_u32 s36, s8, 10485760
  s_addc_u32 s37, s9, 0
  s_mov_b32 s38, 3031040
  s_mov_b32 s39, 0x00020000
  s_mov_b32 s40, s4
  s_mov_b32 s41, s5
  s_mov_b32 s42, 2621440
  s_mov_b32 s43, 0x00020000
  s_mov_b32 s44, s6
  s_mov_b32 s45, s7
  s_mov_b32 s46, 2621440
  s_mov_b32 s47, 0x00020000
  buffer_load_dwordx4 v[32:35], v6, s[36:39], s28 offen offset:0
  buffer_load_dwordx4 v[36:39], v6, s[36:39], s28 offen offset:1024
  buffer_load_dwordx4 v[40:43], v6, s[36:39], s28 offen offset:2048
  buffer_load_dwordx4 v[44:47], v6, s[36:39], s28 offen offset:3072
  buffer_load_dwordx4 v[52:55], v5, s[32:35], s26 offen offset:0
  buffer_load_dwordx4 v[56:59], v5, s[32:35], s26 offen offset:256
  buffer_load_dwordx4 v[60:63], v5, s[32:35], s27 offen offset:0
  buffer_load_dwordx4 v[64:67], v5, s[32:35], s27 offen offset:256
  buffer_load_dwordx4 v[48:51], v7, s[36:39], s28 offen
  s_add_u32 s26, s26, 8192
  s_add_u32 s27, s27, 8192
  s_add_u32 s28, s28, 163840
  buffer_load_dwordx4 v[68:71], v6, s[36:39], s28 offen offset:0
  buffer_load_dwordx4 v[72:75], v6, s[36:39], s28 offen offset:1024
  buffer_load_dwordx4 v[76:79], v6, s[36:39], s28 offen offset:2048
  buffer_load_dwordx4 v[80:83], v6, s[36:39], s28 offen offset:3072
  buffer_load_dwordx4 v[88:91], v5, s[32:35], s26 offen offset:0
  buffer_load_dwordx4 v[92:95], v5, s[32:35], s26 offen offset:256
  buffer_load_dwordx4 v[96:99], v5, s[32:35], s27 offen offset:0
  buffer_load_dwordx4 v[100:103], v5, s[32:35], s27 offen offset:256
  buffer_load_dwordx4 v[84:87], v7, s[36:39], s28 offen
  s_add_u32 s26, s26, 8192
  s_add_u32 s27, s27, 8192
  s_add_u32 s28, s28, 163840
  buffer_load_dwordx4 v[104:107], v6, s[36:39], s28 offen offset:0
  buffer_load_dwordx4 v[108:111], v6, s[36:39], s28 offen offset:1024
  buffer_load_dwordx4 v[112:115], v6, s[36:39], s28 offen offset:2048
  buffer_load_dwordx4 v[116:119], v6, s[36:39], s28 offen offset:3072
  buffer_load_dwordx4 v[124:127], v5, s[32:35], s26 offen offset:0
  buffer_load_dwordx4 v[128:131], v5, s[32:35], s26 offen offset:256
  buffer_load_dwordx4 v[132:135], v5, s[32:35], s27 offen offset:0
  buffer_load_dwordx4 v[136:139], v5, s[32:35], s27 offen offset:256
  buffer_load_dwordx4 v[120:123], v7, s[36:39], s28 offen
  s_add_u32 s26, s26, 8192
  s_add_u32 s27, s27, 8192
  s_add_u32 s28, s28, 163840
  v_cmp_gt_u32 vcc, 128, v0
  v_mov_b32 v14, 0x7fffff00
  s_nop 1
  v_cndmask_b32 v10, v14, v10, vcc
  buffer_load_dwordx4 v[20:23], v8, s[40:43], s30 offen
  buffer_load_dwordx4 v[24:27], v9, s[40:43], s30 offen
  buffer_load_dwordx4 v[28:31], v10, s[40:43], s30 offen
  v_accvgpr_write_b32 a0, 0
  v_accvgpr_write_b32 a1, 0
  v_accvgpr_write_b32 a2, 0
  v_accvgpr_write_b32 a3, 0
  v_accvgpr_write_b32 a4, 0
  v_accvgpr_write_b32 a5, 0
  v_accvgpr_write_b32 a6, 0
  v_accvgpr_write_b32 a7, 0
  v_accvgpr_write_b32 a8, 0
  v_accvgpr_write_b32 a9, 0
  v_accvgpr_write_b32 a10, 0
  v_accvgpr_write_b32 a11, 0
  v_accvgpr_write_b32 a12, 0
  v_accvgpr_write_b32 a13, 0
  v_accvgpr_write_b32 a14, 0
  v_accvgpr_write_b32 a15, 0
  v_accvgpr_write_b32 a16, 0
  v_accvgpr_write_b32 a17, 0
  v_accvgpr_write_b32 a18, 0
  v_accvgpr_write_b32 a19, 0
  v_accvgpr_write_b32 a20, 0
  v_accvgpr_write_b32 a21, 0
  v_accvgpr_write_b32 a22, 0
  v_accvgpr_write_b32 a23, 0
  v_accvgpr_write_b32 a24, 0
  v_accvgpr_write_b32 a25, 0
  v_accvgpr_write_b32 a26, 0
  v_accvgpr_write_b32 a27, 0
  v_accvgpr_write_b32 a28, 0
  v_accvgpr_write_b32 a29, 0
  v_accvgpr_write_b32 a30, 0
  v_accvgpr_write_b32 a31, 0
  v_accvgpr_write_b32 a32, 0
  v_accvgpr_write_b32 a33, 0
  v_accvgpr_write_b32 a34, 0
  v_accvgpr_write_b32 a35, 0
  v_accvgpr_write_b32 a36, 0
  v_accvgpr_write_b32 a37, 0
  v_accvgpr_write_b32 a38, 0
  v_accvgpr_write_b32 a39, 0
  v_accvgpr_write_b32 a40, 0
  v_accvgpr_write_b32 a41, 0
  v_accvgpr_write_b32 a42, 0
  v_accvgpr_write_b32 a43, 0
  v_accvgpr_write_b32 a44, 0
  v_accvgpr_write_b32 a45, 0
  v_accvgpr_write_b32 a46, 0
  v_accvgpr_write_b32 a47, 0
  v_accvgpr_write_b32 a48, 0
  v_accvgpr_write_b32 a49, 0
  v_accvgpr_write_b32 a50, 0
  v_accvgpr_write_b32 a51, 0
  v_accvgpr_write_b32 a52, 0
  v_accvgpr_write_b32 a53, 0
  v_accvgpr_write_b32 a54, 0
  v_accvgpr_write_b32 a55, 0
  v_accvgpr_write_b32 a56, 0
  v_accvgpr_write_b32 a57, 0
  v_accvgpr_write_b32 a58, 0
  v_accvgpr_write_b32 a59, 0
  v_accvgpr_write_b32 a60, 0
  v_accvgpr_write_b32 a61, 0
  v_accvgpr_write_b32 a62, 0
  v_accvgpr_write_b32 a63, 0
  v_accvgpr_write_b32 a64, 0
  v_accvgpr_write_b32 a65, 0
  v_accvgpr_write_b32 a66, 0
  v_accvgpr_write_b32 a67, 0
  v_accvgpr_write_b32 a68, 0
  v_accvgpr_write_b32 a69, 0
  v_accvgpr_write_b32 a70, 0
  v_accvgpr_write_b32 a71, 0
  v_accvgpr_write_b32 a72, 0
  v_accvgpr_write_b32 a73, 0
  v_accvgpr_write_b32 a74, 0
  v_accvgpr_write_b32 a75, 0
  v_accvgpr_write_b32 a76, 0
  v_accvgpr_write_b32 a77, 0
  v_accvgpr_write_b32 a78, 0
  v_accvgpr_write_b32 a79, 0
  s_waitcnt vmcnt(21)
  v_mfma_f32_16x16x32_bf16 a[0:3], v[32:35], v[52:55], a[0:3]
  v_mfma_f32_16x16x32_bf16 a[20:23], v[32:35], v[56:59], a[20:23]
  v_mfma_f32_16x16x32_bf16 a[40:43], v[32:35], v[60:63], a[40:43]
  v_mfma_f32_16x16x32_bf16 a[60:63], v[32:35], v[64:67], a[60:63]
  buffer_load_dwordx4 v[32:35], v6, s[36:39], s28 offen offset:0
  v_mfma_f32_16x16x32_bf16 a[4:7], v[36:39], v[52:55], a[4:7]
  v_mfma_f32_16x16x32_bf16 a[24:27], v[36:39], v[56:59], a[24:27]
  v_mfma_f32_16x16x32_bf16 a[44:47], v[36:39], v[60:63], a[44:47]
  v_mfma_f32_16x16x32_bf16 a[64:67], v[36:39], v[64:67], a[64:67]
  buffer_load_dwordx4 v[36:39], v6, s[36:39], s28 offen offset:1024
  v_mfma_f32_16x16x32_bf16 a[8:11], v[40:43], v[52:55], a[8:11]
  v_mfma_f32_16x16x32_bf16 a[28:31], v[40:43], v[56:59], a[28:31]
  v_mfma_f32_16x16x32_bf16 a[48:51], v[40:43], v[60:63], a[48:51]
  v_mfma_f32_16x16x32_bf16 a[68:71], v[40:43], v[64:67], a[68:71]
  buffer_load_dwordx4 v[40:43], v6, s[36:39], s28 offen offset:2048
  v_mfma_f32_16x16x32_bf16 a[12:15], v[44:47], v[52:55], a[12:15]
  v_mfma_f32_16x16x32_bf16 a[32:35], v[44:47], v[56:59], a[32:35]
  v_mfma_f32_16x16x32_bf16 a[52:55], v[44:47], v[60:63], a[52:55]
  v_mfma_f32_16x16x32_bf16 a[72:75], v[44:47], v[64:67], a[72:75]
  buffer_load_dwordx4 v[44:47], v6, s[36:39], s28 offen offset:3072
  v_mfma_f32_16x16x32_bf16 a[16:19], v[48:51], v[52:55], a[16:19]
  buffer_load_dwordx4 v[52:55], v5, s[32:35], s26 offen offset:0
  v_mfma_f32_16x16x32_bf16 a[36:39], v[48:51], v[56:59], a[36:39]
  buffer_load_dwordx4 v[56:59], v5, s[32:35], s26 offen offset:256
  v_mfma_f32_16x16x32_bf16 a[56:59], v[48:51], v[60:63], a[56:59]
  buffer_load_dwordx4 v[60:63], v5, s[32:35], s27 offen offset:0
  v_mfma_f32_16x16x32_bf16 a[76:79], v[48:51], v[64:67], a[76:79]
  buffer_load_dwordx4 v[64:67], v5, s[32:35], s27 offen offset:256
  buffer_load_dwordx4 v[48:51], v7, s[36:39], s28 offen
  s_add_u32 s26, s26, 8192
  s_add_u32 s27, s27, 8192
  s_add_u32 s28, s28, 163840
  s_waitcnt vmcnt(21)
  v_mfma_f32_16x16x32_bf16 a[0:3], v[68:71], v[88:91], a[0:3]
  v_mfma_f32_16x16x32_bf16 a[20:23], v[68:71], v[92:95], a[20:23]
  v_mfma_f32_16x16x32_bf16 a[40:43], v[68:71], v[96:99], a[40:43]
  v_mfma_f32_16x16x32_bf16 a[60:63], v[68:71], v[100:103], a[60:63]
  buffer_load_dwordx4 v[68:71], v6, s[36:39], s28 offen offset:0
  v_mfma_f32_16x16x32_bf16 a[4:7], v[72:75], v[88:91], a[4:7]
  v_mfma_f32_16x16x32_bf16 a[24:27], v[72:75], v[92:95], a[24:27]
  v_mfma_f32_16x16x32_bf16 a[44:47], v[72:75], v[96:99], a[44:47]
  v_mfma_f32_16x16x32_bf16 a[64:67], v[72:75], v[100:103], a[64:67]
  buffer_load_dwordx4 v[72:75], v6, s[36:39], s28 offen offset:1024
  v_mfma_f32_16x16x32_bf16 a[8:11], v[76:79], v[88:91], a[8:11]
  v_mfma_f32_16x16x32_bf16 a[28:31], v[76:79], v[92:95], a[28:31]
  v_mfma_f32_16x16x32_bf16 a[48:51], v[76:79], v[96:99], a[48:51]
  v_mfma_f32_16x16x32_bf16 a[68:71], v[76:79], v[100:103], a[68:71]
  buffer_load_dwordx4 v[76:79], v6, s[36:39], s28 offen offset:2048
  v_mfma_f32_16x16x32_bf16 a[12:15], v[80:83], v[88:91], a[12:15]
  v_mfma_f32_16x16x32_bf16 a[32:35], v[80:83], v[92:95], a[32:35]
  v_mfma_f32_16x16x32_bf16 a[52:55], v[80:83], v[96:99], a[52:55]
  v_mfma_f32_16x16x32_bf16 a[72:75], v[80:83], v[100:103], a[72:75]
  buffer_load_dwordx4 v[80:83], v6, s[36:39], s28 offen offset:3072
  v_mfma_f32_16x16x32_bf16 a[16:19], v[84:87], v[88:91], a[16:19]
  buffer_load_dwordx4 v[88:91], v5, s[32:35], s26 offen offset:0
  v_mfma_f32_16x16x32_bf16 a[36:39], v[84:87], v[92:95], a[36:39]
  buffer_load_dwordx4 v[92:95], v5, s[32:35], s26 offen offset:256
  v_mfma_f32_16x16x32_bf16 a[56:59], v[84:87], v[96:99], a[56:59]
  buffer_load_dwordx4 v[96:99], v5, s[32:35], s27 offen offset:0
  v_mfma_f32_16x16x32_bf16 a[76:79], v[84:87], v[100:103], a[76:79]
  buffer_load_dwordx4 v[100:103], v5, s[32:35], s27 offen offset:256
  buffer_load_dwordx4 v[84:87], v7, s[36:39], s28 offen
  s_add_u32 s26, s26, 8192
  s_add_u32 s27, s27, 8192
  s_add_u32 s28, s28, 163840
  s_waitcnt vmcnt(21)
  v_mfma_f32_16x16x32_bf16 a[0:3], v[104:107], v[124:127], a[0:3]
  v_mfma_f32_16x16x32_bf16 a[20:23], v[104:107], v[128:131], a[20:23]
  v_mfma_f32_16x16x32_bf16 a[40:43], v[104:107], v[132:135], a[40:43]
  v_mfma_f32_16x16x32_bf16 a[60:63], v[104:107], v[136:139], a[60:63]
  buffer_load_dwordx4 v[104:107], v6, s[36:39], s28 offen offset:0
  v_mfma_f32_16x16x32_bf16 a[4:7], v[108:111], v[124:127], a[4:7]
  v_mfma_f32_16x16x32_bf16 a[24:27], v[108:111], v[128:131], a[24:27]
  v_mfma_f32_16x16x32_bf16 a[44:47], v[108:111], v[132:135], a[44:47]
  v_mfma_f32_16x16x32_bf16 a[64:67], v[108:111], v[136:139], a[64:67]
  buffer_load_dwordx4 v[108:111], v6, s[36:39], s28 offen offset:1024
  v_mfma_f32_16x16x32_bf16 a[8:11], v[112:115], v[124:127], a[8:11]
  v_mfma_f32_16x16x32_bf16 a[28:31], v[112:115], v[128:131], a[28:31]
  v_mfma_f32_16x16x32_bf16 a[48:51], v[112:115], v[132:135], a[48:51]
  v_mfma_f32_16x16x32_bf16 a[68:71], v[112:115], v[136:139], a[68:71]
  buffer_load_dwordx4 v[112:115], v6, s[36:39], s28 offen offset:2048
  v_mfma_f32_16x16x32_bf16 a[12:15], v[116:119], v[124:127], a[12:15]
  v_mfma_f32_16x16x32_bf16 a[32:35], v[116:119], v[128:131], a[32:35]
  v_mfma_f32_16x16x32_bf16 a[52:55], v[116:119], v[132:135], a[52:55]
  v_mfma_f32_16x16x32_bf16 a[72:75], v[116:119], v[136:139], a[72:75]
  buffer_load_dwordx4 v[116:119], v6, s[36:39], s28 offen offset:3072
  v_mfma_f32_16x16x32_bf16 a[16:19], v[120:123], v[124:127], a[16:19]
  buffer_load_dwordx4 v[124:127], v5, s[32:35], s26 offen offset:0
  v_mfma_f32_16x16x32_bf16 a[36:39], v[120:123], v[128:131], a[36:39]
  buffer_load_dwordx4 v[128:131], v5, s[32:35], s26 offen offset:256
  v_mfma_f32_16x16x32_bf16 a[56:59], v[120:123], v[132:135], a[56:59]
  buffer_load_dwordx4 v[132:135], v5, s[32:35], s27 offen offset:0
  v_mfma_f32_16x16x32_bf16 a[76:79], v[120:123], v[136:139], a[76:79]
  buffer_load_dwordx4 v[136:139], v5, s[32:35], s27 offen offset:256
  buffer_load_dwordx4 v[120:123], v7, s[36:39], s28 offen
  s_add_u32 s26, s26, 8192
  s_add_u32 s27, s27, 8192
  s_add_u32 s28, s28, 163840
  s_waitcnt vmcnt(18)
  v_mfma_f32_16x16x32_bf16 a[0:3], v[32:35], v[52:55], a[0:3]
  v_mfma_f32_16x16x32_bf16 a[20:23], v[32:35], v[56:59], a[20:23]
  v_mfma_f32_16x16x32_bf16 a[40:43], v[32:35], v[60:63], a[40:43]
  v_mfma_f32_16x16x32_bf16 a[60:63], v[32:35], v[64:67], a[60:63]
  buffer_load_dwordx4 v[32:35], v6, s[36:39], s28 offen offset:0
  v_mfma_f32_16x16x32_bf16 a[4:7], v[36:39], v[52:55], a[4:7]
  v_mfma_f32_16x16x32_bf16 a[24:27], v[36:39], v[56:59], a[24:27]
  v_mfma_f32_16x16x32_bf16 a[44:47], v[36:39], v[60:63], a[44:47]
  v_mfma_f32_16x16x32_bf16 a[64:67], v[36:39], v[64:67], a[64:67]
  buffer_load_dwordx4 v[36:39], v6, s[36:39], s28 offen offset:1024
  v_mfma_f32_16x16x32_bf16 a[8:11], v[40:43], v[52:55], a[8:11]
  v_mfma_f32_16x16x32_bf16 a[28:31], v[40:43], v[56:59], a[28:31]
  v_mfma_f32_16x16x32_bf16 a[48:51], v[40:43], v[60:63], a[48:51]
  v_mfma_f32_16x16x32_bf16 a[68:71], v[40:43], v[64:67], a[68:71]
  buffer_load_dwordx4 v[40:43], v6, s[36:39], s28 offen offset:2048
  v_mfma_f32_16x16x32_bf16 a[12:15], v[44:47], v[52:55], a[12:15]
  v_mfma_f32_16x16x32_bf16 a[32:35], v[44:47], v[56:59], a[32:35]
  v_mfma_f32_16x16x32_bf16 a[52:55], v[44:47], v[60:63], a[52:55]
  v_mfma_f32_16x16x32_bf16 a[72:75], v[44:47], v[64:67], a[72:75]
  buffer_load_dwordx4 v[44:47], v6, s[36:39], s28 offen offset:3072
  v_mfma_f32_16x16x32_bf16 a[16:19], v[48:51], v[52:55], a[16:19]
  buffer_load_dwordx4 v[52:55], v5, s[32:35], s26 offen offset:0
  v_mfma_f32_16x16x32_bf16 a[36:39], v[48:51], v[56:59], a[36:39]
  buffer_load_dwordx4 v[56:59], v5, s[32:35], s26 offen offset:256
  v_mfma_f32_16x16x32_bf16 a[56:59], v[48:51], v[60:63], a[56:59]
  buffer_load_dwordx4 v[60:63], v5, s[32:35], s27 offen offset:0
  v_mfma_f32_16x16x32_bf16 a[76:79], v[48:51], v[64:67], a[76:79]
  buffer_load_dwordx4 v[64:67], v5, s[32:35], s27 offen offset:256
  buffer_load_dwordx4 v[48:51], v7, s[36:39], s28 offen
  s_add_u32 s26, s26, 8192
  s_add_u32 s27, s27, 8192
  s_add_u32 s28, s28, 163840
  s_waitcnt vmcnt(18)
  v_mfma_f32_16x16x32_bf16 a[0:3], v[68:71], v[88:91], a[0:3]
  v_mfma_f32_16x16x32_bf16 a[20:23], v[68:71], v[92:95], a[20:23]
  v_mfma_f32_16x16x32_bf16 a[40:43], v[68:71], v[96:99], a[40:43]
  v_mfma_f32_16x16x32_bf16 a[60:63], v[68:71], v[100:103], a[60:63]
  buffer_load_dwordx4 v[68:71], v6, s[36:39], s28 offen offset:0
  v_mfma_f32_16x16x32_bf16 a[4:7], v[72:75], v[88:91], a[4:7]
  v_mfma_f32_16x16x32_bf16 a[24:27], v[72:75], v[92:95], a[24:27]
  v_mfma_f32_16x16x32_bf16 a[44:47], v[72:75], v[96:99], a[44:47]
  v_mfma_f32_16x16x32_bf16 a[64:67], v[72:75], v[100:103], a[64:67]
  buffer_load_dwordx4 v[72:75], v6, s[36:39], s28 offen offset:1024
  v_mfma_f32_16x16x32_bf16 a[8:11], v[76:79], v[88:91], a[8:11]
  v_mfma_f32_16x16x32_bf16 a[28:31], v[76:79], v[92:95], a[28:31]
  v_mfma_f32_16x16x32_bf16 a[48:51], v[76:79], v[96:99], a[48:51]
  v_mfma_f32_16x16x32_bf16 a[68:71], v[76:79], v[100:103], a[68:71]
  buffer_load_dwordx4 v[76:79], v6, s[36:39], s28 offen offset:2048
  v_mfma_f32_16x16x32_bf16 a[12:15], v[80:83], v[88:91], a[12:15]
  v_mfma_f32_16x16x32_bf16 a[32:35], v[80:83], v[92:95], a[32:35]
  v_mfma_f32_16x16x32_bf16 a[52:55], v[80:83], v[96:99], a[52:55]
  v_mfma_f32_16x16x32_bf16 a[72:75], v[80:83], v[100:103], a[72:75]
  buffer_load_dwordx4 v[80:83], v6, s[36:39], s28 offen offset:3072
  v_mfma_f32_16x16x32_bf16 a[16:19], v[84:87], v[88:91], a[16:19]
  buffer_load_dwordx4 v[88:91], v5, s[32:35], s26 offen offset:0
  v_mfma_f32_16x16x32_bf16 a[36:39], v[84:87], v[92:95], a[36:39]
  buffer_load_dwordx4 v[92:95], v5, s[32:35], s26 offen offset:256
  v_mfma_f32_16x16x32_bf16 a[56:59], v[84:87], v[96:99], a[56:59]
  buffer_load_dwordx4 v[96:99], v5, s[32:35], s27 offen offset:0
  v_mfma_f32_16x16x32_bf16 a[76:79], v[84:87], v[100:103], a[76:79]
  buffer_load_dwordx4 v[100:103], v5, s[32:35], s27 offen offset:256
  buffer_load_dwordx4 v[84:87], v7, s[36:39], s28 offen
  s_add_u32 s26, s26, 8192
  s_add_u32 s27, s27, 8192
  s_add_u32 s28, s28, 163840
  s_waitcnt vmcnt(18)
  v_mfma_f32_16x16x32_bf16 a[0:3], v[104:107], v[124:127], a[0:3]
  v_mfma_f32_16x16x32_bf16 a[20:23], v[104:107], v[128:131], a[20:23]
  v_mfma_f32_16x16x32_bf16 a[40:43], v[104:107], v[132:135], a[40:43]
  v_mfma_f32_16x16x32_bf16 a[60:63], v[104:107], v[136:139], a[60:63]
  buffer_load_dwordx4 v[104:107], v6, s[36:39], s28 offen offset:0
  v_mfma_f32_16x16x32_bf16 a[4:7], v[108:111], v[124:127], a[4:7]
  v_mfma_f32_16x16x32_bf16 a[24:27], v[108:111], v[128:131], a[24:27]
  v_mfma_f32_16x16x32_bf16 a[44:47], v[108:111], v[132:135], a[44:47]
  v_mfma_f32_16x16x32_bf16 a[64:67], v[108:111], v[136:139], a[64:67]
  buffer_load_dwordx4 v[108:111], v6, s[36:39], s28 offen offset:1024
  v_mfma_f32_16x16x32_bf16 a[8:11], v[112:115], v[124:127], a[8:11]
  v_mfma_f32_16x16x32_bf16 a[28:31], v[112:115], v[128:131], a[28:31]
  v_mfma_f32_16x16x32_bf16 a[48:51], v[112:115], v[132:135], a[48:51]
  v_mfma_f32_16x16x32_bf16 a[68:71], v[112:115], v[136:139], a[68:71]
  buffer_load_dwordx4 v[112:115], v6, s[36:39], s28 offen offset:2048
  v_mfma_f32_16x16x32_bf16 a[12:15], v[116:119], v[124:127], a[12:15]
  v_mfma_f32_16x16x32_bf16 a[32:35], v[116:119], v[128:131], a[32:35]
  v_mfma_f32_16x16x32_bf16 a[52:55], v[116:119], v[132:135], a[52:55]
  v_mfma_f32_16x16x32_bf16 a[72:75], v[116:119], v[136:139], a[72:75]
  buffer_load_dwordx4 v[116:119], v6, s[36:39], s28 offen offset:3072
  v_mfma_f32_16x16x32_bf16 a[16:19], v[120:123], v[124:127], a[16:19]
  buffer_load_dwordx4 v[124:127], v5, s[32:35], s26 offen offset:0
  v_mfma_f32_16x16x32_bf16 a[36:39], v[120:123], v[128:131], a[36:39]
  buffer_load_dwordx4 v[128:131], v5, s[32:35], s26 offen offset:256
  v_mfma_f32_16x16x32_bf16 a[56:59], v[120:123], v[132:135], a[56:59]
  buffer_load_dwordx4 v[132:135], v5, s[32:35], s27 offen offset:0
  v_mfma_f32_16x16x32_bf16 a[76:79], v[120:123], v[136:139], a[76:79]
  buffer_load_dwordx4 v[136:139], v5, s[32:35], s27 offen offset:256
  buffer_load_dwordx4 v[120:123], v7, s[36:39], s28 offen
  s_add_u32 s26, s26, 8192
  s_add_u32 s27, s27, 8192
  s_add_u32 s28, s28, 163840
  s_waitcnt vmcnt(18)
  v_mfma_f32_16x16x32_bf16 a[0:3], v[32:35], v[52:55], a[0:3]
  v_mfma_f32_16x16x32_bf16 a[20:23], v[32:35], v[56:59], a[20:23]
  v_mfma_f32_16x16x32_bf16 a[40:43], v[32:35], v[60:63], a[40:43]
  v_mfma_f32_16x16x32_bf16 a[60:63], v[32:35], v[64:67], a[60:63]
  buffer_load_dwordx4 v[32:35], v6, s[36:39], s28 offen offset:0
  v_mfma_f32_16x16x32_bf16 a[4:7], v[36:39], v[52:55], a[4:7]
  v_mfma_f32_16x16x32_bf16 a[24:27], v[36:39], v[56:59], a[24:27]
  v_mfma_f32_16x16x32_bf16 a[44:47], v[36:39], v[60:63], a[44:47]
  v_mfma_f32_16x16x32_bf16 a[64:67], v[36:39], v[64:67], a[64:67]
  buffer_load_dwordx4 v[36:39], v6, s[36:39], s28 offen offset:1024
  v_mfma_f32_16x16x32_bf16 a[8:11], v[40:43], v[52:55], a[8:11]
  v_mfma_f32_16x16x32_bf16 a[28:31], v[40:43], v[56:59], a[28:31]
  v_mfma_f32_16x16x32_bf16 a[48:51], v[40:43], v[60:63], a[48:51]
  v_mfma_f32_16x16x32_bf16 a[68:71], v[40:43], v[64:67], a[68:71]
  buffer_load_dwordx4 v[40:43], v6, s[36:39], s28 offen offset:2048
  v_mfma_f32_16x16x32_bf16 a[12:15], v[44:47], v[52:55], a[12:15]
  v_mfma_f32_16x16x32_bf16 a[32:35], v[44:47], v[56:59], a[32:35]
  v_mfma_f32_16x16x32_bf16 a[52:55], v[44:47], v[60:63], a[52:55]
  v_mfma_f32_16x16x32_bf16 a[72:75], v[44:47], v[64:67], a[72:75]
  buffer_load_dwordx4 v[44:47], v6, s[36:39], s28 offen offset:3072
  v_mfma_f32_16x16x32_bf16 a[16:19], v[48:51], v[52:55], a[16:19]
  buffer_load_dwordx4 v[52:55], v5, s[32:35], s26 offen offset:0
  v_mfma_f32_16x16x32_bf16 a[36:39], v[48:51], v[56:59], a[36:39]
  buffer_load_dwordx4 v[56:59], v5, s[32:35], s26 offen offset:256
  v_mfma_f32_16x16x32_bf16 a[56:59], v[48:51], v[60:63], a[56:59]
  buffer_load_dwordx4 v[60:63], v5, s[32:35], s27 offen offset:0
  v_mfma_f32_16x16x32_bf16 a[76:79], v[48:51], v[64:67], a[76:79]
  buffer_load_dwordx4 v[64:67], v5, s[32:35], s27 offen offset:256
  buffer_load_dwordx4 v[48:51], v7, s[36:39], s28 offen
  s_add_u32 s26, s26, 8192
  s_add_u32 s27, s27, 8192
  s_add_u32 s28, s28, 163840
  s_waitcnt vmcnt(18)
  v_mfma_f32_16x16x32_bf16 a[0:3], v[68:71], v[88:91], a[0:3]
  v_mfma_f32_16x16x32_bf16 a[20:23], v[68:71], v[92:95], a[20:23]
  v_mfma_f32_16x16x32_bf16 a[40:43], v[68:71], v[96:99], a[40:43]
  v_mfma_f32_16x16x32_bf16 a[60:63], v[68:71], v[100:103], a[60:63]
  buffer_load_dwordx4 v[68:71], v6, s[36:39], s28 offen offset:0
  v_mfma_f32_16x16x32_bf16 a[4:7], v[72:75], v[88:91], a[4:7]
  v_mfma_f32_16x16x32_bf16 a[24:27], v[72:75], v[92:95], a[24:27]
  v_mfma_f32_16x16x32_bf16 a[44:47], v[72:75], v[96:99], a[44:47]
  v_mfma_f32_16x16x32_bf16 a[64:67], v[72:75], v[100:103], a[64:67]
  buffer_load_dwordx4 v[72:75], v6, s[36:39], s28 offen offset:1024
  v_mfma_f32_16x16x32_bf16 a[8:11], v[76:79], v[88:91], a[8:11]
  v_mfma_f32_16x16x32_bf16 a[28:31], v[76:79], v[92:95], a[28:31]
  v_mfma_f32_16x16x32_bf16 a[48:51], v[76:79], v[96:99], a[48:51]
  v_mfma_f32_16x16x32_bf16 a[68:71], v[76:79], v[100:103], a[68:71]
  buffer_load_dwordx4 v[76:79], v6, s[36:39], s28 offen offset:2048
  v_mfma_f32_16x16x32_bf16 a[12:15], v[80:83], v[88:91], a[12:15]
  v_mfma_f32_16x16x32_bf16 a[32:35], v[80:83], v[92:95], a[32:35]
  v_mfma_f32_16x16x32_bf16 a[52:55], v[80:83], v[96:99], a[52:55]
  v_mfma_f32_16x16x32_bf16 a[72:75], v[80:83], v[100:103], a[72:75]
  buffer_load_dwordx4 v[80:83], v6, s[36:39], s28 offen offset:3072
  v_mfma_f32_16x16x32_bf16 a[16:19], v[84:87], v[88:91], a[16:19]
  buffer_load_dwordx4 v[88:91], v5, s[32:35], s26 offen offset:0
  v_mfma_f32_16x16x32_bf16 a[36:39], v[84:87], v[92:95], a[36:39]
  buffer_load_dwordx4 v[92:95], v5, s[32:35], s26 offen offset:256
  v_mfma_f32_16x16x32_bf16 a[56:59], v[84:87], v[96:99], a[56:59]
  buffer_load_dwordx4 v[96:99], v5, s[32:35], s27 offen offset:0
  v_mfma_f32_16x16x32_bf16 a[76:79], v[84:87], v[100:103], a[76:79]
  buffer_load_dwordx4 v[100:103], v5, s[32:35], s27 offen offset:256
  buffer_load_dwordx4 v[84:87], v7, s[36:39], s28 offen
  s_add_u32 s26, s26, 8192
  s_add_u32 s27, s27, 8192
  s_add_u32 s28, s28, 163840
  s_waitcnt vmcnt(18)
  v_mfma_f32_16x16x32_bf16 a[0:3], v[104:107], v[124:127], a[0:3]
  v_mfma_f32_16x16x32_bf16 a[20:23], v[104:107], v[128:131], a[20:23]
  v_mfma_f32_16x16x32_bf16 a[40:43], v[104:107], v[132:135], a[40:43]
  v_mfma_f32_16x16x32_bf16 a[60:63], v[104:107], v[136:139], a[60:63]
  buffer_load_dwordx4 v[104:107], v6, s[36:39], s28 offen offset:0
  v_mfma_f32_16x16x32_bf16 a[4:7], v[108:111], v[124:127], a[4:7]
  v_mfma_f32_16x16x32_bf16 a[24:27], v[108:111], v[128:131], a[24:27]
  v_mfma_f32_16x16x32_bf16 a[44:47], v[108:111], v[132:135], a[44:47]
  v_mfma_f32_16x16x32_bf16 a[64:67], v[108:111], v[136:139], a[64:67]
  buffer_load_dwordx4 v[108:111], v6, s[36:39], s28 offen offset:1024
  v_mfma_f32_16x16x32_bf16 a[8:11], v[112:115], v[124:127], a[8:11]
  v_mfma_f32_16x16x32_bf16 a[28:31], v[112:115], v[128:131], a[28:31]
  v_mfma_f32_16x16x32_bf16 a[48:51], v[112:115], v[132:135], a[48:51]
  v_mfma_f32_16x16x32_bf16 a[68:71], v[112:115], v[136:139], a[68:71]
  buffer_load_dwordx4 v[112:115], v6, s[36:39], s28 offen offset:2048
  v_mfma_f32_16x16x32_bf16 a[12:15], v[116:119], v[124:127], a[12:15]
  v_mfma_f32_16x16x32_bf16 a[32:35], v[116:119], v[128:131], a[32:35]
  v_mfma_f32_16x16x32_bf16 a[52:55], v[116:119], v[132:135], a[52:55]
  v_mfma_f32_16x16x32_bf16 a[72:75], v[116:119], v[136:139], a[72:75]
  buffer_load_dwordx4 v[116:119], v6, s[36:39], s28 offen offset:3072
  v_mfma_f32_16x16x32_bf16 a[16:19], v[120:123], v[124:127], a[16:19]
  buffer_load_dwordx4 v[124:127], v5, s[32:35], s26 offen offset:0
  v_mfma_f32_16x16x32_bf16 a[36:39], v[120:123], v[128:131], a[36:39]
  buffer_load_dwordx4 v[128:131], v5, s[32:35], s26 offen offset:256
  v_mfma_f32_16x16x32_bf16 a[56:59], v[120:123], v[132:135], a[56:59]
  buffer_load_dwordx4 v[132:135], v5, s[32:35], s27 offen offset:0
  v_mfma_f32_16x16x32_bf16 a[76:79], v[120:123], v[136:139], a[76:79]
  buffer_load_dwordx4 v[136:139], v5, s[32:35], s27 offen offset:256
  buffer_load_dwordx4 v[120:123], v7, s[36:39], s28 offen
  s_add_u32 s26, s26, 8192
  s_add_u32 s27, s27, 8192
  s_add_u32 s28, s28, 163840
  s_waitcnt vmcnt(18)
  v_mfma_f32_16x16x32_bf16 a[0:3], v[32:35], v[52:55], a[0:3]
  v_mfma_f32_16x16x32_bf16 a[20:23], v[32:35], v[56:59], a[20:23]
  v_mfma_f32_16x16x32_bf16 a[40:43], v[32:35], v[60:63], a[40:43]
  v_mfma_f32_16x16x32_bf16 a[60:63], v[32:35], v[64:67], a[60:63]
  buffer_load_dwordx4 v[32:35], v6, s[36:39], s28 offen offset:0
  v_mfma_f32_16x16x32_bf16 a[4:7], v[36:39], v[52:55], a[4:7]
  v_mfma_f32_16x16x32_bf16 a[24:27], v[36:39], v[56:59], a[24:27]
  v_mfma_f32_16x16x32_bf16 a[44:47], v[36:39], v[60:63], a[44:47]
  v_mfma_f32_16x16x32_bf16 a[64:67], v[36:39], v[64:67], a[64:67]
  buffer_load_dwordx4 v[36:39], v6, s[36:39], s28 offen offset:1024
  v_mfma_f32_16x16x32_bf16 a[8:11], v[40:43], v[52:55], a[8:11]
  v_mfma_f32_16x16x32_bf16 a[28:31], v[40:43], v[56:59], a[28:31]
  v_mfma_f32_16x16x32_bf16 a[48:51], v[40:43], v[60:63], a[48:51]
  v_mfma_f32_16x16x32_bf16 a[68:71], v[40:43], v[64:67], a[68:71]
  buffer_load_dwordx4 v[40:43], v6, s[36:39], s28 offen offset:2048
  v_mfma_f32_16x16x32_bf16 a[12:15], v[44:47], v[52:55], a[12:15]
  v_mfma_f32_16x16x32_bf16 a[32:35], v[44:47], v[56:59], a[32:35]
  v_mfma_f32_16x16x32_bf16 a[52:55], v[44:47], v[60:63], a[52:55]
  v_mfma_f32_16x16x32_bf16 a[72:75], v[44:47], v[64:67], a[72:75]
  buffer_load_dwordx4 v[44:47], v6, s[36:39], s28 offen offset:3072
  v_mfma_f32_16x16x32_bf16 a[16:19], v[48:51], v[52:55], a[16:19]
  buffer_load_dwordx4 v[52:55], v5, s[32:35], s26 offen offset:0
  v_mfma_f32_16x16x32_bf16 a[36:39], v[48:51], v[56:59], a[36:39]
  buffer_load_dwordx4 v[56:59], v5, s[32:35], s26 offen offset:256
  v_mfma_f32_16x16x32_bf16 a[56:59], v[48:51], v[60:63], a[56:59]
  buffer_load_dwordx4 v[60:63], v5, s[32:35], s27 offen offset:0
  v_mfma_f32_16x16x32_bf16 a[76:79], v[48:51], v[64:67], a[76:79]
  buffer_load_dwordx4 v[64:67], v5, s[32:35], s27 offen offset:256
  buffer_load_dwordx4 v[48:51], v7, s[36:39], s28 offen
  s_add_u32 s26, s26, 8192
  s_add_u32 s27, s27, 8192
  s_add_u32 s28, s28, 163840
  s_waitcnt vmcnt(18)
  v_mfma_f32_16x16x32_bf16 a[0:3], v[68:71], v[88:91], a[0:3]
  v_mfma_f32_16x16x32_bf16 a[20:23], v[68:71], v[92:95], a[20:23]
  v_mfma_f32_16x16x32_bf16 a[40:43], v[68:71], v[96:99], a[40:43]
  v_mfma_f32_16x16x32_bf16 a[60:63], v[68:71], v[100:103], a[60:63]
  buffer_load_dwordx4 v[68:71], v6, s[36:39], s28 offen offset:0
  v_mfma_f32_16x16x32_bf16 a[4:7], v[72:75], v[88:91], a[4:7]
  v_mfma_f32_16x16x32_bf16 a[24:27], v[72:75], v[92:95], a[24:27]
  v_mfma_f32_16x16x32_bf16 a[44:47], v[72:75], v[96:99], a[44:47]
  v_mfma_f32_16x16x32_bf16 a[64:67], v[72:75], v[100:103], a[64:67]
  buffer_load_dwordx4 v[72:75], v6, s[36:39], s28 offen offset:1024
  v_mfma_f32_16x16x32_bf16 a[8:11], v[76:79], v[88:91], a[8:11]
  v_mfma_f32_16x16x32_bf16 a[28:31], v[76:79], v[92:95], a[28:31]
  v_mfma_f32_16x16x32_bf16 a[48:51], v[76:79], v[96:99], a[48:51]
  v_mfma_f32_16x16x32_bf16 a[68:71], v[76:79], v[100:103], a[68:71]
  buffer_load_dwordx4 v[76:79], v6, s[36:39], s28 offen offset:2048
  v_mfma_f32_16x16x32_bf16 a[12:15], v[80:83], v[88:91], a[12:15]
  v_mfma_f32_16x16x32_bf16 a[32:35], v[80:83], v[92:95], a[32:35]
  v_mfma_f32_16x16x32_bf16 a[52:55], v[80:83], v[96:99], a[52:55]
  v_mfma_f32_16x16x32_bf16 a[72:75], v[80:83], v[100:103], a[72:75]
  buffer_load_dwordx4 v[80:83], v6, s[36:39], s28 offen offset:3072
  v_mfma_f32_16x16x32_bf16 a[16:19], v[84:87], v[88:91], a[16:19]
  buffer_load_dwordx4 v[88:91], v5, s[32:35], s26 offen offset:0
  v_mfma_f32_16x16x32_bf16 a[36:39], v[84:87], v[92:95], a[36:39]
  buffer_load_dwordx4 v[92:95], v5, s[32:35], s26 offen offset:256
  v_mfma_f32_16x16x32_bf16 a[56:59], v[84:87], v[96:99], a[56:59]
  buffer_load_dwordx4 v[96:99], v5, s[32:35], s27 offen offset:0
  v_mfma_f32_16x16x32_bf16 a[76:79], v[84:87], v[100:103], a[76:79]
  buffer_load_dwordx4 v[100:103], v5, s[32:35], s27 offen offset:256
  buffer_load_dwordx4 v[84:87], v7, s[36:39], s28 offen
  s_add_u32 s26, s26, 8192
  s_add_u32 s27, s27, 8192
  s_add_u32 s28, s28, 163840
  s_waitcnt vmcnt(18)
  v_mfma_f32_16x16x32_bf16 a[0:3], v[104:107], v[124:127], a[0:3]
  v_mfma_f32_16x16x32_bf16 a[20:23], v[104:107], v[128:131], a[20:23]
  v_mfma_f32_16x16x32_bf16 a[40:43], v[104:107], v[132:135], a[40:43]
  v_mfma_f32_16x16x32_bf16 a[60:63], v[104:107], v[136:139], a[60:63]
  buffer_load_dwordx4 v[104:107], v6, s[36:39], s28 offen offset:0
  v_mfma_f32_16x16x32_bf16 a[4:7], v[108:111], v[124:127], a[4:7]
  v_mfma_f32_16x16x32_bf16 a[24:27], v[108:111], v[128:131], a[24:27]
  v_mfma_f32_16x16x32_bf16 a[44:47], v[108:111], v[132:135], a[44:47]
  v_mfma_f32_16x16x32_bf16 a[64:67], v[108:111], v[136:139], a[64:67]
  buffer_load_dwordx4 v[108:111], v6, s[36:39], s28 offen offset:1024
  v_mfma_f32_16x16x32_bf16 a[8:11], v[112:115], v[124:127], a[8:11]
  v_mfma_f32_16x16x32_bf16 a[28:31], v[112:115], v[128:131], a[28:31]
  v_mfma_f32_16x16x32_bf16 a[48:51], v[112:115], v[132:135], a[48:51]
  v_mfma_f32_16x16x32_bf16 a[68:71], v[112:115], v[136:139], a[68:71]
  buffer_load_dwordx4 v[112:115], v6, s[36:39], s28 offen offset:2048
  v_mfma_f32_16x16x32_bf16 a[12:15], v[116:119], v[124:127], a[12:15]
  v_mfma_f32_16x16x32_bf16 a[32:35], v[116:119], v[128:131], a[32:35]
  v_mfma_f32_16x16x32_bf16 a[52:55], v[116:119], v[132:135], a[52:55]
  v_mfma_f32_16x16x32_bf16 a[72:75], v[116:119], v[136:139], a[72:75]
  buffer_load_dwordx4 v[116:119], v6, s[36:39], s28 offen offset:3072
  v_mfma_f32_16x16x32_bf16 a[16:19], v[120:123], v[124:127], a[16:19]
  buffer_load_dwordx4 v[124:127], v5, s[32:35], s26 offen offset:0
  v_mfma_f32_16x16x32_bf16 a[36:39], v[120:123], v[128:131], a[36:39]
  buffer_load_dwordx4 v[128:131], v5, s[32:35], s26 offen offset:256
  v_mfma_f32_16x16x32_bf16 a[56:59], v[120:123], v[132:135], a[56:59]
  buffer_load_dwordx4 v[132:135], v5, s[32:35], s27 offen offset:0
  v_mfma_f32_16x16x32_bf16 a[76:79], v[120:123], v[136:139], a[76:79]
  buffer_load_dwordx4 v[136:139], v5, s[32:35], s27 offen offset:256
  buffer_load_dwordx4 v[120:123], v7, s[36:39], s28 offen
  s_add_u32 s26, s26, 8192
  s_add_u32 s27, s27, 8192
  s_add_u32 s28, s28, 163840
  s_waitcnt vmcnt(18)
  v_mfma_f32_16x16x32_bf16 a[0:3], v[32:35], v[52:55], a[0:3]
  v_mfma_f32_16x16x32_bf16 a[20:23], v[32:35], v[56:59], a[20:23]
  v_mfma_f32_16x16x32_bf16 a[40:43], v[32:35], v[60:63], a[40:43]
  v_mfma_f32_16x16x32_bf16 a[60:63], v[32:35], v[64:67], a[60:63]
  buffer_load_dwordx4 v[32:35], v6, s[36:39], s28 offen offset:0
  v_mfma_f32_16x16x32_bf16 a[4:7], v[36:39], v[52:55], a[4:7]
  v_mfma_f32_16x16x32_bf16 a[24:27], v[36:39], v[56:59], a[24:27]
  v_mfma_f32_16x16x32_bf16 a[44:47], v[36:39], v[60:63], a[44:47]
  v_mfma_f32_16x16x32_bf16 a[64:67], v[36:39], v[64:67], a[64:67]
  buffer_load_dwordx4 v[36:39], v6, s[36:39], s28 offen offset:1024
  v_mfma_f32_16x16x32_bf16 a[8:11], v[40:43], v[52:55], a[8:11]
  v_mfma_f32_16x16x32_bf16 a[28:31], v[40:43], v[56:59], a[28:31]
  v_mfma_f32_16x16x32_bf16 a[48:51], v[40:43], v[60:63], a[48:51]
  v_mfma_f32_16x16x32_bf16 a[68:71], v[40:43], v[64:67], a[68:71]
  buffer_load_dwordx4 v[40:43], v6, s[36:39], s28 offen offset:2048
  v_mfma_f32_16x16x32_bf16 a[12:15], v[44:47], v[52:55], a[12:15]
  v_mfma_f32_16x16x32_bf16 a[32:35], v[44:47], v[56:59], a[32:35]
  v_mfma_f32_16x16x32_bf16 a[52:55], v[44:47], v[60:63], a[52:55]
  v_mfma_f32_16x16x32_bf16 a[72:75], v[44:47], v[64:67], a[72:75]
  buffer_load_dwordx4 v[44:47], v6, s[36:39], s28 offen offset:3072
  v_mfma_f32_16x16x32_bf16 a[16:19], v[48:51], v[52:55], a[16:19]
  buffer_load_dwordx4 v[52:55], v5, s[32:35], s26 offen offset:0
  v_mfma_f32_16x16x32_bf16 a[36:39], v[48:51], v[56:59], a[36:39]
  buffer_load_dwordx4 v[56:59], v5, s[32:35], s26 offen offset:256
  v_mfma_f32_16x16x32_bf16 a[56:59], v[48:51], v[60:63], a[56:59]
  buffer_load_dwordx4 v[60:63], v5, s[32:35], s27 offen offset:0
  v_mfma_f32_16x16x32_bf16 a[76:79], v[48:51], v[64:67], a[76:79]
  buffer_load_dwordx4 v[64:67], v5, s[32:35], s27 offen offset:256
  buffer_load_dwordx4 v[48:51], v7, s[36:39], s28 offen
  s_add_u32 s26, s26, 8192
  s_add_u32 s27, s27, 8192
  s_add_u32 s28, s28, 163840
  s_waitcnt vmcnt(18)
  v_mfma_f32_16x16x32_bf16 a[0:3], v[68:71], v[88:91], a[0:3]
  v_mfma_f32_16x16x32_bf16 a[20:23], v[68:71], v[92:95], a[20:23]
  v_mfma_f32_16x16x32_bf16 a[40:43], v[68:71], v[96:99], a[40:43]
  v_mfma_f32_16x16x32_bf16 a[60:63], v[68:71], v[100:103], a[60:63]
  buffer_load_dwordx4 v[68:71], v6, s[36:39], s28 offen offset:0
  v_mfma_f32_16x16x32_bf16 a[4:7], v[72:75], v[88:91], a[4:7]
  v_mfma_f32_16x16x32_bf16 a[24:27], v[72:75], v[92:95], a[24:27]
  v_mfma_f32_16x16x32_bf16 a[44:47], v[72:75], v[96:99], a[44:47]
  v_mfma_f32_16x16x32_bf16 a[64:67], v[72:75], v[100:103], a[64:67]
  buffer_load_dwordx4 v[72:75], v6, s[36:39], s28 offen offset:1024
  v_mfma_f32_16x16x32_bf16 a[8:11], v[76:79], v[88:91], a[8:11]
  v_mfma_f32_16x16x32_bf16 a[28:31], v[76:79], v[92:95], a[28:31]
  v_mfma_f32_16x16x32_bf16 a[48:51], v[76:79], v[96:99], a[48:51]
  v_mfma_f32_16x16x32_bf16 a[68:71], v[76:79], v[100:103], a[68:71]
  buffer_load_dwordx4 v[76:79], v6, s[36:39], s28 offen offset:2048
  v_mfma_f32_16x16x32_bf16 a[12:15], v[80:83], v[88:91], a[12:15]
  v_mfma_f32_16x16x32_bf16 a[32:35], v[80:83], v[92:95], a[32:35]
  v_mfma_f32_16x16x32_bf16 a[52:55], v[80:83], v[96:99], a[52:55]
  v_mfma_f32_16x16x32_bf16 a[72:75], v[80:83], v[100:103], a[72:75]
  buffer_load_dwordx4 v[80:83], v6, s[36:39], s28 offen offset:3072
  v_mfma_f32_16x16x32_bf16 a[16:19], v[84:87], v[88:91], a[16:19]
  buffer_load_dwordx4 v[88:91], v5, s[32:35], s26 offen offset:0
  v_mfma_f32_16x16x32_bf16 a[36:39], v[84:87], v[92:95], a[36:39]
  buffer_load_dwordx4 v[92:95], v5, s[32:35], s26 offen offset:256
  v_mfma_f32_16x16x32_bf16 a[56:59], v[84:87], v[96:99], a[56:59]
  buffer_load_dwordx4 v[96:99], v5, s[32:35], s27 offen offset:0
  v_mfma_f32_16x16x32_bf16 a[76:79], v[84:87], v[100:103], a[76:79]
  buffer_load_dwordx4 v[100:103], v5, s[32:35], s27 offen offset:256
  buffer_load_dwordx4 v[84:87], v7, s[36:39], s28 offen
  s_add_u32 s26, s26, 8192
  s_add_u32 s27, s27, 8192
  s_add_u32 s28, s28, 163840
  s_waitcnt vmcnt(18)
  v_mfma_f32_16x16x32_bf16 a[0:3], v[104:107], v[124:127], a[0:3]
  v_mfma_f32_16x16x32_bf16 a[20:23], v[104:107], v[128:131], a[20:23]
  v_mfma_f32_16x16x32_bf16 a[40:43], v[104:107], v[132:135], a[40:43]
  v_mfma_f32_16x16x32_bf16 a[60:63], v[104:107], v[136:139], a[60:63]
  buffer_load_dwordx4 v[104:107], v6, s[36:39], s28 offen offset:0
  v_mfma_f32_16x16x32_bf16 a[4:7], v[108:111], v[124:127], a[4:7]
  v_mfma_f32_16x16x32_bf16 a[24:27], v[108:111], v[128:131], a[24:27]
  v_mfma_f32_16x16x32_bf16 a[44:47], v[108:111], v[132:135], a[44:47]
  v_mfma_f32_16x16x32_bf16 a[64:67], v[108:111], v[136:139], a[64:67]
  buffer_load_dwordx4 v[108:111], v6, s[36:39], s28 offen offset:1024
  v_mfma_f32_16x16x32_bf16 a[8:11], v[112:115], v[124:127], a[8:11]
  v_mfma_f32_16x16x32_bf16 a[28:31], v[112:115], v[128:131], a[28:31]
  v_mfma_f32_16x16x32_bf16 a[48:51], v[112:115], v[132:135], a[48:51]
  v_mfma_f32_16x16x32_bf16 a[68:71], v[112:115], v[136:139], a[68:71]
  buffer_load_dwordx4 v[112:115], v6, s[36:39], s28 offen offset:2048
  v_mfma_f32_16x16x32_bf16 a[12:15], v[116:119], v[124:127], a[12:15]
  v_mfma_f32_16x16x32_bf16 a[32:35], v[116:119], v[128:131], a[32:35]
  v_mfma_f32_16x16x32_bf16 a[52:55], v[116:119], v[132:135], a[52:55]
  v_mfma_f32_16x16x32_bf16 a[72:75], v[116:119], v[136:139], a[72:75]
  buffer_load_dwordx4 v[116:119], v6, s[36:39], s28 offen offset:3072
  v_mfma_f32_16x16x32_bf16 a[16:19], v[120:123], v[124:127], a[16:19]
  buffer_load_dwordx4 v[124:127], v5, s[32:35], s26 offen offset:0
  v_mfma_f32_16x16x32_bf16 a[36:39], v[120:123], v[128:131], a[36:39]
  buffer_load_dwordx4 v[128:131], v5, s[32:35], s26 offen offset:256
  v_mfma_f32_16x16x32_bf16 a[56:59], v[120:123], v[132:135], a[56:59]
  buffer_load_dwordx4 v[132:135], v5, s[32:35], s27 offen offset:0
  v_mfma_f32_16x16x32_bf16 a[76:79], v[120:123], v[136:139], a[76:79]
  buffer_load_dwordx4 v[136:139], v5, s[32:35], s27 offen offset:256
  buffer_load_dwordx4 v[120:123], v7, s[36:39], s28 offen
  s_add_u32 s26, s26, 8192
  s_add_u32 s27, s27, 8192
  s_add_u32 s28, s28, 163840
  s_cmp_ge_u32 s20, 2
  s_cselect_b32 s26, 0x7ff00000, s26
  s_cselect_b32 s27, 0x7ff00000, s27
  s_cselect_b32 s28, 0x7ff00000, s28
  s_waitcnt vmcnt(18)
  v_mfma_f32_16x16x32_bf16 a[0:3], v[32:35], v[52:55], a[0:3]
  v_mfma_f32_16x16x32_bf16 a[20:23], v[32:35], v[56:59], a[20:23]
  v_mfma_f32_16x16x32_bf16 a[40:43], v[32:35], v[60:63], a[40:43]
  v_mfma_f32_16x16x32_bf16 a[60:63], v[32:35], v[64:67], a[60:63]
  buffer_load_dwordx4 v[32:35], v6, s[36:39], s28 offen offset:0
  v_mfma_f32_16x16x32_bf16 a[4:7], v[36:39], v[52:55], a[4:7]
  v_mfma_f32_16x16x32_bf16 a[24:27], v[36:39], v[56:59], a[24:27]
  v_mfma_f32_16x16x32_bf16 a[44:47], v[36:39], v[60:63], a[44:47]
  v_mfma_f32_16x16x32_bf16 a[64:67], v[36:39], v[64:67], a[64:67]
  buffer_load_dwordx4 v[36:39], v6, s[36:39], s28 offen offset:1024
  v_mfma_f32_16x16x32_bf16 a[8:11], v[40:43], v[52:55], a[8:11]
  v_mfma_f32_16x16x32_bf16 a[28:31], v[40:43], v[56:59], a[28:31]
  v_mfma_f32_16x16x32_bf16 a[48:51], v[40:43], v[60:63], a[48:51]
  v_mfma_f32_16x16x32_bf16 a[68:71], v[40:43], v[64:67], a[68:71]
  buffer_load_dwordx4 v[40:43], v6, s[36:39], s28 offen offset:2048
  v_mfma_f32_16x16x32_bf16 a[12:15], v[44:47], v[52:55], a[12:15]
  v_mfma_f32_16x16x32_bf16 a[32:35], v[44:47], v[56:59], a[32:35]
  v_mfma_f32_16x16x32_bf16 a[52:55], v[44:47], v[60:63], a[52:55]
  v_mfma_f32_16x16x32_bf16 a[72:75], v[44:47], v[64:67], a[72:75]
  buffer_load_dwordx4 v[44:47], v6, s[36:39], s28 offen offset:3072
  v_mfma_f32_16x16x32_bf16 a[16:19], v[48:51], v[52:55], a[16:19]
  buffer_load_dwordx4 v[52:55], v5, s[32:35], s26 offen offset:0
  v_mfma_f32_16x16x32_bf16 a[36:39], v[48:51], v[56:59], a[36:39]
  buffer_load_dwordx4 v[56:59], v5, s[32:35], s26 offen offset:256
  v_mfma_f32_16x16x32_bf16 a[56:59], v[48:51], v[60:63], a[56:59]
  buffer_load_dwordx4 v[60:63], v5, s[32:35], s27 offen offset:0
  v_mfma_f32_16x16x32_bf16 a[76:79], v[48:51], v[64:67], a[76:79]
  buffer_load_dwordx4 v[64:67], v5, s[32:35], s27 offen offset:256
  buffer_load_dwordx4 v[48:51], v7, s[36:39], s28 offen
  s_add_u32 s26, s26, 8192
  s_add_u32 s27, s27, 8192
  s_add_u32 s28, s28, 163840
  s_waitcnt vmcnt(18)
  v_mfma_f32_16x16x32_bf16 a[0:3], v[68:71], v[88:91], a[0:3]
  v_mfma_f32_16x16x32_bf16 a[20:23], v[68:71], v[92:95], a[20:23]
  v_mfma_f32_16x16x32_bf16 a[40:43], v[68:71], v[96:99], a[40:43]
  v_mfma_f32_16x16x32_bf16 a[60:63], v[68:71], v[100:103], a[60:63]
  v_mfma_f32_16x16x32_bf16 a[4:7], v[72:75], v[88:91], a[4:7]
  v_mfma_f32_16x16x32_bf16 a[24:27], v[72:75], v[92:95], a[24:27]
  v_mfma_f32_16x16x32_bf16 a[44:47], v[72:75], v[96:99], a[44:47]
  v_mfma_f32_16x16x32_bf16 a[64:67], v[72:75], v[100:103], a[64:67]
  v_mfma_f32_16x16x32_bf16 a[8:11], v[76:79], v[88:91], a[8:11]
  v_mfma_f32_16x16x32_bf16 a[28:31], v[76:79], v[92:95], a[28:31]
  v_mfma_f32_16x16x32_bf16 a[48:51], v[76:79], v[96:99], a[48:51]
  v_mfma_f32_16x16x32_bf16 a[68:71], v[76:79], v[100:103], a[68:71]
  v_mfma_f32_16x16x32_bf16 a[12:15], v[80:83], v[88:91], a[12:15]
  v_mfma_f32_16x16x32_bf16 a[32:35], v[80:83], v[92:95], a[32:35]
  v_mfma_f32_16x16x32_bf16 a[52:55], v[80:83], v[96:99], a[52:55]
  v_mfma_f32_16x16x32_bf16 a[72:75], v[80:83], v[100:103], a[72:75]
  v_mfma_f32_16x16x32_bf16 a[16:19], v[84:87], v[88:91], a[16:19]
  v_mfma_f32_16x16x32_bf16 a[36:39], v[84:87], v[92:95], a[36:39]
  v_mfma_f32_16x16x32_bf16 a[56:59], v[84:87], v[96:99], a[56:59]
  v_mfma_f32_16x16x32_bf16 a[76:79], v[84:87], v[100:103], a[76:79]
  s_waitcnt vmcnt(9)
  v_mfma_f32_16x16x32_bf16 a[0:3], v[104:107], v[124:127], a[0:3]
  v_mfma_f32_16x16x32_bf16 a[20:23], v[104:107], v[128:131], a[20:23]
  v_mfma_f32_16x16x32_bf16 a[40:43], v[104:107], v[132:135], a[40:43]
  v_mfma_f32_16x16x32_bf16 a[60:63], v[104:107], v[136:139], a[60:63]
  v_mfma_f32_16x16x32_bf16 a[4:7], v[108:111], v[124:127], a[4:7]
  v_mfma_f32_16x16x32_bf16 a[24:27], v[108:111], v[128:131], a[24:27]
  v_mfma_f32_16x16x32_bf16 a[44:47], v[108:111], v[132:135], a[44:47]
  v_mfma_f32_16x16x32_bf16 a[64:67], v[108:111], v[136:139], a[64:67]
  v_mfma_f32_16x16x32_bf16 a[8:11], v[112:115], v[124:127], a[8:11]
  v_mfma_f32_16x16x32_bf16 a[28:31], v[112:115], v[128:131], a[28:31]
  v_mfma_f32_16x16x32_bf16 a[48:51], v[112:115], v[132:135], a[48:51]
  v_mfma_f32_16x16x32_bf16 a[68:71], v[112:115], v[136:139], a[68:71]
  v_mfma_f32_16x16x32_bf16 a[12:15], v[116:119], v[124:127], a[12:15]
  v_mfma_f32_16x16x32_bf16 a[32:35], v[116:119], v[128:131], a[32:35]
  v_mfma_f32_16x16x32_bf16 a[52:55], v[116:119], v[132:135], a[52:55]
  v_mfma_f32_16x16x32_bf16 a[72:75], v[116:119], v[136:139], a[72:75]
  v_mfma_f32_16x16x32_bf16 a[16:19], v[120:123], v[124:127], a[16:19]
  v_mfma_f32_16x16x32_bf16 a[36:39], v[120:123], v[128:131], a[36:39]
  v_mfma_f32_16x16x32_bf16 a[56:59], v[120:123], v[132:135], a[56:59]
  v_mfma_f32_16x16x32_bf16 a[76:79], v[120:123], v[136:139], a[76:79]
  s_waitcnt vmcnt(0)
  v_mfma_f32_16x16x32_bf16 a[0:3], v[32:35], v[52:55], a[0:3]
  v_mfma_f32_16x16x32_bf16 a[20:23], v[32:35], v[56:59], a[20:23]
  v_mfma_f32_16x16x32_bf16 a[40:43], v[32:35], v[60:63], a[40:43]
  v_mfma_f32_16x16x32_bf16 a[60:63], v[32:35], v[64:67], a[60:63]
  v_mfma_f32_16x16x32_bf16 a[4:7], v[36:39], v[52:55], a[4:7]
  v_mfma_f32_16x16x32_bf16 a[24:27], v[36:39], v[56:59], a[24:27]
  v_mfma_f32_16x16x32_bf16 a[44:47], v[36:39], v[60:63], a[44:47]
  v_mfma_f32_16x16x32_bf16 a[64:67], v[36:39], v[64:67], a[64:67]
  v_mfma_f32_16x16x32_bf16 a[8:11], v[40:43], v[52:55], a[8:11]
  v_mfma_f32_16x16x32_bf16 a[28:31], v[40:43], v[56:59], a[28:31]
  v_mfma_f32_16x16x32_bf16 a[48:51], v[40:43], v[60:63], a[48:51]
  v_mfma_f32_16x16x32_bf16 a[68:71], v[40:43], v[64:67], a[68:71]
  v_mfma_f32_16x16x32_bf16 a[12:15], v[44:47], v[52:55], a[12:15]
  v_mfma_f32_16x16x32_bf16 a[32:35], v[44:47], v[56:59], a[32:35]
  v_mfma_f32_16x16x32_bf16 a[52:55], v[44:47], v[60:63], a[52:55]
  v_mfma_f32_16x16x32_bf16 a[72:75], v[44:47], v[64:67], a[72:75]
  v_mfma_f32_16x16x32_bf16 a[16:19], v[48:51], v[52:55], a[16:19]
  v_mfma_f32_16x16x32_bf16 a[36:39], v[48:51], v[56:59], a[36:39]
  v_mfma_f32_16x16x32_bf16 a[56:59], v[48:51], v[60:63], a[56:59]
  v_mfma_f32_16x16x32_bf16 a[76:79], v[48:51], v[64:67], a[76:79]
  v_mul_u32_u24 v14, 336, v3
  v_lshlrev_b32 v15, 4, v4
  v_add_u32 v14, v14, v15
  s_mul_i32 s29, s20, 21504
  v_add_u32 v14, s29, v14
  s_nop 7
  ds_write_b128 v14, a[0:3] offset:0
  ds_write_b128 v14, a[4:7] offset:64
  ds_write_b128 v14, a[8:11] offset:128
  ds_write_b128 v14, a[12:15] offset:192
  ds_write_b128 v14, a[16:19] offset:256
  ds_write_b128 v14, a[20:23] offset:5376
  ds_write_b128 v14, a[24:27] offset:5440
  ds_write_b128 v14, a[28:31] offset:5504
  ds_write_b128 v14, a[32:35] offset:5568
  ds_write_b128 v14, a[36:39] offset:5632
  ds_write_b128 v14, a[40:43] offset:10752
  ds_write_b128 v14, a[44:47] offset:10816
  ds_write_b128 v14, a[48:51] offset:10880
  ds_write_b128 v14, a[52:55] offset:10944
  ds_write_b128 v14, a[56:59] offset:11008
  ds_write_b128 v14, a[60:63] offset:16128
  ds_write_b128 v14, a[64:67] offset:16192
  ds_write_b128 v14, a[68:71] offset:16256
  ds_write_b128 v14, a[72:75] offset:16320
  ds_write_b128 v14, a[76:79] offset:16384
  s_waitcnt lgkmcnt(0)
  s_barrier
  ds_read_b128 v[40:43], v11 offset:0
  ds_read_b128 v[44:47], v11 offset:16
  ds_read_b128 v[48:51], v11 offset:21504
  ds_read_b128 v[52:55], v11 offset:21520
  ds_read_b128 v[56:59], v11 offset:43008
  ds_read_b128 v[60:63], v11 offset:43024
  ds_read_b128 v[64:67], v11 offset:64512
  ds_read_b128 v[68:71], v11 offset:64528
  v_lshlrev_b32 v80, 16, v20
  v_and_b32 v81, 0xffff0000, v20
  v_lshlrev_b32 v82, 16, v21
  v_and_b32 v83, 0xffff0000, v21
  v_lshlrev_b32 v84, 16, v22
  v_and_b32 v85, 0xffff0000, v22
  v_lshlrev_b32 v86, 16, v23
  v_and_b32 v87, 0xffff0000, v23
  s_waitcnt lgkmcnt(4)
  v_add_f32 v40, v40, v48
  v_add_f32 v41, v41, v49
  v_add_f32 v42, v42, v50
  v_add_f32 v43, v43, v51
  v_add_f32 v44, v44, v52
  v_add_f32 v45, v45, v53
  v_add_f32 v46, v46, v54
  v_add_f32 v47, v47, v55
  s_waitcnt lgkmcnt(0)
  v_add_f32 v56, v56, v64
  v_add_f32 v57, v57, v65
  v_add_f32 v58, v58, v66
  v_add_f32 v59, v59, v67
  v_add_f32 v60, v60, v68
  v_add_f32 v61, v61, v69
  v_add_f32 v62, v62, v70
  v_add_f32 v63, v63, v71
  v_add_f32 v40, v40, v80
  v_add_f32 v41, v41, v81
  v_add_f32 v42, v42, v82
  v_add_f32 v43, v43, v83
  v_add_f32 v44, v44, v84
  v_add_f32 v45, v45, v85
  v_add_f32 v46, v46, v86
  v_add_f32 v47, v47, v87
  v_add_f32 v40, v40, v56
  v_add_f32 v41, v41, v57
  v_add_f32 v42, v42, v58
  v_add_f32 v43, v43, v59
  v_add_f32 v44, v44, v60
  v_add_f32 v45, v45, v61
  v_add_f32 v46, v46, v62
  v_add_f32 v47, v47, v63
  v_cvt_pk_bf16_f32 v88, v40, v41
  v_cvt_pk_bf16_f32 v89, v42, v43
  v_cvt_pk_bf16_f32 v90, v44, v45
  v_cvt_pk_bf16_f32 v91, v46, v47
  buffer_store_dwordx4 v[88:91], v8, s[44:47], s30 offen
  s_nop 1
  ds_read_b128 v[40:43], v12 offset:0
  ds_read_b128 v[44:47], v12 offset:16
  ds_read_b128 v[48:51], v12 offset:21504
  ds_read_b128 v[52:55], v12 offset:21520
  ds_read_b128 v[56:59], v12 offset:43008
  ds_read_b128 v[60:63], v12 offset:43024
  ds_read_b128 v[64:67], v12 offset:64512
  ds_read_b128 v[68:71], v12 offset:64528
  v_lshlrev_b32 v80, 16, v24
  v_and_b32 v81, 0xffff0000, v24
  v_lshlrev_b32 v82, 16, v25
  v_and_b32 v83, 0xffff0000, v25
  v_lshlrev_b32 v84, 16, v26
  v_and_b32 v85, 0xffff0000, v26
  v_lshlrev_b32 v86, 16, v27
  v_and_b32 v87, 0xffff0000, v27
  s_waitcnt lgkmcnt(4)
  v_add_f32 v40, v40, v48
  v_add_f32 v41, v41, v49
  v_add_f32 v42, v42, v50
  v_add_f32 v43, v43, v51
  v_add_f32 v44, v44, v52
  v_add_f32 v45, v45, v53
  v_add_f32 v46, v46, v54
  v_add_f32 v47, v47, v55
  s_waitcnt lgkmcnt(0)
  v_add_f32 v56, v56, v64
  v_add_f32 v57, v57, v65
  v_add_f32 v58, v58, v66
  v_add_f32 v59, v59, v67
  v_add_f32 v60, v60, v68
  v_add_f32 v61, v61, v69
  v_add_f32 v62, v62, v70
  v_add_f32 v63, v63, v71
  v_add_f32 v40, v40, v80
  v_add_f32 v41, v41, v81
  v_add_f32 v42, v42, v82
  v_add_f32 v43, v43, v83
  v_add_f32 v44, v44, v84
  v_add_f32 v45, v45, v85
  v_add_f32 v46, v46, v86
  v_add_f32 v47, v47, v87
  v_add_f32 v40, v40, v56
  v_add_f32 v41, v41, v57
  v_add_f32 v42, v42, v58
  v_add_f32 v43, v43, v59
  v_add_f32 v44, v44, v60
  v_add_f32 v45, v45, v61
  v_add_f32 v46, v46, v62
  v_add_f32 v47, v47, v63
  v_cvt_pk_bf16_f32 v88, v40, v41
  v_cvt_pk_bf16_f32 v89, v42, v43
  v_cvt_pk_bf16_f32 v90, v44, v45
  v_cvt_pk_bf16_f32 v91, v46, v47
  buffer_store_dwordx4 v[88:91], v9, s[44:47], s30 offen
  s_nop 1
  s_cmp_ge_u32 s20, 2
  s_cbranch_scc1 final_kernel_done
  ds_read_b128 v[40:43], v13 offset:0
  ds_read_b128 v[44:47], v13 offset:16
  ds_read_b128 v[48:51], v13 offset:21504
  ds_read_b128 v[52:55], v13 offset:21520
  ds_read_b128 v[56:59], v13 offset:43008
  ds_read_b128 v[60:63], v13 offset:43024
  ds_read_b128 v[64:67], v13 offset:64512
  ds_read_b128 v[68:71], v13 offset:64528
  v_lshlrev_b32 v80, 16, v28
  v_and_b32 v81, 0xffff0000, v28
  v_lshlrev_b32 v82, 16, v29
  v_and_b32 v83, 0xffff0000, v29
  v_lshlrev_b32 v84, 16, v30
  v_and_b32 v85, 0xffff0000, v30
  v_lshlrev_b32 v86, 16, v31
  v_and_b32 v87, 0xffff0000, v31
  s_waitcnt lgkmcnt(4)
  v_add_f32 v40, v40, v48
  v_add_f32 v41, v41, v49
  v_add_f32 v42, v42, v50
  v_add_f32 v43, v43, v51
  v_add_f32 v44, v44, v52
  v_add_f32 v45, v45, v53
  v_add_f32 v46, v46, v54
  v_add_f32 v47, v47, v55
  s_waitcnt lgkmcnt(0)
  v_add_f32 v56, v56, v64
  v_add_f32 v57, v57, v65
  v_add_f32 v58, v58, v66
  v_add_f32 v59, v59, v67
  v_add_f32 v60, v60, v68
  v_add_f32 v61, v61, v69
  v_add_f32 v62, v62, v70
  v_add_f32 v63, v63, v71
  v_add_f32 v40, v40, v80
  v_add_f32 v41, v41, v81
  v_add_f32 v42, v42, v82
  v_add_f32 v43, v43, v83
  v_add_f32 v44, v44, v84
  v_add_f32 v45, v45, v85
  v_add_f32 v46, v46, v86
  v_add_f32 v47, v47, v87
  v_add_f32 v40, v40, v56
  v_add_f32 v41, v41, v57
  v_add_f32 v42, v42, v58
  v_add_f32 v43, v43, v59
  v_add_f32 v44, v44, v60
  v_add_f32 v45, v45, v61
  v_add_f32 v46, v46, v62
  v_add_f32 v47, v47, v63
  v_cvt_pk_bf16_f32 v88, v40, v41
  v_cvt_pk_bf16_f32 v89, v42, v43
  v_cvt_pk_bf16_f32 v90, v44, v45
  v_cvt_pk_bf16_f32 v91, v46, v47
  buffer_store_dwordx4 v[88:91], v10, s[44:47], s30 offen
  s_nop 1
final_kernel_done:
final_kernel_end:
  s_endpgm
code_end:
.section .rodata,"a"
.p2align 6
.amdhsa_kernel final_kernel
  .amdhsa_next_free_vgpr 512
  .amdhsa_next_free_sgpr 102
  .amdhsa_accum_offset 256
  .amdhsa_group_segment_fixed_size 0
  .amdhsa_kernarg_size 80
  .amdhsa_user_sgpr_count 2
  .amdhsa_user_sgpr_kernarg_segment_ptr 1
  .amdhsa_system_sgpr_workgroup_id_x 1
.end_amdhsa_kernel
.text
```
